```python
import torch

def _softmax(x, axis=-1):
    return torch.softmax(x, dim=axis)
def _gelu(x):
    return torch.nn.functional.gelu(x, approximate="tanh")
def _silu(x):
    return torch.nn.functional.silu(x)
def _sigmoid(x):
    return torch.sigmoid(x)
def _layernorm(x, axis=-1, eps=1e-5):
    m = x.mean(dim=axis, keepdim=True)
    v = x.var(dim=axis, keepdim=True, unbiased=False)
    return (x - m) / torch.sqrt(v + eps)
def _scatter_add(tgt, idx, src, axis=0):
    return tgt.clone().index_add_(axis, idx, src)
def _segment_sum(src, seg, n):
    out = torch.zeros((n,) + src.shape[1:], dtype=src.dtype)
    return out.index_add_(0, seg, src)
def _pad(x, pw):
    flat = tuple(v for pair in reversed(pw) for v in pair)
    return torch.nn.functional.pad(x, flat)

kernel_name = 'concat_heads__sliding_local_dilated__compressed_kv_cla__prompt'

def setup_inputs():

    _w = (lambda a: (lambda t: t.to(torch.bfloat16) if t.is_floating_point() else t)(torch.as_tensor(a)))
    def _A_setup():
        B, S, D = 1, 2048, 512
        return {
            "x": _w((lambda *s: torch.randn(*s, dtype=torch.bfloat16) * 0.4)(B, S, D)),
            "wqkv": _w((lambda *s: torch.randn(*s, dtype=torch.bfloat16) * 0.4)(D, 3 * D)),
            "wo": _w((lambda *s: torch.randn(*s, dtype=torch.bfloat16) * 0.05)(D, D)),
        }
    _A_in = _A_setup()

    def _B_setup():
        B, H, Sq, Sk, D, M = 1, 32, 2048, 2048, 128, 512
        Dc = 4 * D
        return {
            "x": _w((lambda *s: torch.randn(*s, dtype=torch.bfloat16) * 0.2)(B, Sq, M)),
            "c_kv": _w((lambda *s: torch.randn(*s, dtype=torch.bfloat16) * 1.6)(B, Sk, Dc)),
            "w_q": _w((lambda *s: torch.randn(*s, dtype=torch.bfloat16) * 3.2)(M, H, D) * (M ** -0.5)),
            "w_uk": _w((lambda *s: torch.randn(*s, dtype=torch.bfloat16) * 3.2)(Dc, H, D) * (Dc ** -0.5)),
            "w_uv": _w((lambda *s: torch.randn(*s, dtype=torch.bfloat16) * 1.6)(Dc, H, D) * (Dc ** -0.5)),
            "w_o": _w((lambda *s: torch.randn(*s, dtype=torch.bfloat16) * 1.6)(H, D, M) * ((H * D) ** -0.5)),
        }
    _B_in = _B_setup()

    return {
        "A_x": _A_in["x"],
        "A_wqkv": _A_in["wqkv"],
        "A_wo": _A_in["wo"],
        "B_x": _B_in["x"],
        "B_c_kv": _B_in["c_kv"],
        "B_w_q": _B_in["w_q"],
        "B_w_uk": _B_in["w_uk"],
        "B_w_uv": _B_in["w_uv"],
        "B_w_o": _B_in["w_o"],
    }

def reference(A_x, A_wqkv, A_wo, B_x, B_c_kv, B_w_q, B_w_uk, B_w_uv, B_w_o):
    def _A_ref(x, wqkv, wo):
        B, S, D = x.shape
        H = 32; Dh = D // H
        W, dil = 8, 2
        qkv = (lambda x, *d: x.permute(*d))((x @ wqkv).reshape(B, S, 3, H, Dh), 2, 0, 3, 1, 4)
        q, k, v = qkv[0], qkv[1], qkv[2]
        scale = Dh ** -0.5
        pos = torch.arange(S)
        off = torch.arange(W) * dil
        idx = pos[:, None] - off[None, :]
        mask = idx >= 0
        idx_c = torch.where(mask, idx, 0).reshape(-1)
        kg = k[:, :, idx_c, :].reshape(B, H, S, W, Dh)
        vg = v[:, :, idx_c, :].reshape(B, H, S, W, Dh)
        logits = torch.einsum("bhsd,bhswd->bhsw", q, kg) * scale
        logits = torch.where(mask[None, None, :, :], logits, -1e9)
        attn = _softmax(logits, axis=-1)
        o = torch.einsum("bhsw,bhswd->bhsd", attn, vg)
        return (lambda x, *d: x.permute(*d))(o, 0, 2, 1, 3).reshape(B, S, D) @ wo

    def _B_ref(x, c_kv, w_q, w_uk, w_uv, w_o):
        B, Sq, M = x.shape[0], x.shape[1], x.shape[2]
        Sk = c_kv.shape[1]
        H, D = w_q.shape[1], w_q.shape[2]
        q = torch.einsum("bqm,mhd->bhqd", x, w_q)
        k = torch.einsum("bkc,chd->bhkd", c_kv, w_uk)
        v = torch.einsum("bkc,chd->bhkd", c_kv, w_uv)
        scores = torch.einsum("bhqd,bhkd->bhqk", q, k) * (D ** -0.5)
        off = Sk - Sq
        qi = torch.arange(Sq)[:, None]
        kj = torch.arange(Sk)[None, :]
        cmask = kj <= (qi + off)
        scores = torch.where(cmask[None, None], scores, -1e9)
        p = _softmax(scores, axis=-1)
        ctx = torch.einsum("bhqk,bhkd->bhqd", p, v)
        return torch.einsum("bhqd,hdm->bqm", ctx, w_o)

    a = _A_ref(A_x, A_wqkv, A_wo)
    b = _B_ref(B_x, B_c_kv, B_w_q, B_w_uk, B_w_uv, B_w_o)
    return torch.concatenate([a, b], axis=-1)
```

```asm
; @launch grid=(256,1,1) block=(256,1,1) lds=163840
.amdgcn_target "amdgcn-amd-amdhsa--gfx950"
.text
.globl concat_heads__sliding_local_dilated__compressed_kv_cla__prompt_kernel
.p2align 8
.type concat_heads__sliding_local_dilated__compressed_kv_cla__prompt_kernel,@function
concat_heads__sliding_local_dilated__compressed_kv_cla__prompt_kernel:
    s_load_dwordx16 s[56:71], s[0:1], 0
    s_load_dwordx8 s[72:79], s[0:1], 64
    s_getpc_b64 s[100:101]
L_pc:
    s_lshr_b32 s3, s2, 3
    s_lshl_b32 s3, s3, 4
    v_lshrrev_b32 v4, 4, v0
    v_add_lshl_u32 v4, v4, s3, 7
    v_min_u32 v4, 59800, v4
    v_mov_b32 v5, 0
    v_lshl_add_u64 v[4:5], v[4:5], 0, s[100:101]
    global_load_dword v3, v[4:5], off
    v_lshrrev_b32 v4, 3, v0
    v_lshlrev_b32 v4, 7, v4
    v_mov_b32 v5, 0
    v_lshl_add_u64 v[4:5], v[4:5], 0, s[100:101]
    global_load_dword v3, v[4:5], off
    s_cmp_ge_u32 s2, 256
    s_cbranch_scc1 L_end
    v_lshrrev_b32 v1, 6, v0
    s_and_b32 s31, s2, 7
    v_readfirstlane_b32 s28, v1
    s_lshr_b32 s30, s2, 3
    s_and_b32 s29, s30, 3
    s_lshl2_add_u32 s29, s31, s29
    s_lshr_b32 s30, s30, 2
    v_and_b32 v1, 63, v0
    v_lshrrev_b32 v32, 3, v1
    v_and_b32 v33, 7, v1
    v_and_b32 v34, 2, v32
    v_xor_b32 v34, v34, v33
    v_lshlrev_b32 v34, 4, v34
    v_mul_u32_u24 v35, 3072, v32
    v_add_u32 v28, v35, v34
    v_xor_b32 v34, 64, v34
    v_add_u32 v35, v35, v34
    v_add_u32 v29, 23552, v35
    v_lshrrev_b32 v34, 4, v1
    v_xor_b32 v34, v34, v33
    v_lshlrev_b32 v34, 4, v34
    v_lshl_add_u32 v4, v32, 10, v34
    s_and_b32 s47, s28, 1
    s_lshl_b32 s47, s47, 6
    v_xor_b32 v10, s47, v4
    v_xor_b32 v11, 64, v10
    s_mul_i32 s38, s28, 24576
    s_add_u32 s38, s38, 65536
    s_lshr_b32 s53, s31, 1
    s_lshl_b32 s53, s53, 3
    s_add_u32 s53, s53, s30
    s_and_b32 s52, s29, 7
    s_lshl_b32 s44, s52, 7
    s_mul_i32 s47, s28, 49152
    s_add_u32 s44, s44, s47
    s_mul_i32 s43, s28, 3072
    s_lshl_b32 s47, s53, 16
    s_lshl_b32 s54, s43, 3
    s_add_u32 s47, s47, s54
    s_sub_u32 s40, s47, 16384
    s_cselect_b32 s40, 1073741824, s40
    s_sub_u32 s41, s47, 8192
    s_cselect_b32 s41, 1073741824, s41
    s_mov_b32 s42, s47
    s_cmp_eq_u32 s28, 3
    s_cselect_b32 s41, 1073741824, s41
    s_cselect_b32 s42, 1073741824, s42
    s_waitcnt lgkmcnt(0)
    s_mov_b32 s16, s58
    s_mov_b32 s17, s59
    s_mov_b32 s18, 1572864
    s_mov_b32 s19, 0x20000
    s_mov_b32 s4, s56
    s_mov_b32 s5, s57
    s_mov_b32 s6, 2097152
    s_mov_b32 s7, 0x20000
    s_mov_b32 s35, 0
    s_mul_i32 s48, s35, 1536
    s_add_u32 s48, s48, s44
    s_add_u32 s47, s48, 0
    s_add_u32 m0, s38, 0
    s_nop 0
    buffer_load_dwordx4 v28, s[16:19], s47 offen offset:0 lds
    buffer_load_dwordx4 v29, s[16:19], s47 offen offset:1024 lds
    s_add_u32 s47, s48, 1024
    s_add_u32 m0, s38, 2048
    s_nop 0
    buffer_load_dwordx4 v28, s[16:19], s47 offen offset:0 lds
    s_mov_b32 s45, 0
    s_add_u32 s49, s40, s45
    s_add_u32 m0, s43, 0
    s_nop 0
    buffer_load_dwordx4 v10, s[4:7], s49 offen lds
    s_add_u32 s49, s41, s45
    s_add_u32 m0, s43, 1024
    s_nop 0
    buffer_load_dwordx4 v11, s[4:7], s49 offen lds
    s_add_u32 s47, s48, 1024
    s_add_u32 m0, s38, 2048
    s_nop 0
    buffer_load_dwordx4 v29, s[16:19], s47 offen offset:1024 lds
    s_add_u32 s47, s48, 2048
    s_add_u32 m0, s38, 4096
    s_nop 0
    buffer_load_dwordx4 v28, s[16:19], s47 offen offset:0 lds
    buffer_load_dwordx4 v29, s[16:19], s47 offen offset:1024 lds
    s_add_u32 s49, s42, s45
    s_add_u32 m0, s43, 2048
    s_nop 0
    buffer_load_dwordx4 v10, s[4:7], s49 offen lds
    s_mov_b32 s35, 128
    s_mul_i32 s48, s35, 1536
    s_add_u32 s48, s48, s44
    s_add_u32 s47, s48, 0
    s_add_u32 m0, s38, 8192
    s_nop 0
    buffer_load_dwordx4 v28, s[16:19], s47 offen offset:0 lds
    buffer_load_dwordx4 v29, s[16:19], s47 offen offset:1024 lds
    s_add_u32 s47, s48, 1024
    s_add_u32 m0, s38, 10240
    s_nop 0
    buffer_load_dwordx4 v28, s[16:19], s47 offen offset:0 lds
    s_mov_b32 s45, 128
    s_add_u32 s49, s40, s45
    s_add_u32 m0, s43, 16384
    s_nop 0
    buffer_load_dwordx4 v10, s[4:7], s49 offen lds
    s_add_u32 s49, s41, s45
    s_add_u32 m0, s43, 17408
    s_nop 0
    buffer_load_dwordx4 v11, s[4:7], s49 offen lds
    s_add_u32 s47, s48, 1024
    s_add_u32 m0, s38, 10240
    s_nop 0
    buffer_load_dwordx4 v29, s[16:19], s47 offen offset:1024 lds
    s_add_u32 s47, s48, 2048
    s_add_u32 m0, s38, 12288
    s_nop 0
    buffer_load_dwordx4 v28, s[16:19], s47 offen offset:0 lds
    buffer_load_dwordx4 v29, s[16:19], s47 offen offset:1024 lds
    s_add_u32 s49, s42, s45
    s_add_u32 m0, s43, 18432
    s_nop 0
    buffer_load_dwordx4 v10, s[4:7], s49 offen lds
    s_add_u32 s47, s30, s29
    s_and_b32 s48, s47, 3
    s_lshl_b32 s48, s48, 2
    s_lshr_b32 s1, 0x765432, s48
    s_sub_u32 s48, 24, s48
    s_lshl_b32 s48, 0x765432, s48
    s_or_b32 s1, s1, s48
    s_lshl_b32 s1, s1, 8
    v_lshlrev_b32 v2, 4, v1
    v_and_b32 v32, 15, v1
    v_lshrrev_b32 v33, 4, v1
    v_lshrrev_b32 v34, 1, v32
    v_xor_b32 v34, v34, v33
    v_lshlrev_b32 v34, 4, v34
    v_lshl_add_u32 v24, v32, 7, v34
    v_xor_b32 v25, 64, v24
    v_add_u32 v12, s38, v24
    v_xor_b32 v13, 64, v12
    v_bfe_u32 v34, v1, 2, 2
    v_and_b32 v33, 1, v33
    v_lshl_add_u32 v35, v33, 3, v34
    v_lshlrev_b32 v35, 7, v35
    v_and_b32 v32, 3, v1
    v_lshl_add_u32 v35, v32, 3, v35
    v_lshrrev_b32 v34, 1, v34
    v_lshl_or_b32 v34, v33, 1, v34
    v_xor_b32 v34, s28, v34
    v_lshl_add_u32 v35, v34, 5, v35
    v_lshrrev_b32 v34, 5, v1
    v_mul_u32_u24 v34, 24576, v34
    v_add_u32 v35, v35, v34
    v_add_u32 v30, 0x10000, v35
    v_add_u32 v31, 114688, v35
    v_xor_b32 v34, 64, v4
    v_add_u32 v5, 7168, v34
    v_add_u32 v6, 14336, v4
    v_add_u32 v7, 21504, v34
    s_mov_b32 s20, s78
    s_mov_b32 s21, s79
    s_mov_b32 s22, 85983232
    s_mov_b32 s23, 0x20000
    s_mov_b32 s24, s76
    s_mov_b32 s25, s77
    s_mov_b32 s26, 256
    s_mov_b32 s27, 0x20000
    s_mov_b32 s8, s64
    s_mov_b32 s9, s65
    s_mov_b32 s10, 2097152
    s_mov_b32 s11, 0x20000
    s_mov_b32 s12, s68
    s_mov_b32 s13, s69
    s_mov_b32 s14, 4194304
    s_mov_b32 s15, 0x20000
    s_lshl_b32 s100, s2, 2
    s_or_b32 s100, s100, s28
    s_cmp_lg_u32 s100, 0
    s_cbranch_scc1 L_nononce
    s_memrealtime s[100:101]
    s_waitcnt lgkmcnt(0)
    s_or_b32 s100, s100, 1
    v_mov_b32 v14, s100
    v_mov_b32 v15, 0
    s_mov_b64 exec, 1
    buffer_store_dword v14, v15, s[24:27], 0 offen sc1
    s_mov_b64 exec, -1
L_nononce:
    s_waitcnt vmcnt(9)
    s_barrier
    ds_read_b128 a[0:3], v24 offset:0
    ds_read_b128 a[4:7], v24 offset:2048
    ds_read_b128 a[8:11], v24 offset:4096
    ds_read_b128 a[12:15], v24 offset:6144
    ds_read_b128 a[16:19], v24 offset:8192
    ds_read_b64_tr_b16 v[64:65], v30 offset:2048
    ds_read_b64_tr_b16 v[66:67], v30 offset:2560
    ds_read_b64_tr_b16 v[68:69], v30 offset:4096
    ds_read_b64_tr_b16 v[70:71], v30 offset:4608
    ds_read_b64_tr_b16 v[72:73], v30 offset:0
    ds_read_b64_tr_b16 v[74:75], v30 offset:512
    s_waitcnt lgkmcnt(4)
    v_mfma_f32_16x16x32_bf16 v[128:131], v[64:67], a[0:3], 0
    s_bfe_u32 s45, s1, 196616
    s_lshl_b32 s45, s45, 7
    v_mfma_f32_16x16x32_bf16 v[132:135], v[64:67], a[4:7], 0
    s_waitcnt lgkmcnt(0)
    s_add_u32 s49, s40, s45
    v_mfma_f32_16x16x32_bf16 v[136:139], v[64:67], a[8:11], 0
    s_add_u32 m0, s43, 32768
    ds_read_b128 a[20:23], v25 offset:0
    v_mfma_f32_16x16x32_bf16 v[140:143], v[64:67], a[12:15], 0
    ds_read_b128 a[24:27], v25 offset:2048
    buffer_load_dwordx4 v10, s[4:7], s49 offen lds
    s_add_u32 s49, s41, s45
    v_mfma_f32_16x16x32_bf16 v[144:147], v[64:67], a[16:19], 0
    s_add_u32 m0, s43, 33792
    ds_read_b128 a[28:31], v25 offset:4096
    v_mfma_f32_16x16x32_bf16 v[148:151], a[0:3], v[68:71], 0
    ds_read_b128 a[32:35], v25 offset:6144
    buffer_load_dwordx4 v11, s[4:7], s49 offen lds
    s_add_u32 s49, s42, s45
    v_mfma_f32_16x16x32_bf16 v[152:155], a[4:7], v[68:71], 0
    s_add_u32 m0, s43, 34816
    ds_read_b128 a[36:39], v25 offset:8192
    v_mfma_f32_16x16x32_bf16 v[156:159], a[8:11], v[68:71], 0
    ds_read_b64_tr_b16 v[76:77], v31 offset:2048
    buffer_load_dwordx4 v10, s[4:7], s49 offen lds
    s_bfe_u32 s35, s1, 196616
    s_lshl_b32 s35, s35, 7
    s_mul_i32 s48, s35, 1536
    s_add_u32 s48, s48, s44
    s_add_u32 s47, s48, 0
    v_mfma_f32_16x16x32_bf16 v[160:163], a[12:15], v[68:71], 0
    s_add_u32 m0, s38, 16384
    ds_read_b64_tr_b16 v[78:79], v31 offset:2560
    v_mfma_f32_16x16x32_bf16 v[164:167], a[16:19], v[68:71], 0
    ds_read_b64_tr_b16 v[80:81], v31 offset:4096
    buffer_load_dwordx4 v28, s[16:19], s47 offen offset:0 lds
    v_mfma_f32_16x16x32_bf16 v[168:171], v[72:75], a[4:7], 0
    ds_read_b64_tr_b16 v[82:83], v31 offset:4608
    v_mfma_f32_16x16x32_bf16 v[172:175], v[72:75], a[8:11], 0
    ds_read_b64_tr_b16 v[84:85], v31 offset:0
    buffer_load_dwordx4 v29, s[16:19], s47 offen offset:1024 lds
    s_add_u32 s47, s48, 1024
    v_mfma_f32_16x16x32_bf16 v[176:179], v[72:75], a[12:15], 0
    s_add_u32 m0, s38, 18432
    ds_read_b64_tr_b16 v[86:87], v31 offset:512
    v_mfma_f32_16x16x32_bf16 v[180:183], v[72:75], a[16:19], 0
    buffer_load_dwordx4 v28, s[16:19], s47 offen offset:0 lds
    s_waitcnt lgkmcnt(4)
    v_mfma_f32_16x16x32_bf16 v[128:131], v[76:79], a[20:23], v[128:131]
    v_mfma_f32_16x16x32_bf16 v[132:135], v[76:79], a[24:27], v[132:135]
    s_waitcnt vmcnt(6) lgkmcnt(0)
    s_barrier
    s_add_u32 s47, s48, 1024
    v_mfma_f32_16x16x32_bf16 v[136:139], v[76:79], a[28:31], v[136:139]
    s_add_u32 m0, s38, 18432
    ds_read_b128 a[0:3], v24 offset:16384
    v_mfma_f32_16x16x32_bf16 v[140:143], v[76:79], a[32:35], v[140:143]
    ds_read_b128 a[4:7], v24 offset:18432
    buffer_load_dwordx4 v29, s[16:19], s47 offen offset:1024 lds
    s_add_u32 s47, s48, 2048
    v_mfma_f32_16x16x32_bf16 v[144:147], v[76:79], a[36:39], v[144:147]
    s_add_u32 m0, s38, 20480
    ds_read_b128 a[8:11], v24 offset:20480
    v_mfma_f32_16x16x32_bf16 v[148:151], a[20:23], v[80:83], v[148:151]
    ds_read_b128 a[12:15], v24 offset:22528
    buffer_load_dwordx4 v28, s[16:19], s47 offen offset:0 lds
    v_mfma_f32_16x16x32_bf16 v[152:155], a[24:27], v[80:83], v[152:155]
    ds_read_b128 a[16:19], v24 offset:24576
    v_mfma_f32_16x16x32_bf16 v[156:159], a[28:31], v[80:83], v[156:159]
    ds_read_b64_tr_b16 v[64:65], v30 offset:10240
    buffer_load_dwordx4 v29, s[16:19], s47 offen offset:1024 lds
    s_bfe_u32 s45, s1, 196620
    s_lshl_b32 s45, s45, 7
    s_add_u32 s49, s40, s45
    v_mfma_f32_16x16x32_bf16 v[160:163], a[32:35], v[80:83], v[160:163]
    s_add_u32 m0, s43, 49152
    ds_read_b64_tr_b16 v[66:67], v30 offset:10752
    v_mfma_f32_16x16x32_bf16 v[164:167], a[36:39], v[80:83], v[164:167]
    ds_read_b64_tr_b16 v[68:69], v30 offset:12288
    buffer_load_dwordx4 v10, s[4:7], s49 offen lds
    s_add_u32 s49, s41, s45
    v_mfma_f32_16x16x32_bf16 v[168:171], v[84:87], a[24:27], v[168:171]
    s_add_u32 m0, s43, 50176
    ds_read_b64_tr_b16 v[70:71], v30 offset:12800
    v_mfma_f32_16x16x32_bf16 v[172:175], v[84:87], a[28:31], v[172:175]
    ds_read_b64_tr_b16 v[72:73], v30 offset:8192
    buffer_load_dwordx4 v11, s[4:7], s49 offen lds
    s_add_u32 s49, s42, s45
    v_mfma_f32_16x16x32_bf16 v[176:179], v[84:87], a[32:35], v[176:179]
    s_add_u32 m0, s43, 51200
    ds_read_b64_tr_b16 v[74:75], v30 offset:8704
    v_mfma_f32_16x16x32_bf16 v[180:183], v[84:87], a[36:39], v[180:183]
    buffer_load_dwordx4 v10, s[4:7], s49 offen lds
    s_waitcnt lgkmcnt(4)
    v_mfma_f32_16x16x32_bf16 v[128:131], v[64:67], a[0:3], v[128:131]
    s_bfe_u32 s35, s1, 196620
    s_lshl_b32 s35, s35, 7
    s_mul_i32 s48, s35, 1536
    s_add_u32 s48, s48, s44
    v_mfma_f32_16x16x32_bf16 v[132:135], v[64:67], a[4:7], v[132:135]
    s_waitcnt lgkmcnt(0)
    s_add_u32 s47, s48, 0
    v_mfma_f32_16x16x32_bf16 v[136:139], v[64:67], a[8:11], v[136:139]
    s_add_u32 m0, s38, 0
    ds_read_b128 a[20:23], v25 offset:16384
    v_mfma_f32_16x16x32_bf16 v[140:143], v[64:67], a[12:15], v[140:143]
    ds_read_b128 a[24:27], v25 offset:18432
    buffer_load_dwordx4 v28, s[16:19], s47 offen offset:0 lds
    v_mfma_f32_16x16x32_bf16 v[144:147], v[64:67], a[16:19], v[144:147]
    ds_read_b128 a[28:31], v25 offset:20480
    v_mfma_f32_16x16x32_bf16 v[148:151], a[0:3], v[68:71], v[148:151]
    ds_read_b128 a[32:35], v25 offset:22528
    buffer_load_dwordx4 v29, s[16:19], s47 offen offset:1024 lds
    s_add_u32 s47, s48, 1024
    v_mfma_f32_16x16x32_bf16 v[152:155], a[4:7], v[68:71], v[152:155]
    s_add_u32 m0, s38, 2048
    ds_read_b128 a[36:39], v25 offset:24576
    v_mfma_f32_16x16x32_bf16 v[156:159], a[8:11], v[68:71], v[156:159]
    ds_read_b64_tr_b16 v[76:77], v31 offset:10240
    buffer_load_dwordx4 v28, s[16:19], s47 offen offset:0 lds
    s_add_u32 s47, s48, 1024
    v_mfma_f32_16x16x32_bf16 v[160:163], a[12:15], v[68:71], v[160:163]
    s_add_u32 m0, s38, 2048
    ds_read_b64_tr_b16 v[78:79], v31 offset:10752
    v_mfma_f32_16x16x32_bf16 v[164:167], a[16:19], v[68:71], v[164:167]
    ds_read_b64_tr_b16 v[80:81], v31 offset:12288
    buffer_load_dwordx4 v29, s[16:19], s47 offen offset:1024 lds
    s_add_u32 s47, s48, 2048
    v_mfma_f32_16x16x32_bf16 v[168:171], v[72:75], a[4:7], v[168:171]
    s_add_u32 m0, s38, 4096
    ds_read_b64_tr_b16 v[82:83], v31 offset:12800
    v_mfma_f32_16x16x32_bf16 v[172:175], v[72:75], a[8:11], v[172:175]
    ds_read_b64_tr_b16 v[84:85], v31 offset:8192
    buffer_load_dwordx4 v28, s[16:19], s47 offen offset:0 lds
    v_mfma_f32_16x16x32_bf16 v[176:179], v[72:75], a[12:15], v[176:179]
    ds_read_b64_tr_b16 v[86:87], v31 offset:8704
    v_mfma_f32_16x16x32_bf16 v[180:183], v[72:75], a[16:19], v[180:183]
    buffer_load_dwordx4 v29, s[16:19], s47 offen offset:1024 lds
    s_waitcnt lgkmcnt(4)
    v_mfma_f32_16x16x32_bf16 v[128:131], v[76:79], a[20:23], v[128:131]
    s_bfe_u32 s35, s1, 196624
    s_lshl_b32 s35, s35, 7
    s_mul_i32 s48, s35, 1536
    s_add_u32 s48, s48, s44
    s_lshl_b32 s37, s29, 8
    s_lshl_b32 s39, s28, 11
    s_and_b32 s100, s28, 1
    s_lshl_b32 s100, s100, 2
    v_lshrrev_b32 v96, 4, v1
    v_or_b32 v97, s100, v96
    v_mfma_f32_16x16x32_bf16 v[132:135], v[76:79], a[24:27], v[132:135]
    s_waitcnt vmcnt(9) lgkmcnt(0)
    s_barrier
    s_add_u32 s47, s48, 0
    v_lshlrev_b32 v97, 1, v97
    v_and_b32 v98, 15, v1
    v_mfma_f32_16x16x32_bf16 v[136:139], v[76:79], a[28:31], v[136:139]
    s_add_u32 m0, s38, 8192
    ds_read_b128 a[0:3], v24 offset:32768
    v_xor_b32 v97, v97, v98
    v_mfma_f32_16x16x32_bf16 v[140:143], v[76:79], a[32:35], v[140:143]
    ds_read_b128 a[4:7], v24 offset:34816
    buffer_load_dwordx4 v28, s[16:19], s47 offen offset:0 lds
    v_mfma_f32_16x16x32_bf16 v[144:147], v[76:79], a[36:39], v[144:147]
    ds_read_b128 a[8:11], v24 offset:36864
    v_lshlrev_b32 v97, 4, v97
    v_mfma_f32_16x16x32_bf16 v[148:151], a[20:23], v[80:83], v[148:151]
    ds_read_b128 a[12:15], v24 offset:38912
    buffer_load_dwordx4 v29, s[16:19], s47 offen offset:1024 lds
    s_add_u32 s47, s48, 1024
    v_mfma_f32_16x16x32_bf16 v[152:155], a[24:27], v[80:83], v[152:155]
    s_add_u32 m0, s38, 10240
    ds_read_b128 a[16:19], v24 offset:40960
    v_lshl_add_u32 v97, v96, 13, v97
    v_mfma_f32_16x16x32_bf16 v[156:159], a[28:31], v[80:83], v[156:159]
    s_lshl_b32 s100, s28, 16
    ds_read_b64_tr_b16 v[64:65], v30 offset:18432
    buffer_load_dwordx4 v28, s[16:19], s47 offen offset:0 lds
    s_add_u32 s47, s48, 1024
    v_mfma_f32_16x16x32_bf16 v[160:163], a[32:35], v[80:83], v[160:163]
    s_add_u32 m0, s38, 10240
    ds_read_b64_tr_b16 v[66:67], v30 offset:18944
    v_add_u32 v8, s100, v97
    v_mfma_f32_16x16x32_bf16 v[164:167], a[36:39], v[80:83], v[164:167]
    ds_read_b64_tr_b16 v[68:69], v30 offset:20480
    buffer_load_dwordx4 v29, s[16:19], s47 offen offset:1024 lds
    s_add_u32 s47, s48, 2048
    v_mfma_f32_16x16x32_bf16 v[168:171], v[84:87], a[24:27], v[168:171]
    s_add_u32 m0, s38, 12288
    ds_read_b64_tr_b16 v[70:71], v30 offset:20992
    v_add_u32 v9, 31744, v8
    v_mfma_f32_16x16x32_bf16 v[172:175], v[84:87], a[28:31], v[172:175]
    s_lshl_b32 s32, s30, 18
    s_add_u32 s32, s32, s100
    ds_read_b64_tr_b16 v[72:73], v30 offset:16384
    buffer_load_dwordx4 v28, s[16:19], s47 offen offset:0 lds
    v_mfma_f32_16x16x32_bf16 v[176:179], v[84:87], a[32:35], v[176:179]
    ds_read_b64_tr_b16 v[74:75], v30 offset:16896
    v_bfe_u32 v97, v1, 2, 2
    v_mfma_f32_16x16x32_bf16 v[180:183], v[84:87], a[36:39], v[180:183]
    buffer_load_dwordx4 v29, s[16:19], s47 offen offset:1024 lds
    v_lshl_add_u32 v98, v96, 3, v97
    s_waitcnt lgkmcnt(4)
    v_mfma_f32_16x16x32_bf16 v[128:131], v[64:67], a[0:3], v[128:131]
    s_bfe_u32 s45, s1, 196624
    s_lshl_b32 s45, s45, 7
    v_and_b32 v96, 1, v96
    v_lshl_or_b32 v99, v96, 2, v97
    v_mfma_f32_16x16x32_bf16 v[132:135], v[64:67], a[4:7], v[132:135]
    s_waitcnt lgkmcnt(0)
    s_add_u32 s49, s40, s45
    v_lshlrev_b32 v99, 5, v99
    v_lshl_add_u32 v99, v98, 8, v99
    v_mfma_f32_16x16x32_bf16 v[136:139], v[64:67], a[8:11], v[136:139]
    s_add_u32 m0, s43, 0
    ds_read_b128 a[20:23], v25 offset:32768
    v_and_b32 v96, 3, v1
    v_mfma_f32_16x16x32_bf16 v[140:143], v[64:67], a[12:15], v[140:143]
    ds_read_b128 a[24:27], v25 offset:34816
    buffer_load_dwordx4 v10, s[4:7], s49 offen lds
    s_add_u32 s49, s41, s45
    v_mfma_f32_16x16x32_bf16 v[144:147], v[64:67], a[16:19], v[144:147]
    s_add_u32 m0, s43, 1024
    ds_read_b128 a[28:31], v25 offset:36864
    v_lshl_add_u32 v16, v96, 3, v99
    v_mfma_f32_16x16x32_bf16 v[148:151], a[0:3], v[68:71], v[148:151]
    ds_read_b128 a[32:35], v25 offset:38912
    buffer_load_dwordx4 v11, s[4:7], s49 offen lds
    s_add_u32 s49, s42, s45
    v_mfma_f32_16x16x32_bf16 v[152:155], a[4:7], v[68:71], v[152:155]
    s_add_u32 m0, s43, 2048
    ds_read_b128 a[36:39], v25 offset:40960
    v_xor_b32 v17, 32, v16
    v_mfma_f32_16x16x32_bf16 v[156:159], a[8:11], v[68:71], v[156:159]
    ds_read_b64_tr_b16 v[76:77], v31 offset:18432
    buffer_load_dwordx4 v10, s[4:7], s49 offen lds
    s_bfe_u32 s45, s1, 196628
    s_lshl_b32 s45, s45, 7
    s_add_u32 s49, s40, s45
    v_mfma_f32_16x16x32_bf16 v[160:163], a[12:15], v[68:71], v[160:163]
    s_add_u32 m0, s43, 16384
    ds_read_b64_tr_b16 v[78:79], v31 offset:18944
    v_xor_b32 v18, 64, v16
    v_mfma_f32_16x16x32_bf16 v[164:167], a[16:19], v[68:71], v[164:167]
    ds_read_b64_tr_b16 v[80:81], v31 offset:20480
    buffer_load_dwordx4 v10, s[4:7], s49 offen lds
    s_add_u32 s49, s41, s45
    v_mfma_f32_16x16x32_bf16 v[168:171], v[72:75], a[4:7], v[168:171]
    s_add_u32 m0, s43, 17408
    ds_read_b64_tr_b16 v[82:83], v31 offset:20992
    v_xor_b32 v19, 96, v16
    v_mfma_f32_16x16x32_bf16 v[172:175], v[72:75], a[8:11], v[172:175]
    ds_read_b64_tr_b16 v[84:85], v31 offset:16384
    buffer_load_dwordx4 v11, s[4:7], s49 offen lds
    s_add_u32 s49, s42, s45
    v_mfma_f32_16x16x32_bf16 v[176:179], v[72:75], a[12:15], v[176:179]
    s_add_u32 m0, s43, 18432
    ds_read_b64_tr_b16 v[86:87], v31 offset:16896
    v_xor_b32 v20, 128, v16
    v_mfma_f32_16x16x32_bf16 v[180:183], v[72:75], a[16:19], v[180:183]
    buffer_load_dwordx4 v10, s[4:7], s49 offen lds
    v_xor_b32 v21, 160, v16
    v_min_u32 v14, 15, v1
    v_lshlrev_b32 v14, 7, v14
    s_lshl2_add_u32 s100, s2, s28
    s_mul_i32 s100, s100, 2048
    v_add_u32 v14, s100, v14
    global_load_dword v3, v14, s[64:65]
    s_waitcnt lgkmcnt(4)
    v_mfma_f32_16x16x32_bf16 v[128:131], v[76:79], a[20:23], v[128:131]
    s_bfe_u32 s35, s1, 196628
    s_lshl_b32 s35, s35, 7
    s_mul_i32 s48, s35, 1536
    s_add_u32 s48, s48, s44
    v_xor_b32 v22, 192, v16
    v_xor_b32 v23, 224, v16
    v_mfma_f32_16x16x32_bf16 v[132:135], v[76:79], a[24:27], v[132:135]
    s_waitcnt vmcnt(13) lgkmcnt(0)
    s_barrier
    s_add_u32 s47, s48, 0
    v_mfma_f32_16x16x32_bf16 v[136:139], v[76:79], a[28:31], v[136:139]
    s_lshl_b32 s100, s30, 2
    s_add_u32 m0, s38, 16384
    ds_read_b128 a[0:3], v24 offset:49152
    v_mfma_f32_16x16x32_bf16 v[140:143], v[76:79], a[32:35], v[140:143]
    s_add_u32 s34, s100, s28
    ds_read_b128 a[4:7], v24 offset:51200
    buffer_load_dwordx4 v28, s[16:19], s47 offen offset:0 lds
    v_mfma_f32_16x16x32_bf16 v[144:147], v[76:79], a[36:39], v[144:147]
    s_lshl_b32 s100, s100, 1
    ds_read_b128 a[8:11], v24 offset:53248
    v_mfma_f32_16x16x32_bf16 v[148:151], a[20:23], v[80:83], v[148:151]
    s_sub_u32 s33, s28, s100
    ds_read_b128 a[12:15], v24 offset:55296
    buffer_load_dwordx4 v29, s[16:19], s47 offen offset:1024 lds
    s_add_u32 s47, s48, 1024
    v_mfma_f32_16x16x32_bf16 v[152:155], a[24:27], v[80:83], v[152:155]
    s_add_u32 s33, s33, 120
    s_add_u32 m0, s38, 18432
    ds_read_b128 a[16:19], v24 offset:57344
    v_mfma_f32_16x16x32_bf16 v[156:159], a[28:31], v[80:83], v[156:159]
    s_lshl_b32 s33, s33, 14
    ds_read_b64_tr_b16 v[64:65], v30 offset:2048
    buffer_load_dwordx4 v28, s[16:19], s47 offen offset:0 lds
    s_add_u32 s47, s48, 1024
    v_mfma_f32_16x16x32_bf16 v[160:163], a[32:35], v[80:83], v[160:163]
    s_lshl_b32 s34, s34, 15
    s_add_u32 m0, s38, 18432
    ds_read_b64_tr_b16 v[66:67], v30 offset:2560
    v_mfma_f32_16x16x32_bf16 v[164:167], a[36:39], v[80:83], v[164:167]
    s_mul_i32 s46, s29, 1065984
    ds_read_b64_tr_b16 v[68:69], v30 offset:4096
    buffer_load_dwordx4 v29, s[16:19], s47 offen offset:1024 lds
    s_add_u32 s47, s48, 2048
    v_mfma_f32_16x16x32_bf16 v[168:171], v[84:87], a[24:27], v[168:171]
    s_lshl2_add_u32 s100, s30, s28
    s_add_u32 m0, s38, 20480
    ds_read_b64_tr_b16 v[70:71], v30 offset:4608
    v_mfma_f32_16x16x32_bf16 v[172:175], v[84:87], a[28:31], v[172:175]
    s_mul_i32 s100, s100, 32768
    ds_read_b64_tr_b16 v[72:73], v30 offset:0
    buffer_load_dwordx4 v28, s[16:19], s47 offen offset:0 lds
    v_mfma_f32_16x16x32_bf16 v[176:179], v[84:87], a[32:35], v[176:179]
    s_add_u32 s46, s46, s100
    ds_read_b64_tr_b16 v[74:75], v30 offset:512
    v_mfma_f32_16x16x32_bf16 v[180:183], v[84:87], a[36:39], v[180:183]
    s_mov_b32 s50, 1040356334
    buffer_load_dwordx4 v29, s[16:19], s47 offen offset:1024 lds
    v_bfe_u32 v14, v1, 1, 4
    v_lshlrev_b32 v14, 13, v14
    v_and_b32 v15, 1, v1
    v_lshl_add_u32 v14, v15, 7, v14
    s_lshl2_add_u32 s100, s30, s28
    s_lshl_b32 s100, s100, 17
    s_add_u32 s100, s100, s37
    v_add_u32 v14, s100, v14
    global_load_dword v3, v14, s[68:69]
    s_waitcnt lgkmcnt(4)
    v_mfma_f32_16x16x32_bf16 v[128:131], v[64:67], a[0:3], v[128:131]
    s_bfe_u32 s45, s1, 196632
    s_lshl_b32 s45, s45, 7
    v_mfma_f32_16x16x32_bf16 v[132:135], v[64:67], a[4:7], v[132:135]
    s_waitcnt lgkmcnt(0)
    s_add_u32 s49, s40, s45
    v_mfma_f32_16x16x32_bf16 v[136:139], v[64:67], a[8:11], v[136:139]
    s_mov_b32 s51, 1052289595
    s_add_u32 m0, s43, 32768
    ds_read_b128 a[20:23], v25 offset:49152
    v_mfma_f32_16x16x32_bf16 v[140:143], v[64:67], a[12:15], v[140:143]
    s_lshl_b32 s52, s52, 11
    ds_read_b128 a[24:27], v25 offset:51200
    buffer_load_dwordx4 v10, s[4:7], s49 offen lds
    s_add_u32 s49, s41, s45
    v_mfma_f32_16x16x32_bf16 v[144:147], v[64:67], a[16:19], v[144:147]
    s_lshl_b32 s100, s53, 16
    s_add_u32 m0, s43, 33792
    ds_read_b128 a[28:31], v25 offset:53248
    v_mfma_f32_16x16x32_bf16 v[148:151], a[0:3], v[68:71], v[148:151]
    s_add_u32 s52, s52, s100
    ds_read_b128 a[32:35], v25 offset:55296
    buffer_load_dwordx4 v11, s[4:7], s49 offen lds
    s_add_u32 s49, s42, s45
    v_mfma_f32_16x16x32_bf16 v[152:155], a[4:7], v[68:71], v[152:155]
    s_lshr_b32 s100, s28, 1
    s_add_u32 m0, s43, 34816
    ds_read_b128 a[36:39], v25 offset:57344
    v_mfma_f32_16x16x32_bf16 v[156:159], a[8:11], v[68:71], v[156:159]
    s_lshl_b32 s100, s100, 10
    ds_read_b64_tr_b16 v[76:77], v31 offset:2048
    buffer_load_dwordx4 v10, s[4:7], s49 offen lds
    v_mfma_f32_16x16x32_bf16 v[160:163], a[12:15], v[68:71], v[160:163]
    s_add_u32 s52, s52, s100
    ds_read_b64_tr_b16 v[78:79], v31 offset:2560
    v_mfma_f32_16x16x32_bf16 v[164:167], a[16:19], v[68:71], v[164:167]
    s_add_u32 s52, s52, 63963136
    ds_read_b64_tr_b16 v[80:81], v31 offset:4096
    v_mfma_f32_16x16x32_bf16 v[168:171], v[72:75], a[4:7], v[168:171]
    s_and_b32 s100, s28, 1
    ds_read_b64_tr_b16 v[82:83], v31 offset:4608
    v_mfma_f32_16x16x32_bf16 v[172:175], v[72:75], a[8:11], v[172:175]
    s_lshl_b32 s100, s100, 3
    ds_read_b64_tr_b16 v[84:85], v31 offset:0
    v_mfma_f32_16x16x32_bf16 v[176:179], v[72:75], a[12:15], v[176:179]
    ds_read_b64_tr_b16 v[86:87], v31 offset:512
    v_add_u32 v26, s100, v2
    v_mfma_f32_16x16x32_bf16 v[180:183], v[72:75], a[16:19], v[180:183]
    s_waitcnt lgkmcnt(4)
    v_mfma_f32_16x16x32_bf16 v[128:131], v[76:79], a[20:23], v[128:131]
    s_bfe_u32 s35, s1, 196632
    s_lshl_b32 s35, s35, 7
    s_mul_i32 s48, s35, 1536
    s_add_u32 s48, s48, s44
    v_mfma_f32_16x16x32_bf16 v[132:135], v[76:79], a[24:27], v[132:135]
    s_waitcnt vmcnt(14) lgkmcnt(0)
    s_barrier
    s_add_u32 s47, s48, 0
    v_mfma_f32_16x16x32_bf16 v[136:139], v[76:79], a[28:31], v[136:139]
    s_add_u32 m0, s38, 0
    ds_read_b128 a[0:3], v24 offset:0
    v_mfma_f32_16x16x32_bf16 v[140:143], v[76:79], a[32:35], v[140:143]
    ds_read_b128 a[4:7], v24 offset:2048
    buffer_load_dwordx4 v28, s[16:19], s47 offen offset:0 lds
    v_mfma_f32_16x16x32_bf16 v[144:147], v[76:79], a[36:39], v[144:147]
    ds_read_b128 a[8:11], v24 offset:4096
    v_mfma_f32_16x16x32_bf16 v[148:151], a[20:23], v[80:83], v[148:151]
    ds_read_b128 a[12:15], v24 offset:6144
    buffer_load_dwordx4 v29, s[16:19], s47 offen offset:1024 lds
    s_add_u32 s47, s48, 1024
    v_mfma_f32_16x16x32_bf16 v[152:155], a[24:27], v[80:83], v[152:155]
    s_add_u32 m0, s38, 2048
    ds_read_b128 a[16:19], v24 offset:8192
    v_mfma_f32_16x16x32_bf16 v[156:159], a[28:31], v[80:83], v[156:159]
    ds_read_b64_tr_b16 v[64:65], v30 offset:10240
    buffer_load_dwordx4 v28, s[16:19], s47 offen offset:0 lds
    s_add_u32 s47, s48, 1024
    v_mfma_f32_16x16x32_bf16 v[160:163], a[32:35], v[80:83], v[160:163]
    s_add_u32 m0, s38, 2048
    ds_read_b64_tr_b16 v[66:67], v30 offset:10752
    v_mfma_f32_16x16x32_bf16 v[164:167], a[36:39], v[80:83], v[164:167]
    ds_read_b64_tr_b16 v[68:69], v30 offset:12288
    buffer_load_dwordx4 v29, s[16:19], s47 offen offset:1024 lds
    s_add_u32 s47, s48, 2048
    v_mfma_f32_16x16x32_bf16 v[168:171], v[84:87], a[24:27], v[168:171]
    s_add_u32 m0, s38, 4096
    ds_read_b64_tr_b16 v[70:71], v30 offset:12800
    v_mfma_f32_16x16x32_bf16 v[172:175], v[84:87], a[28:31], v[172:175]
    ds_read_b64_tr_b16 v[72:73], v30 offset:8192
    buffer_load_dwordx4 v28, s[16:19], s47 offen offset:0 lds
    v_mfma_f32_16x16x32_bf16 v[176:179], v[84:87], a[32:35], v[176:179]
    ds_read_b64_tr_b16 v[74:75], v30 offset:8704
    v_mfma_f32_16x16x32_bf16 v[180:183], v[84:87], a[36:39], v[180:183]
    buffer_load_dwordx4 v29, s[16:19], s47 offen offset:1024 lds
    s_waitcnt lgkmcnt(4)
    v_mfma_f32_16x16x32_bf16 v[128:131], v[64:67], a[0:3], v[128:131]
    s_bfe_u32 s45, s1, 196636
    s_lshl_b32 s45, s45, 7
    v_mfma_f32_16x16x32_bf16 v[132:135], v[64:67], a[4:7], v[132:135]
    s_waitcnt lgkmcnt(0)
    s_add_u32 s49, s40, s45
    v_mfma_f32_16x16x32_bf16 v[136:139], v[64:67], a[8:11], v[136:139]
    s_add_u32 m0, s43, 49152
    ds_read_b128 a[20:23], v25 offset:0
    v_mfma_f32_16x16x32_bf16 v[140:143], v[64:67], a[12:15], v[140:143]
    ds_read_b128 a[24:27], v25 offset:2048
    buffer_load_dwordx4 v10, s[4:7], s49 offen lds
    s_add_u32 s49, s41, s45
    v_mfma_f32_16x16x32_bf16 v[144:147], v[64:67], a[16:19], v[144:147]
    s_add_u32 m0, s43, 50176
    ds_read_b128 a[28:31], v25 offset:4096
    v_mfma_f32_16x16x32_bf16 v[148:151], a[0:3], v[68:71], v[148:151]
    ds_read_b128 a[32:35], v25 offset:6144
    buffer_load_dwordx4 v11, s[4:7], s49 offen lds
    s_add_u32 s49, s42, s45
    v_mfma_f32_16x16x32_bf16 v[152:155], a[4:7], v[68:71], v[152:155]
    s_add_u32 m0, s43, 51200
    ds_read_b128 a[36:39], v25 offset:8192
    v_mfma_f32_16x16x32_bf16 v[156:159], a[8:11], v[68:71], v[156:159]
    ds_read_b64_tr_b16 v[76:77], v31 offset:10240
    buffer_load_dwordx4 v10, s[4:7], s49 offen lds
    v_mfma_f32_16x16x32_bf16 v[160:163], a[12:15], v[68:71], v[160:163]
    ds_read_b64_tr_b16 v[78:79], v31 offset:10752
    v_mfma_f32_16x16x32_bf16 v[164:167], a[16:19], v[68:71], v[164:167]
    ds_read_b64_tr_b16 v[80:81], v31 offset:12288
    v_mfma_f32_16x16x32_bf16 v[168:171], v[72:75], a[4:7], v[168:171]
    ds_read_b64_tr_b16 v[82:83], v31 offset:12800
    v_mfma_f32_16x16x32_bf16 v[172:175], v[72:75], a[8:11], v[172:175]
    ds_read_b64_tr_b16 v[84:85], v31 offset:8192
    v_mfma_f32_16x16x32_bf16 v[176:179], v[72:75], a[12:15], v[176:179]
    ds_read_b64_tr_b16 v[86:87], v31 offset:8704
    v_mfma_f32_16x16x32_bf16 v[180:183], v[72:75], a[16:19], v[180:183]
    s_waitcnt lgkmcnt(4)
    v_mfma_f32_16x16x32_bf16 v[128:131], v[76:79], a[20:23], v[128:131]
    s_bfe_u32 s35, s1, 196636
    s_lshl_b32 s35, s35, 7
    s_mul_i32 s48, s35, 1536
    s_add_u32 s48, s48, s44
    v_mfma_f32_16x16x32_bf16 v[132:135], v[76:79], a[24:27], v[132:135]
    s_waitcnt vmcnt(13) lgkmcnt(0)
    s_barrier
    s_add_u32 s47, s48, 0
    v_mfma_f32_16x16x32_bf16 v[136:139], v[76:79], a[28:31], v[136:139]
    s_add_u32 m0, s38, 8192
    ds_read_b128 a[0:3], v24 offset:16384
    v_mfma_f32_16x16x32_bf16 v[140:143], v[76:79], a[32:35], v[140:143]
    ds_read_b128 a[4:7], v24 offset:18432
    buffer_load_dwordx4 v28, s[16:19], s47 offen offset:0 lds
    v_mfma_f32_16x16x32_bf16 v[144:147], v[76:79], a[36:39], v[144:147]
    ds_read_b128 a[8:11], v24 offset:20480
    v_mfma_f32_16x16x32_bf16 v[148:151], a[20:23], v[80:83], v[148:151]
    ds_read_b128 a[12:15], v24 offset:22528
    buffer_load_dwordx4 v29, s[16:19], s47 offen offset:1024 lds
    s_add_u32 s47, s48, 1024
    v_mfma_f32_16x16x32_bf16 v[152:155], a[24:27], v[80:83], v[152:155]
    s_add_u32 m0, s38, 10240
    ds_read_b128 a[16:19], v24 offset:24576
    v_mfma_f32_16x16x32_bf16 v[156:159], a[28:31], v[80:83], v[156:159]
    ds_read_b64_tr_b16 v[64:65], v30 offset:18432
    buffer_load_dwordx4 v28, s[16:19], s47 offen offset:0 lds
    s_add_u32 s47, s48, 1024
    v_mfma_f32_16x16x32_bf16 v[160:163], a[32:35], v[80:83], v[160:163]
    s_add_u32 m0, s38, 10240
    ds_read_b64_tr_b16 v[66:67], v30 offset:18944
    v_mfma_f32_16x16x32_bf16 v[164:167], a[36:39], v[80:83], v[164:167]
    ds_read_b64_tr_b16 v[68:69], v30 offset:20480
    buffer_load_dwordx4 v29, s[16:19], s47 offen offset:1024 lds
    s_add_u32 s47, s48, 2048
    v_mfma_f32_16x16x32_bf16 v[168:171], v[84:87], a[24:27], v[168:171]
    s_add_u32 m0, s38, 12288
    ds_read_b64_tr_b16 v[70:71], v30 offset:20992
    v_mfma_f32_16x16x32_bf16 v[172:175], v[84:87], a[28:31], v[172:175]
    ds_read_b64_tr_b16 v[72:73], v30 offset:16384
    buffer_load_dwordx4 v28, s[16:19], s47 offen offset:0 lds
    v_mfma_f32_16x16x32_bf16 v[176:179], v[84:87], a[32:35], v[176:179]
    ds_read_b64_tr_b16 v[74:75], v30 offset:16896
    v_mfma_f32_16x16x32_bf16 v[180:183], v[84:87], a[36:39], v[180:183]
    buffer_load_dwordx4 v29, s[16:19], s47 offen offset:1024 lds
    s_waitcnt lgkmcnt(4)
    v_mfma_f32_16x16x32_bf16 v[128:131], v[64:67], a[0:3], v[128:131]
    s_mov_b32 s45, 0
    s_lshl_b32 s36, s45, 12
    v_mfma_f32_16x16x32_bf16 v[132:135], v[64:67], a[4:7], v[132:135]
    s_waitcnt lgkmcnt(0)
    s_add_u32 s36, s36, s37
    v_mfma_f32_16x16x32_bf16 v[136:139], v[64:67], a[8:11], v[136:139]
    s_add_u32 m0, s39, 0
    ds_read_b128 a[20:23], v25 offset:16384
    v_mfma_f32_16x16x32_bf16 v[140:143], v[64:67], a[12:15], v[140:143]
    ds_read_b128 a[24:27], v25 offset:18432
    buffer_load_dwordx4 v8, s[12:15], s36 offen lds
    v_mfma_f32_16x16x32_bf16 v[144:147], v[64:67], a[16:19], v[144:147]
    ds_read_b128 a[28:31], v25 offset:20480
    v_mfma_f32_16x16x32_bf16 v[148:151], a[0:3], v[68:71], v[148:151]
    ds_read_b128 a[32:35], v25 offset:22528
    buffer_load_dwordx4 v9, s[12:15], s36 offen offset:1024 lds
    s_add_u32 s36, s36, 262144
    v_mfma_f32_16x16x32_bf16 v[152:155], a[4:7], v[68:71], v[152:155]
    s_add_u32 m0, s39, 8192
    ds_read_b128 a[36:39], v25 offset:24576
    v_mfma_f32_16x16x32_bf16 v[156:159], a[8:11], v[68:71], v[156:159]
    ds_read_b64_tr_b16 v[76:77], v31 offset:18432
    buffer_load_dwordx4 v8, s[12:15], s36 offen lds
    v_mfma_f32_16x16x32_bf16 v[160:163], a[12:15], v[68:71], v[160:163]
    ds_read_b64_tr_b16 v[78:79], v31 offset:18944
    v_mfma_f32_16x16x32_bf16 v[164:167], a[16:19], v[68:71], v[164:167]
    ds_read_b64_tr_b16 v[80:81], v31 offset:20480
    buffer_load_dwordx4 v9, s[12:15], s36 offen offset:1024 lds
    v_mfma_f32_16x16x32_bf16 v[168:171], v[72:75], a[4:7], v[168:171]
    ds_read_b64_tr_b16 v[82:83], v31 offset:20992
    v_mfma_f32_16x16x32_bf16 v[172:175], v[72:75], a[8:11], v[172:175]
    ds_read_b64_tr_b16 v[84:85], v31 offset:16384
    v_mfma_f32_16x16x32_bf16 v[176:179], v[72:75], a[12:15], v[176:179]
    ds_read_b64_tr_b16 v[86:87], v31 offset:16896
    v_mfma_f32_16x16x32_bf16 v[180:183], v[72:75], a[16:19], v[180:183]
    s_waitcnt lgkmcnt(4)
    v_mfma_f32_16x16x32_bf16 v[128:131], v[76:79], a[20:23], v[128:131]
    s_mov_b32 s35, 0
    v_mfma_f32_16x16x32_bf16 v[132:135], v[76:79], a[24:27], v[132:135]
    s_waitcnt vmcnt(13) lgkmcnt(0)
    s_barrier
    s_add_u32 s47, s32, s35
    v_mfma_f32_16x16x32_bf16 v[136:139], v[76:79], a[28:31], v[136:139]
    s_add_u32 m0, s38, 16384
    ds_read_b128 a[0:3], v24 offset:32768
    v_mfma_f32_16x16x32_bf16 v[140:143], v[76:79], a[32:35], v[140:143]
    ds_read_b128 a[4:7], v24 offset:34816
    buffer_load_dwordx4 v4, s[8:11], s47 offen offset:0 lds
    v_mfma_f32_16x16x32_bf16 v[144:147], v[76:79], a[36:39], v[144:147]
    ds_read_b128 a[8:11], v24 offset:36864
    buffer_load_dwordx4 v5, s[8:11], s47 offen offset:1024 lds
    v_mfma_f32_16x16x32_bf16 v[148:151], a[20:23], v[80:83], v[148:151]
    ds_read_b128 a[12:15], v24 offset:38912
    buffer_load_dwordx4 v6, s[8:11], s47 offen offset:2048 lds
    v_mfma_f32_16x16x32_bf16 v[152:155], a[24:27], v[80:83], v[152:155]
    ds_read_b128 a[16:19], v24 offset:40960
    buffer_load_dwordx4 v7, s[8:11], s47 offen offset:3072 lds
    s_add_u32 s47, s32, s35
    v_mfma_f32_16x16x32_bf16 v[156:159], a[28:31], v[80:83], v[156:159]
    s_mov_b32 s16, s70
    s_add_u32 s47, s47, 32768
    ds_read_b64_tr_b16 v[64:65], v30 offset:2048
    v_mfma_f32_16x16x32_bf16 v[160:163], a[32:35], v[80:83], v[160:163]
    s_mov_b32 s17, s71
    s_add_u32 m0, s38, 20480
    ds_read_b64_tr_b16 v[66:67], v30 offset:2560
    v_mfma_f32_16x16x32_bf16 v[164:167], a[36:39], v[80:83], v[164:167]
    s_mov_b32 s18, 4194304
    ds_read_b64_tr_b16 v[68:69], v30 offset:4096
    buffer_load_dwordx4 v4, s[8:11], s47 offen offset:0 lds
    v_mfma_f32_16x16x32_bf16 v[168:171], v[84:87], a[24:27], v[168:171]
    ds_read_b64_tr_b16 v[70:71], v30 offset:4608
    buffer_load_dwordx4 v5, s[8:11], s47 offen offset:1024 lds
    v_mfma_f32_16x16x32_bf16 v[172:175], v[84:87], a[28:31], v[172:175]
    ds_read_b64_tr_b16 v[72:73], v30 offset:0
    buffer_load_dwordx4 v6, s[8:11], s47 offen offset:2048 lds
    v_mfma_f32_16x16x32_bf16 v[176:179], v[84:87], a[32:35], v[176:179]
    ds_read_b64_tr_b16 v[74:75], v30 offset:512
    buffer_load_dwordx4 v7, s[8:11], s47 offen offset:3072 lds
    v_mfma_f32_16x16x32_bf16 v[180:183], v[84:87], a[36:39], v[180:183]
    s_waitcnt lgkmcnt(4)
    v_mfma_f32_16x16x32_bf16 v[128:131], v[64:67], a[0:3], v[128:131]
    s_mov_b32 s45, 128
    s_lshl_b32 s36, s45, 12
    v_mfma_f32_16x16x32_bf16 v[132:135], v[64:67], a[4:7], v[132:135]
    s_waitcnt lgkmcnt(0)
    s_add_u32 s36, s36, s37
    v_mfma_f32_16x16x32_bf16 v[136:139], v[64:67], a[8:11], v[136:139]
    s_add_u32 m0, s39, 16384
    ds_read_b128 a[20:23], v25 offset:32768
    v_mfma_f32_16x16x32_bf16 v[140:143], v[64:67], a[12:15], v[140:143]
    ds_read_b128 a[24:27], v25 offset:34816
    buffer_load_dwordx4 v8, s[12:15], s36 offen lds
    v_mfma_f32_16x16x32_bf16 v[144:147], v[64:67], a[16:19], v[144:147]
    ds_read_b128 a[28:31], v25 offset:36864
    v_mfma_f32_16x16x32_bf16 v[148:151], a[0:3], v[68:71], v[148:151]
    ds_read_b128 a[32:35], v25 offset:38912
    buffer_load_dwordx4 v9, s[12:15], s36 offen offset:1024 lds
    s_add_u32 s36, s36, 262144
    v_mfma_f32_16x16x32_bf16 v[152:155], a[4:7], v[68:71], v[152:155]
    s_add_u32 m0, s39, 24576
    ds_read_b128 a[36:39], v25 offset:40960
    v_mfma_f32_16x16x32_bf16 v[156:159], a[8:11], v[68:71], v[156:159]
    ds_read_b64_tr_b16 v[76:77], v31 offset:2048
    buffer_load_dwordx4 v8, s[12:15], s36 offen lds
    v_mfma_f32_16x16x32_bf16 v[160:163], a[12:15], v[68:71], v[160:163]
    ds_read_b64_tr_b16 v[78:79], v31 offset:2560
    v_mfma_f32_16x16x32_bf16 v[164:167], a[16:19], v[68:71], v[164:167]
    ds_read_b64_tr_b16 v[80:81], v31 offset:4096
    buffer_load_dwordx4 v9, s[12:15], s36 offen offset:1024 lds
    v_mfma_f32_16x16x32_bf16 v[168:171], v[72:75], a[4:7], v[168:171]
    s_mov_b32 s4, s62
    ds_read_b64_tr_b16 v[82:83], v31 offset:4608
    v_mfma_f32_16x16x32_bf16 v[172:175], v[72:75], a[8:11], v[172:175]
    s_mov_b32 s5, s63
    ds_read_b64_tr_b16 v[84:85], v31 offset:0
    v_mfma_f32_16x16x32_bf16 v[176:179], v[72:75], a[12:15], v[176:179]
    ds_read_b64_tr_b16 v[86:87], v31 offset:512
    v_mfma_f32_16x16x32_bf16 v[180:183], v[72:75], a[16:19], v[180:183]
    s_waitcnt lgkmcnt(4)
    v_mfma_f32_16x16x32_bf16 v[128:131], v[76:79], a[20:23], v[128:131]
    s_mov_b32 s35, 128
    v_mfma_f32_16x16x32_bf16 v[132:135], v[76:79], a[24:27], v[132:135]
    s_waitcnt vmcnt(16) lgkmcnt(0)
    s_barrier
    s_add_u32 s47, s32, s35
    v_mfma_f32_16x16x32_bf16 v[136:139], v[76:79], a[28:31], v[136:139]
    s_add_u32 m0, s38, 0
    ds_read_b128 a[0:3], v24 offset:49152
    v_mfma_f32_16x16x32_bf16 v[140:143], v[76:79], a[32:35], v[140:143]
    ds_read_b128 a[4:7], v24 offset:51200
    buffer_load_dwordx4 v4, s[8:11], s47 offen offset:0 lds
    v_mfma_f32_16x16x32_bf16 v[144:147], v[76:79], a[36:39], v[144:147]
    ds_read_b128 a[8:11], v24 offset:53248
    buffer_load_dwordx4 v5, s[8:11], s47 offen offset:1024 lds
    v_mfma_f32_16x16x32_bf16 v[148:151], a[20:23], v[80:83], v[148:151]
    ds_read_b128 a[12:15], v24 offset:55296
    buffer_load_dwordx4 v6, s[8:11], s47 offen offset:2048 lds
    v_mfma_f32_16x16x32_bf16 v[152:155], a[24:27], v[80:83], v[152:155]
    ds_read_b128 a[16:19], v24 offset:57344
    buffer_load_dwordx4 v7, s[8:11], s47 offen offset:3072 lds
    s_add_u32 s47, s32, s35
    v_mfma_f32_16x16x32_bf16 v[156:159], a[28:31], v[80:83], v[156:159]
    s_add_u32 s47, s47, 32768
    ds_read_b64_tr_b16 v[64:65], v30 offset:10240
    v_mfma_f32_16x16x32_bf16 v[160:163], a[32:35], v[80:83], v[160:163]
    s_add_u32 m0, s38, 4096
    ds_read_b64_tr_b16 v[66:67], v30 offset:10752
    v_mfma_f32_16x16x32_bf16 v[164:167], a[36:39], v[80:83], v[164:167]
    ds_read_b64_tr_b16 v[68:69], v30 offset:12288
    buffer_load_dwordx4 v4, s[8:11], s47 offen offset:0 lds
    v_mfma_f32_16x16x32_bf16 v[168:171], v[84:87], a[24:27], v[168:171]
    ds_read_b64_tr_b16 v[70:71], v30 offset:12800
    buffer_load_dwordx4 v5, s[8:11], s47 offen offset:1024 lds
    v_mfma_f32_16x16x32_bf16 v[172:175], v[84:87], a[28:31], v[172:175]
    ds_read_b64_tr_b16 v[72:73], v30 offset:8192
    buffer_load_dwordx4 v6, s[8:11], s47 offen offset:2048 lds
    v_mfma_f32_16x16x32_bf16 v[176:179], v[84:87], a[32:35], v[176:179]
    ds_read_b64_tr_b16 v[74:75], v30 offset:8704
    buffer_load_dwordx4 v7, s[8:11], s47 offen offset:3072 lds
    v_mfma_f32_16x16x32_bf16 v[180:183], v[84:87], a[36:39], v[180:183]
    s_waitcnt lgkmcnt(4)
    v_mfma_f32_16x16x32_bf16 v[128:131], v[64:67], a[0:3], v[128:131]
    s_bfe_u32 s45, s1, 196616
    s_lshl_b32 s45, s45, 7
    s_lshl_b32 s36, s45, 12
    v_mfma_f32_16x16x32_bf16 v[132:135], v[64:67], a[4:7], v[132:135]
    s_waitcnt lgkmcnt(0)
    s_add_u32 s36, s36, s37
    v_mfma_f32_16x16x32_bf16 v[136:139], v[64:67], a[8:11], v[136:139]
    s_add_u32 m0, s39, 32768
    ds_read_b128 a[20:23], v25 offset:49152
    v_mfma_f32_16x16x32_bf16 v[140:143], v[64:67], a[12:15], v[140:143]
    ds_read_b128 a[24:27], v25 offset:51200
    buffer_load_dwordx4 v8, s[12:15], s36 offen lds
    v_mfma_f32_16x16x32_bf16 v[144:147], v[64:67], a[16:19], v[144:147]
    ds_read_b128 a[28:31], v25 offset:53248
    v_mfma_f32_16x16x32_bf16 v[148:151], a[0:3], v[68:71], v[148:151]
    ds_read_b128 a[32:35], v25 offset:55296
    buffer_load_dwordx4 v9, s[12:15], s36 offen offset:1024 lds
    s_add_u32 s36, s36, 262144
    v_mfma_f32_16x16x32_bf16 v[152:155], a[4:7], v[68:71], v[152:155]
    s_add_u32 m0, s39, 40960
    ds_read_b128 a[36:39], v25 offset:57344
    v_mfma_f32_16x16x32_bf16 v[156:159], a[8:11], v[68:71], v[156:159]
    ds_read_b64_tr_b16 v[76:77], v31 offset:10240
    buffer_load_dwordx4 v8, s[12:15], s36 offen lds
    v_mfma_f32_16x16x32_bf16 v[160:163], a[12:15], v[68:71], v[160:163]
    ds_read_b64_tr_b16 v[78:79], v31 offset:10752
    v_mfma_f32_16x16x32_bf16 v[164:167], a[16:19], v[68:71], v[164:167]
    ds_read_b64_tr_b16 v[80:81], v31 offset:12288
    buffer_load_dwordx4 v9, s[12:15], s36 offen offset:1024 lds
    v_mfma_f32_16x16x32_bf16 v[168:171], v[72:75], a[4:7], v[168:171]
    ds_read_b64_tr_b16 v[82:83], v31 offset:12800
    v_mfma_f32_16x16x32_bf16 v[172:175], v[72:75], a[8:11], v[172:175]
    ds_read_b64_tr_b16 v[84:85], v31 offset:8192
    v_mfma_f32_16x16x32_bf16 v[176:179], v[72:75], a[12:15], v[176:179]
    ds_read_b64_tr_b16 v[86:87], v31 offset:8704
    v_mfma_f32_16x16x32_bf16 v[180:183], v[72:75], a[16:19], v[180:183]
    v_mov_b32 v27, 0
    buffer_load_dword v0, v27, s[24:27], 0 offen sc1
    s_waitcnt lgkmcnt(4)
    v_mfma_f32_16x16x32_bf16 v[128:131], v[76:79], a[20:23], v[128:131]
    s_bfe_u32 s35, s1, 196616
    s_lshl_b32 s35, s35, 7
    v_mfma_f32_16x16x32_bf16 v[132:135], v[76:79], a[24:27], v[132:135]
    s_waitcnt vmcnt(17) lgkmcnt(0)
    s_barrier
    s_add_u32 s47, s32, s35
    v_mfma_f32_16x16x32_bf16 v[136:139], v[76:79], a[28:31], v[136:139]
    s_add_u32 m0, s38, 8192
    ds_read_b128 a[0:3], v12 offset:16384
    ds_read_b128 a[4:7], v12 offset:18432
    v_mfma_f32_16x16x32_bf16 v[140:143], v[76:79], a[32:35], v[140:143]
    ds_read_b128 a[8:11], v12 offset:20480
    ds_read_b128 a[12:15], v12 offset:22528
    buffer_load_dwordx4 v4, s[8:11], s47 offen offset:0 lds
    v_mfma_f32_16x16x32_bf16 v[144:147], v[76:79], a[36:39], v[144:147]
    ds_read_b64_tr_b16 v[32:33], v16 offset:0
    buffer_load_dwordx4 v5, s[8:11], s47 offen offset:1024 lds
    v_mfma_f32_16x16x32_bf16 v[148:151], a[20:23], v[80:83], v[148:151]
    ds_read_b64_tr_b16 v[34:35], v16 offset:1024
    ds_read_b64_tr_b16 v[36:37], v17 offset:0
    buffer_load_dwordx4 v6, s[8:11], s47 offen offset:2048 lds
    v_mfma_f32_16x16x32_bf16 v[152:155], a[24:27], v[80:83], v[152:155]
    ds_read_b64_tr_b16 v[38:39], v17 offset:1024
    ds_read_b64_tr_b16 v[40:41], v18 offset:0
    buffer_load_dwordx4 v7, s[8:11], s47 offen offset:3072 lds
    s_add_u32 s47, s32, s35
    v_mfma_f32_16x16x32_bf16 v[156:159], a[28:31], v[80:83], v[156:159]
    s_add_u32 s47, s47, 32768
    ds_read_b64_tr_b16 v[42:43], v18 offset:1024
    v_mfma_f32_16x16x32_bf16 v[160:163], a[32:35], v[80:83], v[160:163]
    s_add_u32 m0, s38, 12288
    ds_read_b64_tr_b16 v[44:45], v19 offset:0
    ds_read_b64_tr_b16 v[46:47], v19 offset:1024
    v_mfma_f32_16x16x32_bf16 v[164:167], a[36:39], v[80:83], v[164:167]
    ds_read_b64_tr_b16 v[48:49], v20 offset:0
    ds_read_b64_tr_b16 v[50:51], v20 offset:1024
    buffer_load_dwordx4 v4, s[8:11], s47 offen offset:0 lds
    v_mfma_f32_16x16x32_bf16 v[168:171], v[84:87], a[24:27], v[168:171]
    ds_read_b64_tr_b16 v[52:53], v21 offset:0
    buffer_load_dwordx4 v5, s[8:11], s47 offen offset:1024 lds
    v_mfma_f32_16x16x32_bf16 v[172:175], v[84:87], a[28:31], v[172:175]
    ds_read_b64_tr_b16 v[54:55], v21 offset:1024
    ds_read_b64_tr_b16 v[56:57], v22 offset:0
    buffer_load_dwordx4 v6, s[8:11], s47 offen offset:2048 lds
    v_mfma_f32_16x16x32_bf16 v[176:179], v[84:87], a[32:35], v[176:179]
    ds_read_b64_tr_b16 v[58:59], v22 offset:1024
    ds_read_b64_tr_b16 v[60:61], v23 offset:0
    buffer_load_dwordx4 v7, s[8:11], s47 offen offset:3072 lds
    v_mfma_f32_16x16x32_bf16 v[180:183], v[84:87], a[36:39], v[180:183]
    ds_read_b64_tr_b16 v[62:63], v23 offset:1024
    s_waitcnt lgkmcnt(12)
    v_cvt_pk_bf16_f32 v96, v128, v129
    v_cvt_pk_bf16_f32 v97, v130, v131
    v_cvt_pk_bf16_f32 v98, v132, v133
    v_cvt_pk_bf16_f32 v99, v134, v135
    v_cvt_pk_bf16_f32 v100, v136, v137
    v_cvt_pk_bf16_f32 v101, v138, v139
    v_mfma_f32_16x16x32_bf16 v[128:131], v[32:35], a[0:3], 0
    ds_read_b128 a[16:19], v13 offset:16384
    v_cvt_pk_bf16_f32 v102, v140, v141
    v_cvt_pk_bf16_f32 v103, v142, v143
    v_mfma_f32_16x16x32_bf16 v[132:135], v[32:35], a[4:7], 0
    s_bfe_u32 s45, s1, 196620
    ds_read_b128 a[20:23], v13 offset:18432
    v_cvt_pk_bf16_f32 v104, v144, v145
    v_cvt_pk_bf16_f32 v105, v146, v147
    v_mfma_f32_16x16x32_bf16 v[136:139], v[32:35], a[8:11], 0
    s_lshl_b32 s45, s45, 7
    ds_read_b128 a[24:27], v13 offset:20480
    v_cvt_pk_bf16_f32 v106, v148, v149
    v_cvt_pk_bf16_f32 v107, v150, v151
    v_mfma_f32_16x16x32_bf16 v[140:143], v[32:35], a[12:15], 0
    s_lshl_b32 s36, s45, 12
    ds_read_b128 a[28:31], v13 offset:22528
    v_cvt_pk_bf16_f32 v108, v152, v153
    v_cvt_pk_bf16_f32 v109, v154, v155
    v_mfma_f32_16x16x32_bf16 v[144:147], v[36:39], a[0:3], 0
    s_add_u32 s36, s36, s37
    ds_read_b64_tr_b16 v[64:65], v16 offset:8192
    v_cvt_pk_bf16_f32 v110, v156, v157
    v_cvt_pk_bf16_f32 v111, v158, v159
    v_mfma_f32_16x16x32_bf16 v[148:151], v[36:39], a[4:7], 0
    s_add_u32 m0, s39, 49152
    ds_read_b64_tr_b16 v[66:67], v16 offset:9216
    v_cvt_pk_bf16_f32 v112, v160, v161
    v_cvt_pk_bf16_f32 v113, v162, v163
    v_mfma_f32_16x16x32_bf16 v[152:155], v[36:39], a[8:11], 0
    buffer_load_dwordx4 v8, s[12:15], s36 offen lds
    v_cvt_pk_bf16_f32 v114, v164, v165
    v_cvt_pk_bf16_f32 v115, v166, v167
    v_mfma_f32_16x16x32_bf16 v[156:159], v[36:39], a[12:15], 0
    s_waitcnt lgkmcnt(6)
    ds_read_b64_tr_b16 v[68:69], v17 offset:8192
    v_cvt_pk_bf16_f32 v116, v168, v169
    v_cvt_pk_bf16_f32 v117, v170, v171
    v_mfma_f32_16x16x32_bf16 v[160:163], v[40:43], a[0:3], 0
    ds_read_b64_tr_b16 v[70:71], v17 offset:9216
    v_cvt_pk_bf16_f32 v118, v172, v173
    v_cvt_pk_bf16_f32 v119, v174, v175
    v_mfma_f32_16x16x32_bf16 v[164:167], v[40:43], a[4:7], 0
    ds_read_b64_tr_b16 v[72:73], v18 offset:8192
    v_cvt_pk_bf16_f32 v120, v176, v177
    v_cvt_pk_bf16_f32 v121, v178, v179
    v_mfma_f32_16x16x32_bf16 v[168:171], v[40:43], a[8:11], 0
    buffer_load_dwordx4 v9, s[12:15], s36 offen offset:1024 lds
    v_cvt_pk_bf16_f32 v122, v180, v181
    v_cvt_pk_bf16_f32 v123, v182, v183
    v_mfma_f32_16x16x32_bf16 v[172:175], v[40:43], a[12:15], 0
    ds_read_b64_tr_b16 v[74:75], v18 offset:9216
    v_mfma_f32_16x16x32_bf16 v[176:179], v[44:47], a[0:3], 0
    s_add_u32 s36, s36, 262144
    ds_read_b64_tr_b16 v[76:77], v19 offset:8192
    v_accvgpr_write_b32 a228, v96
    v_mfma_f32_16x16x32_bf16 v[180:183], v[44:47], a[4:7], 0
    s_add_u32 m0, s39, 57344
    ds_read_b64_tr_b16 v[78:79], v19 offset:9216
    v_accvgpr_write_b32 a229, v97
    v_mfma_f32_16x16x32_bf16 v[184:187], v[44:47], a[8:11], 0
    buffer_load_dwordx4 v8, s[12:15], s36 offen lds
    v_accvgpr_write_b32 a230, v98
    v_mfma_f32_16x16x32_bf16 v[188:191], v[44:47], a[12:15], 0
    ds_read_b64_tr_b16 v[80:81], v20 offset:8192
    v_accvgpr_write_b32 a231, v99
    v_mfma_f32_16x16x32_bf16 v[192:195], v[48:51], a[0:3], 0
    ds_read_b64_tr_b16 v[82:83], v20 offset:9216
    v_accvgpr_write_b32 a232, v100
    v_mfma_f32_16x16x32_bf16 v[196:199], v[48:51], a[4:7], 0
    ds_read_b64_tr_b16 v[84:85], v21 offset:8192
    v_accvgpr_write_b32 a233, v101
    v_mfma_f32_16x16x32_bf16 v[200:203], v[48:51], a[8:11], 0
    buffer_load_dwordx4 v9, s[12:15], s36 offen offset:1024 lds
    v_accvgpr_write_b32 a234, v102
    v_mfma_f32_16x16x32_bf16 v[204:207], v[48:51], a[12:15], 0
    ds_read_b64_tr_b16 v[86:87], v21 offset:9216
    v_accvgpr_write_b32 a235, v103
    v_mfma_f32_16x16x32_bf16 v[208:211], v[52:55], a[0:3], 0
    ds_read_b64_tr_b16 v[88:89], v22 offset:8192
    v_accvgpr_write_b32 a236, v104
    v_mfma_f32_16x16x32_bf16 v[212:215], v[52:55], a[4:7], 0
    ds_read_b64_tr_b16 v[90:91], v22 offset:9216
    v_accvgpr_write_b32 a237, v105
    v_mfma_f32_16x16x32_bf16 v[216:219], v[52:55], a[8:11], 0
    ds_read_b64_tr_b16 v[92:93], v23 offset:8192
    v_accvgpr_write_b32 a238, v106
    v_mfma_f32_16x16x32_bf16 v[220:223], v[52:55], a[12:15], 0
    ds_read_b64_tr_b16 v[94:95], v23 offset:9216
    v_accvgpr_write_b32 a239, v107
    v_mfma_f32_16x16x32_bf16 v[224:227], v[56:59], a[0:3], 0
    v_accvgpr_write_b32 a240, v108
    v_accvgpr_write_b32 a241, v109
    v_mfma_f32_16x16x32_bf16 v[228:231], v[56:59], a[4:7], 0
    v_accvgpr_write_b32 a242, v110
    v_accvgpr_write_b32 a243, v111
    v_mfma_f32_16x16x32_bf16 v[232:235], v[56:59], a[8:11], 0
    v_accvgpr_write_b32 a244, v112
    v_accvgpr_write_b32 a245, v113
    v_mfma_f32_16x16x32_bf16 v[236:239], v[56:59], a[12:15], 0
    v_accvgpr_write_b32 a246, v114
    v_accvgpr_write_b32 a247, v115
    v_mfma_f32_16x16x32_bf16 v[240:243], v[60:63], a[0:3], 0
    v_accvgpr_write_b32 a248, v116
    v_accvgpr_write_b32 a249, v117
    v_mfma_f32_16x16x32_bf16 v[244:247], v[60:63], a[4:7], 0
    v_accvgpr_write_b32 a250, v118
    v_accvgpr_write_b32 a251, v119
    v_mfma_f32_16x16x32_bf16 v[248:251], v[60:63], a[8:11], 0
    v_accvgpr_write_b32 a252, v120
    v_accvgpr_write_b32 a253, v121
    v_mfma_f32_16x16x32_bf16 v[252:255], v[60:63], a[12:15], 0
    v_accvgpr_write_b32 a254, v122
    v_accvgpr_write_b32 a255, v123
    s_waitcnt lgkmcnt(12)
    v_mfma_f32_16x16x32_bf16 v[128:131], v[64:67], a[16:19], v[128:131]
    v_lshrrev_b32 v125, 4, v1
    v_bfe_u32 v126, v1, 2, 2
    v_mfma_f32_16x16x32_bf16 v[132:135], v[64:67], a[20:23], v[132:135]
    v_lshl_add_u32 v127, v125, 3, v126
    v_lshlrev_b32 v127, 7, v127
    v_mfma_f32_16x16x32_bf16 v[136:139], v[64:67], a[24:27], v[136:139]
    s_bfe_u32 s35, s1, 196620
    v_and_b32 v124, 3, v1
    v_lshl_add_u32 v127, v124, 3, v127
    v_mfma_f32_16x16x32_bf16 v[140:143], v[64:67], a[28:31], v[140:143]
    s_waitcnt vmcnt(17) lgkmcnt(0)
    s_barrier
    s_lshl_b32 s35, s35, 7
    v_and_b32 v125, 1, v125
    v_lshrrev_b32 v126, 1, v126
    v_mfma_f32_16x16x32_bf16 v[144:147], v[68:71], a[16:19], v[144:147]
    s_add_u32 s47, s32, s35
    ds_read_b128 a[32:35], v12 offset:0
    v_lshl_or_b32 v126, v125, 1, v126
    v_mfma_f32_16x16x32_bf16 v[148:151], v[68:71], a[20:23], v[148:151]
    s_add_u32 m0, s38, 16384
    ds_read_b128 a[36:39], v12 offset:2048
    v_lshl_add_u32 v28, v126, 5, v127
    v_mfma_f32_16x16x32_bf16 v[152:155], v[68:71], a[24:27], v[152:155]
    buffer_load_dwordx4 v4, s[8:11], s47 offen offset:0 lds
    v_xor_b32 v29, 32, v28
    v_mfma_f32_16x16x32_bf16 v[156:159], v[68:71], a[28:31], v[156:159]
    ds_read_b128 a[40:43], v12 offset:4096
    v_xor_b32 v30, 64, v28
    v_mfma_f32_16x16x32_bf16 v[160:163], v[72:75], a[16:19], v[160:163]
    ds_read_b128 a[44:47], v12 offset:6144
    v_xor_b32 v31, 96, v28
    v_mfma_f32_16x16x32_bf16 v[164:167], v[72:75], a[20:23], v[164:167]
    buffer_load_dwordx4 v5, s[8:11], s47 offen offset:1024 lds
    v_lshrrev_b32 v126, 3, v1
    v_mfma_f32_16x16x32_bf16 v[168:171], v[72:75], a[24:27], v[168:171]
    ds_read_b64_tr_b16 v[32:33], v16 offset:16384
    v_and_b32 v127, 2, v126
    v_mfma_f32_16x16x32_bf16 v[172:175], v[72:75], a[28:31], v[172:175]
    ds_read_b64_tr_b16 v[34:35], v16 offset:17408
    v_and_b32 v124, 7, v1
    v_mfma_f32_16x16x32_bf16 v[176:179], v[76:79], a[16:19], v[176:179]
    buffer_load_dwordx4 v6, s[8:11], s47 offen offset:2048 lds
    v_xor_b32 v127, v127, v124
    v_mfma_f32_16x16x32_bf16 v[180:183], v[76:79], a[20:23], v[180:183]
    ds_read_b64_tr_b16 v[36:37], v17 offset:16384
    v_lshlrev_b32 v127, 4, v127
    v_mfma_f32_16x16x32_bf16 v[184:187], v[76:79], a[24:27], v[184:187]
    ds_read_b64_tr_b16 v[38:39], v17 offset:17408
    v_lshl_add_u32 v127, v126, 13, v127
    v_mfma_f32_16x16x32_bf16 v[188:191], v[76:79], a[28:31], v[188:191]
    s_lshl_b32 s100, s28, 17
    buffer_load_dwordx4 v7, s[8:11], s47 offen offset:3072 lds
    s_add_u32 s47, s32, s35
    v_add_u32 v10, s100, v127
    v_mfma_f32_16x16x32_bf16 v[192:195], v[80:83], a[16:19], v[192:195]
    s_add_u32 s47, s47, 32768
    ds_read_b64_tr_b16 v[40:41], v18 offset:16384
    v_xor_b32 v127, 64, v10
    v_mfma_f32_16x16x32_bf16 v[196:199], v[80:83], a[20:23], v[196:199]
    s_add_u32 m0, s38, 20480
    ds_read_b64_tr_b16 v[42:43], v18 offset:17408
    v_add_u32 v11, 64512, v127
    v_mfma_f32_16x16x32_bf16 v[200:203], v[80:83], a[24:27], v[200:203]
    buffer_load_dwordx4 v4, s[8:11], s47 offen offset:0 lds
    v_and_b32 v124, 15, v1
    v_mfma_f32_16x16x32_bf16 v[204:207], v[80:83], a[28:31], v[204:207]
    ds_read_b64_tr_b16 v[44:45], v19 offset:16384
    v_lshrrev_b32 v125, 4, v1
    v_mfma_f32_16x16x32_bf16 v[208:211], v[84:87], a[16:19], v[208:211]
    ds_read_b64_tr_b16 v[46:47], v19 offset:17408
    v_lshlrev_b32 v125, 2, v125
    v_mfma_f32_16x16x32_bf16 v[212:215], v[84:87], a[20:23], v[212:215]
    buffer_load_dwordx4 v5, s[8:11], s47 offen offset:1024 lds
    v_sub_u32 v124, v124, v125
    v_mfma_f32_16x16x32_bf16 v[216:219], v[84:87], a[24:27], v[216:219]
    ds_read_b64_tr_b16 v[48:49], v20 offset:16384
    v_mov_b32 v125, 0x3f803f80
    v_mfma_f32_16x16x32_bf16 v[220:223], v[84:87], a[28:31], v[220:223]
    ds_read_b64_tr_b16 v[50:51], v20 offset:17408
    v_accvgpr_write_b32 a224, v125
    v_mfma_f32_16x16x32_bf16 v[224:227], v[88:91], a[16:19], v[224:227]
    buffer_load_dwordx4 v6, s[8:11], s47 offen offset:2048 lds
    v_accvgpr_write_b32 a225, v125
    v_mfma_f32_16x16x32_bf16 v[228:231], v[88:91], a[20:23], v[228:231]
    ds_read_b64_tr_b16 v[52:53], v21 offset:16384
    v_accvgpr_write_b32 a226, v125
    v_mfma_f32_16x16x32_bf16 v[232:235], v[88:91], a[24:27], v[232:235]
    ds_read_b64_tr_b16 v[54:55], v21 offset:17408
    v_accvgpr_write_b32 a227, v125
    v_mfma_f32_16x16x32_bf16 v[236:239], v[88:91], a[28:31], v[236:239]
    buffer_load_dwordx4 v7, s[8:11], s47 offen offset:3072 lds
    v_mov_b32 v125, 0xf149f2ca
    v_mfma_f32_16x16x32_bf16 v[240:243], v[92:95], a[16:19], v[240:243]
    ds_read_b64_tr_b16 v[56:57], v22 offset:16384
    v_subrev_u32 v126, 0, v124
    v_mfma_f32_16x16x32_bf16 v[244:247], v[92:95], a[20:23], v[244:247]
    ds_read_b64_tr_b16 v[58:59], v22 offset:17408
    v_and_b32 v127, -15, v126
    v_mfma_f32_16x16x32_bf16 v[248:251], v[92:95], a[24:27], v[248:251]
    ds_read_b64_tr_b16 v[60:61], v23 offset:16384
    v_cmp_ne_u32 vcc, 0, v127
    v_mfma_f32_16x16x32_bf16 v[252:255], v[92:95], a[28:31], v[252:255]
    ds_read_b64_tr_b16 v[62:63], v23 offset:17408
    v_add_u32 v126, 16, v126
    s_waitcnt lgkmcnt(12)
    v_mfma_f32_16x16x32_bf16 v[128:131], v[32:35], a[32:35], v[128:131]
    ds_read_b128 a[48:51], v13 offset:0
    v_and_b32 v127, -15, v126
    v_mfma_f32_16x16x32_bf16 v[132:135], v[32:35], a[36:39], v[132:135]
    s_bfe_u32 s45, s1, 196624
    ds_read_b128 a[52:55], v13 offset:2048
    v_cndmask_b32 v100, 0, v125, vcc
    v_mfma_f32_16x16x32_bf16 v[136:139], v[32:35], a[40:43], v[136:139]
    s_lshl_b32 s45, s45, 7
    ds_read_b128 a[56:59], v13 offset:4096
    v_cmp_ne_u32 vcc, 0, v127
    v_mfma_f32_16x16x32_bf16 v[140:143], v[32:35], a[44:47], v[140:143]
    s_lshl_b32 s36, s45, 12
    ds_read_b128 a[60:63], v13 offset:6144
    v_mfma_f32_16x16x32_bf16 v[144:147], v[36:39], a[32:35], v[144:147]
    s_add_u32 s36, s36, s37
    ds_read_b64_tr_b16 v[64:65], v16 offset:24576
    v_cndmask_b32 v96, 0, v125, vcc
    v_mfma_f32_16x16x32_bf16 v[148:151], v[36:39], a[36:39], v[148:151]
    s_add_u32 m0, s39, 0
    ds_read_b64_tr_b16 v[66:67], v16 offset:25600
    v_subrev_u32 v126, 1, v124
    v_mfma_f32_16x16x32_bf16 v[152:155], v[36:39], a[40:43], v[152:155]
    buffer_load_dwordx4 v8, s[12:15], s36 offen lds
    v_and_b32 v127, -15, v126
    v_mfma_f32_16x16x32_bf16 v[156:159], v[36:39], a[44:47], v[156:159]
    s_waitcnt lgkmcnt(6)
    ds_read_b64_tr_b16 v[68:69], v17 offset:24576
    v_cmp_ne_u32 vcc, 0, v127
    v_mfma_f32_16x16x32_bf16 v[160:163], v[40:43], a[32:35], v[160:163]
    ds_read_b64_tr_b16 v[70:71], v17 offset:25600
    v_add_u32 v126, 16, v126
    v_mfma_f32_16x16x32_bf16 v[164:167], v[40:43], a[36:39], v[164:167]
    ds_read_b64_tr_b16 v[72:73], v18 offset:24576
    v_and_b32 v127, -15, v126
    v_mfma_f32_16x16x32_bf16 v[168:171], v[40:43], a[40:43], v[168:171]
    buffer_load_dwordx4 v9, s[12:15], s36 offen offset:1024 lds
    v_cndmask_b32 v101, 0, v125, vcc
    v_mfma_f32_16x16x32_bf16 v[172:175], v[40:43], a[44:47], v[172:175]
    ds_read_b64_tr_b16 v[74:75], v18 offset:25600
    v_cmp_ne_u32 vcc, 0, v127
    v_mfma_f32_16x16x32_bf16 v[176:179], v[44:47], a[32:35], v[176:179]
    s_add_u32 s36, s36, 262144
    ds_read_b64_tr_b16 v[76:77], v19 offset:24576
    v_mfma_f32_16x16x32_bf16 v[180:183], v[44:47], a[36:39], v[180:183]
    s_add_u32 m0, s39, 8192
    ds_read_b64_tr_b16 v[78:79], v19 offset:25600
    v_cndmask_b32 v97, 0, v125, vcc
    v_mfma_f32_16x16x32_bf16 v[184:187], v[44:47], a[40:43], v[184:187]
    buffer_load_dwordx4 v8, s[12:15], s36 offen lds
    v_subrev_u32 v126, 2, v124
    v_mfma_f32_16x16x32_bf16 v[188:191], v[44:47], a[44:47], v[188:191]
    ds_read_b64_tr_b16 v[80:81], v20 offset:24576
    v_and_b32 v127, -15, v126
    v_mfma_f32_16x16x32_bf16 v[192:195], v[48:51], a[32:35], v[192:195]
    ds_read_b64_tr_b16 v[82:83], v20 offset:25600
    v_cmp_ne_u32 vcc, 0, v127
    v_mfma_f32_16x16x32_bf16 v[196:199], v[48:51], a[36:39], v[196:199]
    ds_read_b64_tr_b16 v[84:85], v21 offset:24576
    v_add_u32 v126, 16, v126
    v_mfma_f32_16x16x32_bf16 v[200:203], v[48:51], a[40:43], v[200:203]
    buffer_load_dwordx4 v9, s[12:15], s36 offen offset:1024 lds
    v_and_b32 v127, -15, v126
    v_mfma_f32_16x16x32_bf16 v[204:207], v[48:51], a[44:47], v[204:207]
    ds_read_b64_tr_b16 v[86:87], v21 offset:25600
    v_cndmask_b32 v102, 0, v125, vcc
    v_mfma_f32_16x16x32_bf16 v[208:211], v[52:55], a[32:35], v[208:211]
    ds_read_b64_tr_b16 v[88:89], v22 offset:24576
    v_cmp_ne_u32 vcc, 0, v127
    v_mfma_f32_16x16x32_bf16 v[212:215], v[52:55], a[36:39], v[212:215]
    ds_read_b64_tr_b16 v[90:91], v22 offset:25600
    v_mfma_f32_16x16x32_bf16 v[216:219], v[52:55], a[40:43], v[216:219]
    ds_read_b64_tr_b16 v[92:93], v23 offset:24576
    v_cndmask_b32 v98, 0, v125, vcc
    v_mfma_f32_16x16x32_bf16 v[220:223], v[52:55], a[44:47], v[220:223]
    ds_read_b64_tr_b16 v[94:95], v23 offset:25600
    v_subrev_u32 v126, 3, v124
    v_mfma_f32_16x16x32_bf16 v[224:227], v[56:59], a[32:35], v[224:227]
    v_and_b32 v127, -15, v126
    v_cmp_ne_u32 vcc, 0, v127
    v_mfma_f32_16x16x32_bf16 v[228:231], v[56:59], a[36:39], v[228:231]
    v_add_u32 v126, 16, v126
    v_and_b32 v127, -15, v126
    v_mfma_f32_16x16x32_bf16 v[232:235], v[56:59], a[40:43], v[232:235]
    v_cndmask_b32 v103, 0, v125, vcc
    v_cmp_ne_u32 vcc, 0, v127
    v_mfma_f32_16x16x32_bf16 v[236:239], v[56:59], a[44:47], v[236:239]
    v_mfma_f32_16x16x32_bf16 v[240:243], v[60:63], a[32:35], v[240:243]
    v_cndmask_b32 v99, 0, v125, vcc
    v_mfma_f32_16x16x32_bf16 v[244:247], v[60:63], a[36:39], v[244:247]
    s_cmp_eq_u32 s53, 0
    s_cselect_b32 s101, 0, 2139095039
    s_cselect_b32 s101, 4048155338, s101
    v_min_f32 v104, s101, v96
    v_min_f32 v105, s101, v97
    v_mfma_f32_16x16x32_bf16 v[248:251], v[60:63], a[40:43], v[248:251]
    v_min_f32 v106, s101, v98
    v_min_f32 v107, s101, v99
    v_mfma_f32_16x16x32_bf16 v[252:255], v[60:63], a[44:47], v[252:255]
    s_waitcnt lgkmcnt(12)
    v_mfma_f32_16x16x32_bf16 v[128:131], v[64:67], a[48:51], v[128:131]
    v_mfma_f32_16x16x16_bf16 v[108:111], a[228:229], a[248:249], v[104:107]
    v_mfma_f32_16x16x16_bf16 v[112:115], a[230:231], a[248:249], v[100:103]
    v_mfma_f32_16x16x32_bf16 v[132:135], v[64:67], a[52:55], v[132:135]
    v_mfma_f32_16x16x32_bf16 v[136:139], v[64:67], a[56:59], v[136:139]
    s_bfe_u32 s35, s1, 196624
    v_mfma_f32_16x16x32_bf16 v[140:143], v[64:67], a[60:63], v[140:143]
    s_waitcnt vmcnt(16) lgkmcnt(0)
    s_barrier
    s_lshl_b32 s35, s35, 7
    v_mfma_f32_16x16x32_bf16 v[144:147], v[68:71], a[48:51], v[144:147]
    s_add_u32 s47, s32, s35
    ds_read_b128 a[64:67], v12 offset:8192
    v_mfma_f32_16x16x32_bf16 v[148:151], v[68:71], a[52:55], v[148:151]
    s_add_u32 m0, s38, 0
    ds_read_b128 a[68:71], v12 offset:10240
    v_mfma_f32_16x16x32_bf16 v[152:155], v[68:71], a[56:59], v[152:155]
    buffer_load_dwordx4 v4, s[8:11], s47 offen offset:0 lds
    v_mfma_f32_16x16x32_bf16 v[156:159], v[68:71], a[60:63], v[156:159]
    ds_read_b128 a[72:75], v12 offset:12288
    v_max3_f32 v116, v108, v109, v110
    v_mfma_f32_16x16x32_bf16 v[160:163], v[72:75], a[48:51], v[160:163]
    ds_read_b128 a[76:79], v12 offset:14336
    v_max3_f32 v116, v116, v111, v112
    v_mfma_f32_16x16x32_bf16 v[164:167], v[72:75], a[52:55], v[164:167]
    buffer_load_dwordx4 v5, s[8:11], s47 offen offset:1024 lds
    v_max3_f32 v116, v116, v113, v114
    v_mfma_f32_16x16x32_bf16 v[168:171], v[72:75], a[56:59], v[168:171]
    ds_read_b64_tr_b16 v[32:33], v16 offset:32768
    v_max_f32 v116, v116, v115
    v_mfma_f32_16x16x32_bf16 v[172:175], v[72:75], a[60:63], v[172:175]
    ds_read_b64_tr_b16 v[34:35], v16 offset:33792
    v_mov_b32 v117, v116
    v_mfma_f32_16x16x32_bf16 v[176:179], v[76:79], a[48:51], v[176:179]
    buffer_load_dwordx4 v6, s[8:11], s47 offen offset:2048 lds
    v_mfma_f32_16x16x32_bf16 v[180:183], v[76:79], a[52:55], v[180:183]
    ds_read_b64_tr_b16 v[36:37], v17 offset:32768
    v_permlane32_swap_b32 v116, v117
    v_mfma_f32_16x16x32_bf16 v[184:187], v[76:79], a[56:59], v[184:187]
    ds_read_b64_tr_b16 v[38:39], v17 offset:33792
    v_max_f32 v116, v116, v117
    v_mfma_f32_16x16x32_bf16 v[188:191], v[76:79], a[60:63], v[188:191]
    buffer_load_dwordx4 v7, s[8:11], s47 offen offset:3072 lds
    s_add_u32 s47, s32, s35
    v_mov_b32 v117, v116
    v_mfma_f32_16x16x32_bf16 v[192:195], v[80:83], a[48:51], v[192:195]
    s_add_u32 s47, s47, 32768
    ds_read_b64_tr_b16 v[40:41], v18 offset:32768
    v_mfma_f32_16x16x32_bf16 v[196:199], v[80:83], a[52:55], v[196:199]
    s_add_u32 m0, s38, 4096
    ds_read_b64_tr_b16 v[42:43], v18 offset:33792
    v_permlane16_swap_b32 v116, v117
    v_mfma_f32_16x16x32_bf16 v[200:203], v[80:83], a[56:59], v[200:203]
    buffer_load_dwordx4 v4, s[8:11], s47 offen offset:0 lds
    v_max_f32 v116, v116, v117
    v_mfma_f32_16x16x32_bf16 v[204:207], v[80:83], a[60:63], v[204:207]
    ds_read_b64_tr_b16 v[44:45], v19 offset:32768
    v_mul_f32 v116, s51, v116
    v_mfma_f32_16x16x32_bf16 v[208:211], v[84:87], a[48:51], v[208:211]
    ds_read_b64_tr_b16 v[46:47], v19 offset:33792
    v_fma_f32 v108, v108, s51, -v116
    v_mfma_f32_16x16x32_bf16 v[212:215], v[84:87], a[52:55], v[212:215]
    buffer_load_dwordx4 v5, s[8:11], s47 offen offset:1024 lds
    v_fma_f32 v109, v109, s51, -v116
    v_mfma_f32_16x16x32_bf16 v[216:219], v[84:87], a[56:59], v[216:219]
    ds_read_b64_tr_b16 v[48:49], v20 offset:32768
    v_fma_f32 v110, v110, s51, -v116
    v_mfma_f32_16x16x32_bf16 v[220:223], v[84:87], a[60:63], v[220:223]
    ds_read_b64_tr_b16 v[50:51], v20 offset:33792
    v_fma_f32 v111, v111, s51, -v116
    v_mfma_f32_16x16x32_bf16 v[224:227], v[88:91], a[48:51], v[224:227]
    buffer_load_dwordx4 v6, s[8:11], s47 offen offset:2048 lds
    v_fma_f32 v112, v112, s51, -v116
    v_mfma_f32_16x16x32_bf16 v[228:231], v[88:91], a[52:55], v[228:231]
    ds_read_b64_tr_b16 v[52:53], v21 offset:32768
    v_fma_f32 v113, v113, s51, -v116
    v_mfma_f32_16x16x32_bf16 v[232:235], v[88:91], a[56:59], v[232:235]
    ds_read_b64_tr_b16 v[54:55], v21 offset:33792
    v_fma_f32 v114, v114, s51, -v116
    v_mfma_f32_16x16x32_bf16 v[236:239], v[88:91], a[60:63], v[236:239]
    buffer_load_dwordx4 v7, s[8:11], s47 offen offset:3072 lds
    v_fma_f32 v115, v115, s51, -v116
    v_mfma_f32_16x16x32_bf16 v[240:243], v[92:95], a[48:51], v[240:243]
    ds_read_b64_tr_b16 v[56:57], v22 offset:32768
    v_mfma_f32_16x16x32_bf16 v[244:247], v[92:95], a[52:55], v[244:247]
    ds_read_b64_tr_b16 v[58:59], v22 offset:33792
    v_exp_f32 v108, v108
    v_mfma_f32_16x16x32_bf16 v[248:251], v[92:95], a[56:59], v[248:251]
    ds_read_b64_tr_b16 v[60:61], v23 offset:32768
    v_mfma_f32_16x16x32_bf16 v[252:255], v[92:95], a[60:63], v[252:255]
    ds_read_b64_tr_b16 v[62:63], v23 offset:33792
    v_exp_f32 v109, v109
    s_waitcnt lgkmcnt(12)
    v_mfma_f32_16x16x32_bf16 v[128:131], v[32:35], a[64:67], v[128:131]
    ds_read_b128 a[80:83], v13 offset:8192
    v_mfma_f32_16x16x32_bf16 v[132:135], v[32:35], a[68:71], v[132:135]
    s_bfe_u32 s45, s1, 196628
    ds_read_b128 a[84:87], v13 offset:10240
    v_mfma_f32_16x16x32_bf16 v[136:139], v[32:35], a[72:75], v[136:139]
    s_lshl_b32 s45, s45, 7
    ds_read_b128 a[88:91], v13 offset:12288
    v_exp_f32 v110, v110
    v_mfma_f32_16x16x32_bf16 v[140:143], v[32:35], a[76:79], v[140:143]
    s_lshl_b32 s36, s45, 12
    ds_read_b128 a[92:95], v13 offset:14336
    v_mfma_f32_16x16x32_bf16 v[144:147], v[36:39], a[64:67], v[144:147]
    s_add_u32 s36, s36, s37
    ds_read_b64_tr_b16 v[64:65], v16 offset:40960
    v_exp_f32 v111, v111
    v_mfma_f32_16x16x32_bf16 v[148:151], v[36:39], a[68:71], v[148:151]
    s_add_u32 m0, s39, 16384
    ds_read_b64_tr_b16 v[66:67], v16 offset:41984
    v_mfma_f32_16x16x32_bf16 v[152:155], v[36:39], a[72:75], v[152:155]
    buffer_load_dwordx4 v8, s[12:15], s36 offen lds
    v_exp_f32 v112, v112
    v_mfma_f32_16x16x32_bf16 v[156:159], v[36:39], a[76:79], v[156:159]
    s_waitcnt lgkmcnt(6)
    ds_read_b64_tr_b16 v[68:69], v17 offset:40960
    v_mfma_f32_16x16x32_bf16 v[160:163], v[40:43], a[64:67], v[160:163]
    ds_read_b64_tr_b16 v[70:71], v17 offset:41984
    v_exp_f32 v113, v113
    v_mfma_f32_16x16x32_bf16 v[164:167], v[40:43], a[68:71], v[164:167]
    ds_read_b64_tr_b16 v[72:73], v18 offset:40960
    v_mfma_f32_16x16x32_bf16 v[168:171], v[40:43], a[72:75], v[168:171]
    buffer_load_dwordx4 v9, s[12:15], s36 offen offset:1024 lds
    v_exp_f32 v114, v114
    v_mfma_f32_16x16x32_bf16 v[172:175], v[40:43], a[76:79], v[172:175]
    ds_read_b64_tr_b16 v[74:75], v18 offset:41984
    v_mfma_f32_16x16x32_bf16 v[176:179], v[44:47], a[64:67], v[176:179]
    s_add_u32 s36, s36, 262144
    ds_read_b64_tr_b16 v[76:77], v19 offset:40960
    v_exp_f32 v115, v115
    v_mfma_f32_16x16x32_bf16 v[180:183], v[44:47], a[68:71], v[180:183]
    s_add_u32 m0, s39, 24576
    ds_read_b64_tr_b16 v[78:79], v19 offset:41984
    v_cvt_pk_bf16_f32 v108, v108, v109
    v_mfma_f32_16x16x32_bf16 v[184:187], v[44:47], a[72:75], v[184:187]
    buffer_load_dwordx4 v8, s[12:15], s36 offen lds
    v_cvt_pk_bf16_f32 v109, v110, v111
    v_mfma_f32_16x16x32_bf16 v[188:191], v[44:47], a[76:79], v[188:191]
    ds_read_b64_tr_b16 v[80:81], v20 offset:40960
    v_cvt_pk_bf16_f32 v110, v112, v113
    v_mfma_f32_16x16x32_bf16 v[192:195], v[48:51], a[64:67], v[192:195]
    ds_read_b64_tr_b16 v[82:83], v20 offset:41984
    v_cvt_pk_bf16_f32 v111, v114, v115
    v_mfma_f32_16x16x32_bf16 v[196:199], v[48:51], a[68:71], v[196:199]
    ds_read_b64_tr_b16 v[84:85], v21 offset:40960
    v_mfma_f32_16x16x32_bf16 v[200:203], v[48:51], a[72:75], v[200:203]
    buffer_load_dwordx4 v9, s[12:15], s36 offen offset:1024 lds
    v_mfma_f32_16x16x32_bf16 v[112:115], a[224:227], v[108:111], 0
    v_mfma_f32_16x16x32_bf16 v[204:207], v[48:51], a[76:79], v[204:207]
    ds_read_b64_tr_b16 v[86:87], v21 offset:41984
    v_mfma_f32_16x16x32_bf16 v[120:123], a[238:241], v[108:111], 0
    v_mfma_f32_16x16x32_bf16 v[208:211], v[52:55], a[64:67], v[208:211]
    ds_read_b64_tr_b16 v[88:89], v22 offset:40960
    v_mfma_f32_16x16x32_bf16 v[212:215], v[52:55], a[68:71], v[212:215]
    ds_read_b64_tr_b16 v[90:91], v22 offset:41984
    v_mfma_f32_16x16x32_bf16 v[216:219], v[52:55], a[72:75], v[216:219]
    ds_read_b64_tr_b16 v[92:93], v23 offset:40960
    v_mfma_f32_16x16x32_bf16 v[220:223], v[52:55], a[76:79], v[220:223]
    ds_read_b64_tr_b16 v[94:95], v23 offset:41984
    v_mfma_f32_16x16x32_bf16 v[224:227], v[56:59], a[64:67], v[224:227]
    v_mfma_f32_16x16x32_bf16 v[228:231], v[56:59], a[68:71], v[228:231]
    v_mfma_f32_16x16x32_bf16 v[232:235], v[56:59], a[72:75], v[232:235]
    v_rcp_f32 v116, v112
    v_mfma_f32_16x16x32_bf16 v[236:239], v[56:59], a[76:79], v[236:239]
    v_mul_f32 v120, v116, v120
    v_mul_f32 v121, v116, v121
    v_mfma_f32_16x16x32_bf16 v[240:243], v[60:63], a[64:67], v[240:243]
    v_mul_f32 v122, v116, v122
    v_mul_f32 v123, v116, v123
    v_mfma_f32_16x16x32_bf16 v[244:247], v[60:63], a[68:71], v[244:247]
    v_cvt_pk_bf16_f32 v118, v120, v121
    v_cvt_pk_bf16_f32 v119, v122, v123
    v_mfma_f32_16x16x32_bf16 v[248:251], v[60:63], a[72:75], v[248:251]
    s_add_u32 s54, s52, 0
    buffer_store_dwordx2 v[118:119], v26, s[20:23], s54 offen sc1
    v_mfma_f32_16x16x32_bf16 v[252:255], v[60:63], a[76:79], v[252:255]
    s_waitcnt lgkmcnt(12)
    v_mfma_f32_16x16x32_bf16 v[128:131], v[64:67], a[80:83], v[128:131]
    v_mfma_f32_16x16x32_bf16 v[132:135], v[64:67], a[84:87], v[132:135]
    v_mfma_f32_16x16x32_bf16 v[136:139], v[64:67], a[88:91], v[136:139]
    s_bfe_u32 s35, s1, 196628
    v_mfma_f32_16x16x16_bf16 v[108:111], a[230:231], a[250:251], v[96:99]
    v_mfma_f32_16x16x16_bf16 v[112:115], a[232:233], a[250:251], v[100:103]
    v_mfma_f32_16x16x32_bf16 v[140:143], v[64:67], a[92:95], v[140:143]
    s_waitcnt vmcnt(17) lgkmcnt(0)
    s_barrier
    s_lshl_b32 s35, s35, 7
    v_mfma_f32_16x16x32_bf16 v[144:147], v[68:71], a[80:83], v[144:147]
    s_add_u32 s47, s32, s35
    ds_read_b128 a[96:99], v12 offset:16384
    v_mfma_f32_16x16x32_bf16 v[148:151], v[68:71], a[84:87], v[148:151]
    s_add_u32 m0, s38, 8192
    ds_read_b128 a[100:103], v12 offset:18432
    v_mfma_f32_16x16x32_bf16 v[152:155], v[68:71], a[88:91], v[152:155]
    buffer_load_dwordx4 v4, s[8:11], s47 offen offset:0 lds
    v_mfma_f32_16x16x32_bf16 v[156:159], v[68:71], a[92:95], v[156:159]
    ds_read_b128 a[104:107], v12 offset:20480
    v_mfma_f32_16x16x32_bf16 v[160:163], v[72:75], a[80:83], v[160:163]
    ds_read_b128 a[108:111], v12 offset:22528
    v_mfma_f32_16x16x32_bf16 v[164:167], v[72:75], a[84:87], v[164:167]
    buffer_load_dwordx4 v5, s[8:11], s47 offen offset:1024 lds
    v_max3_f32 v116, v108, v109, v110
    v_mfma_f32_16x16x32_bf16 v[168:171], v[72:75], a[88:91], v[168:171]
    ds_read_b64_tr_b16 v[32:33], v16 offset:49152
    v_max3_f32 v116, v116, v111, v112
    v_mfma_f32_16x16x32_bf16 v[172:175], v[72:75], a[92:95], v[172:175]
    ds_read_b64_tr_b16 v[34:35], v16 offset:50176
    v_max3_f32 v116, v116, v113, v114
    v_mfma_f32_16x16x32_bf16 v[176:179], v[76:79], a[80:83], v[176:179]
    buffer_load_dwordx4 v6, s[8:11], s47 offen offset:2048 lds
    v_max_f32 v116, v116, v115
    v_mfma_f32_16x16x32_bf16 v[180:183], v[76:79], a[84:87], v[180:183]
    ds_read_b64_tr_b16 v[36:37], v17 offset:49152
    v_mov_b32 v117, v116
    v_mfma_f32_16x16x32_bf16 v[184:187], v[76:79], a[88:91], v[184:187]
    ds_read_b64_tr_b16 v[38:39], v17 offset:50176
    v_mfma_f32_16x16x32_bf16 v[188:191], v[76:79], a[92:95], v[188:191]
    buffer_load_dwordx4 v7, s[8:11], s47 offen offset:3072 lds
    s_add_u32 s47, s32, s35
    v_permlane32_swap_b32 v116, v117
    v_mfma_f32_16x16x32_bf16 v[192:195], v[80:83], a[80:83], v[192:195]
    s_add_u32 s47, s47, 32768
    ds_read_b64_tr_b16 v[40:41], v18 offset:49152
    v_max_f32 v116, v116, v117
    v_mfma_f32_16x16x32_bf16 v[196:199], v[80:83], a[84:87], v[196:199]
    s_add_u32 m0, s38, 12288
    ds_read_b64_tr_b16 v[42:43], v18 offset:50176
    v_mov_b32 v117, v116
    v_mfma_f32_16x16x32_bf16 v[200:203], v[80:83], a[88:91], v[200:203]
    buffer_load_dwordx4 v4, s[8:11], s47 offen offset:0 lds
    v_mfma_f32_16x16x32_bf16 v[204:207], v[80:83], a[92:95], v[204:207]
    ds_read_b64_tr_b16 v[44:45], v19 offset:49152
    v_permlane16_swap_b32 v116, v117
    v_mfma_f32_16x16x32_bf16 v[208:211], v[84:87], a[80:83], v[208:211]
    ds_read_b64_tr_b16 v[46:47], v19 offset:50176
    v_max_f32 v116, v116, v117
    v_mfma_f32_16x16x32_bf16 v[212:215], v[84:87], a[84:87], v[212:215]
    buffer_load_dwordx4 v5, s[8:11], s47 offen offset:1024 lds
    v_mul_f32 v116, s51, v116
    v_mfma_f32_16x16x32_bf16 v[216:219], v[84:87], a[88:91], v[216:219]
    ds_read_b64_tr_b16 v[48:49], v20 offset:49152
    v_fma_f32 v108, v108, s51, -v116
    v_mfma_f32_16x16x32_bf16 v[220:223], v[84:87], a[92:95], v[220:223]
    ds_read_b64_tr_b16 v[50:51], v20 offset:50176
    v_fma_f32 v109, v109, s51, -v116
    v_mfma_f32_16x16x32_bf16 v[224:227], v[88:91], a[80:83], v[224:227]
    buffer_load_dwordx4 v6, s[8:11], s47 offen offset:2048 lds
    v_fma_f32 v110, v110, s51, -v116
    v_mfma_f32_16x16x32_bf16 v[228:231], v[88:91], a[84:87], v[228:231]
    ds_read_b64_tr_b16 v[52:53], v21 offset:49152
    v_fma_f32 v111, v111, s51, -v116
    v_mfma_f32_16x16x32_bf16 v[232:235], v[88:91], a[88:91], v[232:235]
    ds_read_b64_tr_b16 v[54:55], v21 offset:50176
    v_fma_f32 v112, v112, s51, -v116
    v_mfma_f32_16x16x32_bf16 v[236:239], v[88:91], a[92:95], v[236:239]
    buffer_load_dwordx4 v7, s[8:11], s47 offen offset:3072 lds
    v_fma_f32 v113, v113, s51, -v116
    v_mfma_f32_16x16x32_bf16 v[240:243], v[92:95], a[80:83], v[240:243]
    ds_read_b64_tr_b16 v[56:57], v22 offset:49152
    v_fma_f32 v114, v114, s51, -v116
    v_mfma_f32_16x16x32_bf16 v[244:247], v[92:95], a[84:87], v[244:247]
    ds_read_b64_tr_b16 v[58:59], v22 offset:50176
    v_fma_f32 v115, v115, s51, -v116
    v_mfma_f32_16x16x32_bf16 v[248:251], v[92:95], a[88:91], v[248:251]
    ds_read_b64_tr_b16 v[60:61], v23 offset:49152
    s_mov_b32 s100, 0x20000
PL1:
    v_cmp_eq_u32 vcc, 0, v0
    s_cbranch_vccz PL1x
    s_sub_u32 s100, s100, 1
    s_cbranch_scc1 PL1x
    s_sleep 4
    buffer_load_dword v0, v27, s[24:27], 0 offen sc1
    s_waitcnt vmcnt(0)
    s_branch PL1
PL1x:
    v_readfirstlane_b32 s3, v0
    v_mfma_f32_16x16x32_bf16 v[252:255], v[92:95], a[92:95], v[252:255]
    ds_read_b64_tr_b16 v[62:63], v23 offset:50176
    v_exp_f32 v108, v108
    s_waitcnt lgkmcnt(12)
    v_mfma_f32_16x16x32_bf16 v[128:131], v[32:35], a[96:99], v[128:131]
    ds_read_b128 a[112:115], v13 offset:16384
    v_mfma_f32_16x16x32_bf16 v[132:135], v[32:35], a[100:103], v[132:135]
    s_bfe_u32 s45, s1, 196632
    ds_read_b128 a[116:119], v13 offset:18432
    v_mfma_f32_16x16x32_bf16 v[136:139], v[32:35], a[104:107], v[136:139]
    s_lshl_b32 s45, s45, 7
    ds_read_b128 a[120:123], v13 offset:20480
    v_exp_f32 v109, v109
    v_mfma_f32_16x16x32_bf16 v[140:143], v[32:35], a[108:111], v[140:143]
    s_lshl_b32 s36, s45, 12
    ds_read_b128 a[124:127], v13 offset:22528
    v_mfma_f32_16x16x32_bf16 v[144:147], v[36:39], a[96:99], v[144:147]
    s_add_u32 s36, s36, s37
    ds_read_b64_tr_b16 v[64:65], v16 offset:57344
    v_exp_f32 v110, v110
    v_mfma_f32_16x16x32_bf16 v[148:151], v[36:39], a[100:103], v[148:151]
    s_add_u32 m0, s39, 32768
    ds_read_b64_tr_b16 v[66:67], v16 offset:58368
    v_mfma_f32_16x16x32_bf16 v[152:155], v[36:39], a[104:107], v[152:155]
    buffer_load_dwordx4 v8, s[12:15], s36 offen lds
    v_exp_f32 v111, v111
    v_mfma_f32_16x16x32_bf16 v[156:159], v[36:39], a[108:111], v[156:159]
    s_waitcnt lgkmcnt(6)
    ds_read_b64_tr_b16 v[68:69], v17 offset:57344
    v_mfma_f32_16x16x32_bf16 v[160:163], v[40:43], a[96:99], v[160:163]
    ds_read_b64_tr_b16 v[70:71], v17 offset:58368
    v_exp_f32 v112, v112
    v_mfma_f32_16x16x32_bf16 v[164:167], v[40:43], a[100:103], v[164:167]
    ds_read_b64_tr_b16 v[72:73], v18 offset:57344
    v_mfma_f32_16x16x32_bf16 v[168:171], v[40:43], a[104:107], v[168:171]
    buffer_load_dwordx4 v9, s[12:15], s36 offen offset:1024 lds
    v_exp_f32 v113, v113
    v_mfma_f32_16x16x32_bf16 v[172:175], v[40:43], a[108:111], v[172:175]
    ds_read_b64_tr_b16 v[74:75], v18 offset:58368
    v_mfma_f32_16x16x32_bf16 v[176:179], v[44:47], a[96:99], v[176:179]
    s_add_u32 s36, s36, 262144
    ds_read_b64_tr_b16 v[76:77], v19 offset:57344
    v_exp_f32 v114, v114
    v_mfma_f32_16x16x32_bf16 v[180:183], v[44:47], a[100:103], v[180:183]
    s_add_u32 m0, s39, 40960
    ds_read_b64_tr_b16 v[78:79], v19 offset:58368
    v_mfma_f32_16x16x32_bf16 v[184:187], v[44:47], a[104:107], v[184:187]
    buffer_load_dwordx4 v8, s[12:15], s36 offen lds
    v_exp_f32 v115, v115
    v_mfma_f32_16x16x32_bf16 v[188:191], v[44:47], a[108:111], v[188:191]
    ds_read_b64_tr_b16 v[80:81], v20 offset:57344
    v_cvt_pk_bf16_f32 v108, v108, v109
    v_mfma_f32_16x16x32_bf16 v[192:195], v[48:51], a[96:99], v[192:195]
    ds_read_b64_tr_b16 v[82:83], v20 offset:58368
    v_cvt_pk_bf16_f32 v109, v110, v111
    v_mfma_f32_16x16x32_bf16 v[196:199], v[48:51], a[100:103], v[196:199]
    ds_read_b64_tr_b16 v[84:85], v21 offset:57344
    v_cvt_pk_bf16_f32 v110, v112, v113
    v_mfma_f32_16x16x32_bf16 v[200:203], v[48:51], a[104:107], v[200:203]
    buffer_load_dwordx4 v9, s[12:15], s36 offen offset:1024 lds
    v_cvt_pk_bf16_f32 v111, v114, v115
    v_mfma_f32_16x16x32_bf16 v[204:207], v[48:51], a[108:111], v[204:207]
    ds_read_b64_tr_b16 v[86:87], v21 offset:58368
    v_mfma_f32_16x16x32_bf16 v[208:211], v[52:55], a[96:99], v[208:211]
    ds_read_b64_tr_b16 v[88:89], v22 offset:57344
    v_mfma_f32_16x16x32_bf16 v[112:115], a[224:227], v[108:111], 0
    v_mfma_f32_16x16x32_bf16 v[212:215], v[52:55], a[100:103], v[212:215]
    ds_read_b64_tr_b16 v[90:91], v22 offset:58368
    v_mfma_f32_16x16x32_bf16 v[120:123], a[240:243], v[108:111], 0
    v_mfma_f32_16x16x32_bf16 v[216:219], v[52:55], a[104:107], v[216:219]
    ds_read_b64_tr_b16 v[92:93], v23 offset:57344
    v_mfma_f32_16x16x32_bf16 v[220:223], v[52:55], a[108:111], v[220:223]
    ds_read_b64_tr_b16 v[94:95], v23 offset:58368
    v_mfma_f32_16x16x32_bf16 v[224:227], v[56:59], a[96:99], v[224:227]
    v_mfma_f32_16x16x32_bf16 v[228:231], v[56:59], a[100:103], v[228:231]
    v_mfma_f32_16x16x32_bf16 v[232:235], v[56:59], a[104:107], v[232:235]
    v_mfma_f32_16x16x32_bf16 v[236:239], v[56:59], a[108:111], v[236:239]
    v_mfma_f32_16x16x32_bf16 v[240:243], v[60:63], a[96:99], v[240:243]
    v_rcp_f32 v116, v112
    v_mfma_f32_16x16x32_bf16 v[244:247], v[60:63], a[100:103], v[244:247]
    v_mul_f32 v120, v116, v120
    v_mul_f32 v121, v116, v121
    v_mfma_f32_16x16x32_bf16 v[248:251], v[60:63], a[104:107], v[248:251]
    v_mul_f32 v122, v116, v122
    v_mul_f32 v123, v116, v123
    v_mfma_f32_16x16x32_bf16 v[252:255], v[60:63], a[108:111], v[252:255]
    v_cvt_pk_bf16_f32 v118, v120, v121
    v_cvt_pk_bf16_f32 v119, v122, v123
    s_waitcnt lgkmcnt(12)
    v_mfma_f32_16x16x32_bf16 v[128:131], v[64:67], a[112:115], v[128:131]
    s_add_u32 s54, s52, 16384
    buffer_store_dwordx2 v[118:119], v26, s[20:23], s54 offen sc1
    v_mfma_f32_16x16x32_bf16 v[132:135], v[64:67], a[116:119], v[132:135]
    v_mfma_f32_16x16x32_bf16 v[136:139], v[64:67], a[120:123], v[136:139]
    s_bfe_u32 s35, s1, 196632
    v_mfma_f32_16x16x32_bf16 v[140:143], v[64:67], a[124:127], v[140:143]
    s_waitcnt vmcnt(18) lgkmcnt(0)
    s_barrier
    s_lshl_b32 s35, s35, 7
    v_mfma_f32_16x16x32_bf16 v[144:147], v[68:71], a[112:115], v[144:147]
    s_add_u32 s47, s32, s35
    ds_read_b128 a[128:131], v12 offset:0
    v_mfma_f32_16x16x16_bf16 v[108:111], a[232:233], a[252:253], v[96:99]
    v_mfma_f32_16x16x32_bf16 v[148:151], v[68:71], a[116:119], v[148:151]
    s_add_u32 m0, s38, 16384
    ds_read_b128 a[132:135], v12 offset:2048
    v_mfma_f32_16x16x16_bf16 v[112:115], a[234:235], a[252:253], v[100:103]
    v_mfma_f32_16x16x32_bf16 v[152:155], v[68:71], a[120:123], v[152:155]
    buffer_load_dwordx4 v4, s[8:11], s47 offen offset:0 lds
    v_mfma_f32_16x16x32_bf16 v[156:159], v[68:71], a[124:127], v[156:159]
    ds_read_b128 a[136:139], v12 offset:4096
    v_mfma_f32_16x16x32_bf16 v[160:163], v[72:75], a[112:115], v[160:163]
    ds_read_b128 a[140:143], v12 offset:6144
    v_mfma_f32_16x16x32_bf16 v[164:167], v[72:75], a[116:119], v[164:167]
    buffer_load_dwordx4 v5, s[8:11], s47 offen offset:1024 lds
    v_mfma_f32_16x16x32_bf16 v[168:171], v[72:75], a[120:123], v[168:171]
    ds_read_b64_tr_b16 v[32:33], v16 offset:0
    v_mfma_f32_16x16x32_bf16 v[172:175], v[72:75], a[124:127], v[172:175]
    ds_read_b64_tr_b16 v[34:35], v16 offset:1024
    v_mfma_f32_16x16x32_bf16 v[176:179], v[76:79], a[112:115], v[176:179]
    buffer_load_dwordx4 v6, s[8:11], s47 offen offset:2048 lds
    v_max3_f32 v116, v108, v109, v110
    v_mfma_f32_16x16x32_bf16 v[180:183], v[76:79], a[116:119], v[180:183]
    ds_read_b64_tr_b16 v[36:37], v17 offset:0
    v_max3_f32 v116, v116, v111, v112
    v_mfma_f32_16x16x32_bf16 v[184:187], v[76:79], a[120:123], v[184:187]
    ds_read_b64_tr_b16 v[38:39], v17 offset:1024
    v_max3_f32 v116, v116, v113, v114
    v_mfma_f32_16x16x32_bf16 v[188:191], v[76:79], a[124:127], v[188:191]
    buffer_load_dwordx4 v7, s[8:11], s47 offen offset:3072 lds
    s_add_u32 s47, s32, s35
    v_max_f32 v116, v116, v115
    v_mfma_f32_16x16x32_bf16 v[192:195], v[80:83], a[112:115], v[192:195]
    s_add_u32 s47, s47, 32768
    ds_read_b64_tr_b16 v[40:41], v18 offset:0
    v_mov_b32 v117, v116
    v_mfma_f32_16x16x32_bf16 v[196:199], v[80:83], a[116:119], v[196:199]
    s_add_u32 m0, s38, 20480
    ds_read_b64_tr_b16 v[42:43], v18 offset:1024
    v_mfma_f32_16x16x32_bf16 v[200:203], v[80:83], a[120:123], v[200:203]
    buffer_load_dwordx4 v4, s[8:11], s47 offen offset:0 lds
    v_permlane32_swap_b32 v116, v117
    v_mfma_f32_16x16x32_bf16 v[204:207], v[80:83], a[124:127], v[204:207]
    ds_read_b64_tr_b16 v[44:45], v19 offset:0
    v_max_f32 v116, v116, v117
    v_mfma_f32_16x16x32_bf16 v[208:211], v[84:87], a[112:115], v[208:211]
    ds_read_b64_tr_b16 v[46:47], v19 offset:1024
    v_mov_b32 v117, v116
    v_mfma_f32_16x16x32_bf16 v[212:215], v[84:87], a[116:119], v[212:215]
    buffer_load_dwordx4 v5, s[8:11], s47 offen offset:1024 lds
    v_mfma_f32_16x16x32_bf16 v[216:219], v[84:87], a[120:123], v[216:219]
    ds_read_b64_tr_b16 v[48:49], v20 offset:0
    v_permlane16_swap_b32 v116, v117
    v_mfma_f32_16x16x32_bf16 v[220:223], v[84:87], a[124:127], v[220:223]
    ds_read_b64_tr_b16 v[50:51], v20 offset:1024
    v_max_f32 v116, v116, v117
    v_mfma_f32_16x16x32_bf16 v[224:227], v[88:91], a[112:115], v[224:227]
    buffer_load_dwordx4 v6, s[8:11], s47 offen offset:2048 lds
    v_mul_f32 v116, s51, v116
    v_mfma_f32_16x16x32_bf16 v[228:231], v[88:91], a[116:119], v[228:231]
    ds_read_b64_tr_b16 v[52:53], v21 offset:0
    v_fma_f32 v108, v108, s51, -v116
    v_mfma_f32_16x16x32_bf16 v[232:235], v[88:91], a[120:123], v[232:235]
    ds_read_b64_tr_b16 v[54:55], v21 offset:1024
    v_fma_f32 v109, v109, s51, -v116
    v_mfma_f32_16x16x32_bf16 v[236:239], v[88:91], a[124:127], v[236:239]
    buffer_load_dwordx4 v7, s[8:11], s47 offen offset:3072 lds
    v_fma_f32 v110, v110, s51, -v116
    v_mfma_f32_16x16x32_bf16 v[240:243], v[92:95], a[112:115], v[240:243]
    ds_read_b64_tr_b16 v[56:57], v22 offset:0
    v_fma_f32 v111, v111, s51, -v116
    v_mfma_f32_16x16x32_bf16 v[244:247], v[92:95], a[116:119], v[244:247]
    ds_read_b64_tr_b16 v[58:59], v22 offset:1024
    v_fma_f32 v112, v112, s51, -v116
    v_mfma_f32_16x16x32_bf16 v[248:251], v[92:95], a[120:123], v[248:251]
    ds_read_b64_tr_b16 v[60:61], v23 offset:0
    v_fma_f32 v113, v113, s51, -v116
    v_mfma_f32_16x16x32_bf16 v[252:255], v[92:95], a[124:127], v[252:255]
    ds_read_b64_tr_b16 v[62:63], v23 offset:1024
    v_fma_f32 v114, v114, s51, -v116
    s_waitcnt lgkmcnt(12)
    v_mfma_f32_16x16x32_bf16 v[128:131], v[32:35], a[128:131], v[128:131]
    ds_read_b128 a[144:147], v13 offset:0
    v_fma_f32 v115, v115, s51, -v116
    v_mfma_f32_16x16x32_bf16 v[132:135], v[32:35], a[132:135], v[132:135]
    s_bfe_u32 s45, s1, 196636
    ds_read_b128 a[148:151], v13 offset:2048
    v_mfma_f32_16x16x32_bf16 v[136:139], v[32:35], a[136:139], v[136:139]
    s_lshl_b32 s45, s45, 7
    ds_read_b128 a[152:155], v13 offset:4096
    v_exp_f32 v108, v108
    v_mfma_f32_16x16x32_bf16 v[140:143], v[32:35], a[140:143], v[140:143]
    s_lshl_b32 s36, s45, 12
    ds_read_b128 a[156:159], v13 offset:6144
    v_mfma_f32_16x16x32_bf16 v[144:147], v[36:39], a[128:131], v[144:147]
    s_add_u32 s36, s36, s37
    ds_read_b64_tr_b16 v[64:65], v16 offset:8192
    v_exp_f32 v109, v109
    v_mfma_f32_16x16x32_bf16 v[148:151], v[36:39], a[132:135], v[148:151]
    s_add_u32 m0, s39, 49152
    ds_read_b64_tr_b16 v[66:67], v16 offset:9216
    v_mfma_f32_16x16x32_bf16 v[152:155], v[36:39], a[136:139], v[152:155]
    buffer_load_dwordx4 v8, s[12:15], s36 offen lds
    v_exp_f32 v110, v110
    v_mfma_f32_16x16x32_bf16 v[156:159], v[36:39], a[140:143], v[156:159]
    s_waitcnt lgkmcnt(6)
    ds_read_b64_tr_b16 v[68:69], v17 offset:8192
    v_mfma_f32_16x16x32_bf16 v[160:163], v[40:43], a[128:131], v[160:163]
    ds_read_b64_tr_b16 v[70:71], v17 offset:9216
    v_exp_f32 v111, v111
    v_mfma_f32_16x16x32_bf16 v[164:167], v[40:43], a[132:135], v[164:167]
    ds_read_b64_tr_b16 v[72:73], v18 offset:8192
    v_mfma_f32_16x16x32_bf16 v[168:171], v[40:43], a[136:139], v[168:171]
    buffer_load_dwordx4 v9, s[12:15], s36 offen offset:1024 lds
    v_exp_f32 v112, v112
    v_mfma_f32_16x16x32_bf16 v[172:175], v[40:43], a[140:143], v[172:175]
    ds_read_b64_tr_b16 v[74:75], v18 offset:9216
    v_mfma_f32_16x16x32_bf16 v[176:179], v[44:47], a[128:131], v[176:179]
    s_add_u32 s36, s36, 262144
    ds_read_b64_tr_b16 v[76:77], v19 offset:8192
    v_exp_f32 v113, v113
    v_mfma_f32_16x16x32_bf16 v[180:183], v[44:47], a[132:135], v[180:183]
    s_add_u32 m0, s39, 57344
    ds_read_b64_tr_b16 v[78:79], v19 offset:9216
    v_mfma_f32_16x16x32_bf16 v[184:187], v[44:47], a[136:139], v[184:187]
    buffer_load_dwordx4 v8, s[12:15], s36 offen lds
    v_exp_f32 v114, v114
    v_mfma_f32_16x16x32_bf16 v[188:191], v[44:47], a[140:143], v[188:191]
    ds_read_b64_tr_b16 v[80:81], v20 offset:8192
    v_mfma_f32_16x16x32_bf16 v[192:195], v[48:51], a[128:131], v[192:195]
    ds_read_b64_tr_b16 v[82:83], v20 offset:9216
    v_exp_f32 v115, v115
    v_mfma_f32_16x16x32_bf16 v[196:199], v[48:51], a[132:135], v[196:199]
    ds_read_b64_tr_b16 v[84:85], v21 offset:8192
    v_cvt_pk_bf16_f32 v108, v108, v109
    v_mfma_f32_16x16x32_bf16 v[200:203], v[48:51], a[136:139], v[200:203]
    buffer_load_dwordx4 v9, s[12:15], s36 offen offset:1024 lds
    v_cvt_pk_bf16_f32 v109, v110, v111
    v_mfma_f32_16x16x32_bf16 v[204:207], v[48:51], a[140:143], v[204:207]
    ds_read_b64_tr_b16 v[86:87], v21 offset:9216
    v_cvt_pk_bf16_f32 v110, v112, v113
    v_mfma_f32_16x16x32_bf16 v[208:211], v[52:55], a[128:131], v[208:211]
    ds_read_b64_tr_b16 v[88:89], v22 offset:8192
    v_cvt_pk_bf16_f32 v111, v114, v115
    v_mfma_f32_16x16x32_bf16 v[212:215], v[52:55], a[132:135], v[212:215]
    ds_read_b64_tr_b16 v[90:91], v22 offset:9216
    v_mfma_f32_16x16x32_bf16 v[216:219], v[52:55], a[136:139], v[216:219]
    ds_read_b64_tr_b16 v[92:93], v23 offset:8192
    v_mfma_f32_16x16x32_bf16 v[112:115], a[224:227], v[108:111], 0
    v_mfma_f32_16x16x32_bf16 v[220:223], v[52:55], a[140:143], v[220:223]
    ds_read_b64_tr_b16 v[94:95], v23 offset:9216
    v_mfma_f32_16x16x32_bf16 v[120:123], a[242:245], v[108:111], 0
    v_mfma_f32_16x16x32_bf16 v[224:227], v[56:59], a[128:131], v[224:227]
    v_mfma_f32_16x16x32_bf16 v[228:231], v[56:59], a[132:135], v[228:231]
    v_mfma_f32_16x16x32_bf16 v[232:235], v[56:59], a[136:139], v[232:235]
    v_mfma_f32_16x16x32_bf16 v[236:239], v[56:59], a[140:143], v[236:239]
    v_mfma_f32_16x16x32_bf16 v[240:243], v[60:63], a[128:131], v[240:243]
    v_mfma_f32_16x16x32_bf16 v[244:247], v[60:63], a[132:135], v[244:247]
    v_mfma_f32_16x16x32_bf16 v[248:251], v[60:63], a[136:139], v[248:251]
    v_rcp_f32 v116, v112
    v_mfma_f32_16x16x32_bf16 v[252:255], v[60:63], a[140:143], v[252:255]
    v_mul_f32 v120, v116, v120
    v_mul_f32 v121, v116, v121
    s_waitcnt lgkmcnt(12)
    v_mfma_f32_16x16x32_bf16 v[128:131], v[64:67], a[144:147], v[128:131]
    v_mul_f32 v122, v116, v122
    v_mul_f32 v123, v116, v123
    v_mfma_f32_16x16x32_bf16 v[132:135], v[64:67], a[148:151], v[132:135]
    v_cvt_pk_bf16_f32 v118, v120, v121
    v_cvt_pk_bf16_f32 v119, v122, v123
    v_mfma_f32_16x16x32_bf16 v[136:139], v[64:67], a[152:155], v[136:139]
    s_bfe_u32 s35, s1, 196636
    s_add_u32 s54, s52, 32768
    buffer_store_dwordx2 v[118:119], v26, s[20:23], s54 offen sc1
    v_mfma_f32_16x16x32_bf16 v[140:143], v[64:67], a[156:159], v[140:143]
    s_waitcnt vmcnt(18) lgkmcnt(0)
    s_barrier
    s_lshl_b32 s35, s35, 7
    v_mfma_f32_16x16x32_bf16 v[144:147], v[68:71], a[144:147], v[144:147]
    s_add_u32 s47, s32, s35
    ds_read_b128 a[160:163], v12 offset:8192
    v_mfma_f32_16x16x32_bf16 v[148:151], v[68:71], a[148:151], v[148:151]
    s_add_u32 m0, s38, 0
    ds_read_b128 a[164:167], v12 offset:10240
    v_mfma_f32_16x16x32_bf16 v[152:155], v[68:71], a[152:155], v[152:155]
    buffer_load_dwordx4 v4, s[8:11], s47 offen offset:0 lds
    v_mfma_f32_16x16x16_bf16 v[108:111], a[234:235], a[254:255], v[96:99]
    v_mfma_f32_16x16x32_bf16 v[156:159], v[68:71], a[156:159], v[156:159]
    ds_read_b128 a[168:171], v12 offset:12288
    v_mfma_f32_16x16x16_bf16 v[112:115], a[236:237], a[254:255], v[100:103]
    v_mfma_f32_16x16x32_bf16 v[160:163], v[72:75], a[144:147], v[160:163]
    ds_read_b128 a[172:175], v12 offset:14336
    v_mfma_f32_16x16x32_bf16 v[164:167], v[72:75], a[148:151], v[164:167]
    buffer_load_dwordx4 v5, s[8:11], s47 offen offset:1024 lds
    v_mfma_f32_16x16x32_bf16 v[168:171], v[72:75], a[152:155], v[168:171]
    ds_read_b64_tr_b16 v[32:33], v16 offset:16384
    v_mfma_f32_16x16x32_bf16 v[172:175], v[72:75], a[156:159], v[172:175]
    ds_read_b64_tr_b16 v[34:35], v16 offset:17408
    v_mfma_f32_16x16x32_bf16 v[176:179], v[76:79], a[144:147], v[176:179]
    buffer_load_dwordx4 v6, s[8:11], s47 offen offset:2048 lds
    v_mfma_f32_16x16x32_bf16 v[180:183], v[76:79], a[148:151], v[180:183]
    ds_read_b64_tr_b16 v[36:37], v17 offset:16384
    v_mfma_f32_16x16x32_bf16 v[184:187], v[76:79], a[152:155], v[184:187]
    ds_read_b64_tr_b16 v[38:39], v17 offset:17408
    v_max3_f32 v116, v108, v109, v110
    v_mfma_f32_16x16x32_bf16 v[188:191], v[76:79], a[156:159], v[188:191]
    buffer_load_dwordx4 v7, s[8:11], s47 offen offset:3072 lds
    s_add_u32 s47, s32, s35
    v_max3_f32 v116, v116, v111, v112
    v_mfma_f32_16x16x32_bf16 v[192:195], v[80:83], a[144:147], v[192:195]
    s_add_u32 s47, s47, 32768
    ds_read_b64_tr_b16 v[40:41], v18 offset:16384
    v_max3_f32 v116, v116, v113, v114
    v_mfma_f32_16x16x32_bf16 v[196:199], v[80:83], a[148:151], v[196:199]
    s_add_u32 m0, s38, 4096
    ds_read_b64_tr_b16 v[42:43], v18 offset:17408
    v_max_f32 v116, v116, v115
    v_mfma_f32_16x16x32_bf16 v[200:203], v[80:83], a[152:155], v[200:203]
    buffer_load_dwordx4 v4, s[8:11], s47 offen offset:0 lds
    v_mov_b32 v117, v116
    v_mfma_f32_16x16x32_bf16 v[204:207], v[80:83], a[156:159], v[204:207]
    ds_read_b64_tr_b16 v[44:45], v19 offset:16384
    v_mfma_f32_16x16x32_bf16 v[208:211], v[84:87], a[144:147], v[208:211]
    ds_read_b64_tr_b16 v[46:47], v19 offset:17408
    v_permlane32_swap_b32 v116, v117
    v_mfma_f32_16x16x32_bf16 v[212:215], v[84:87], a[148:151], v[212:215]
    buffer_load_dwordx4 v5, s[8:11], s47 offen offset:1024 lds
    v_max_f32 v116, v116, v117
    v_mfma_f32_16x16x32_bf16 v[216:219], v[84:87], a[152:155], v[216:219]
    ds_read_b64_tr_b16 v[48:49], v20 offset:16384
    v_mov_b32 v117, v116
    v_mfma_f32_16x16x32_bf16 v[220:223], v[84:87], a[156:159], v[220:223]
    ds_read_b64_tr_b16 v[50:51], v20 offset:17408
    v_mfma_f32_16x16x32_bf16 v[224:227], v[88:91], a[144:147], v[224:227]
    buffer_load_dwordx4 v6, s[8:11], s47 offen offset:2048 lds
    v_permlane16_swap_b32 v116, v117
    v_mfma_f32_16x16x32_bf16 v[228:231], v[88:91], a[148:151], v[228:231]
    ds_read_b64_tr_b16 v[52:53], v21 offset:16384
    v_max_f32 v116, v116, v117
    v_mfma_f32_16x16x32_bf16 v[232:235], v[88:91], a[152:155], v[232:235]
    ds_read_b64_tr_b16 v[54:55], v21 offset:17408
    v_mul_f32 v116, s51, v116
    v_mfma_f32_16x16x32_bf16 v[236:239], v[88:91], a[156:159], v[236:239]
    buffer_load_dwordx4 v7, s[8:11], s47 offen offset:3072 lds
    v_fma_f32 v108, v108, s51, -v116
    v_mfma_f32_16x16x32_bf16 v[240:243], v[92:95], a[144:147], v[240:243]
    ds_read_b64_tr_b16 v[56:57], v22 offset:16384
    v_fma_f32 v109, v109, s51, -v116
    v_mfma_f32_16x16x32_bf16 v[244:247], v[92:95], a[148:151], v[244:247]
    ds_read_b64_tr_b16 v[58:59], v22 offset:17408
    v_fma_f32 v110, v110, s51, -v116
    v_mfma_f32_16x16x32_bf16 v[248:251], v[92:95], a[152:155], v[248:251]
    ds_read_b64_tr_b16 v[60:61], v23 offset:16384
    v_fma_f32 v111, v111, s51, -v116
    v_bfe_u32 v14, v1, 1, 4
    v_lshlrev_b32 v14, 13, v14
    v_and_b32 v15, 1, v1
    v_lshl_add_u32 v14, v15, 7, v14
    s_lshl2_add_u32 s100, s30, s28
    s_lshl_b32 s100, s100, 17
    s_add_u32 s100, s100, s37
    v_add_u32 v14, s100, v14
    global_load_dword v3, v14, s[70:71]
    v_mfma_f32_16x16x32_bf16 v[252:255], v[92:95], a[156:159], v[252:255]
    ds_read_b64_tr_b16 v[62:63], v23 offset:17408
    v_fma_f32 v112, v112, s51, -v116
    s_waitcnt lgkmcnt(12)
    v_mfma_f32_16x16x32_bf16 v[128:131], v[32:35], a[160:163], v[128:131]
    ds_read_b128 a[176:179], v13 offset:8192
    v_fma_f32 v113, v113, s51, -v116
    v_mfma_f32_16x16x32_bf16 v[132:135], v[32:35], a[164:167], v[132:135]
    ds_read_b128 a[180:183], v13 offset:10240
    v_fma_f32 v114, v114, s51, -v116
    v_mfma_f32_16x16x32_bf16 v[136:139], v[32:35], a[168:171], v[136:139]
    s_mov_b32 s45, 0
    ds_read_b128 a[184:187], v13 offset:12288
    v_fma_f32 v115, v115, s51, -v116
    v_mfma_f32_16x16x32_bf16 v[140:143], v[32:35], a[172:175], v[140:143]
    s_lshl_b32 s36, s45, 12
    ds_read_b128 a[188:191], v13 offset:14336
    v_mfma_f32_16x16x32_bf16 v[144:147], v[36:39], a[160:163], v[144:147]
    s_add_u32 s36, s36, s37
    ds_read_b64_tr_b16 v[64:65], v16 offset:24576
    v_exp_f32 v108, v108
    v_mfma_f32_16x16x32_bf16 v[148:151], v[36:39], a[164:167], v[148:151]
    s_add_u32 m0, s39, 0
    ds_read_b64_tr_b16 v[66:67], v16 offset:25600
    v_mfma_f32_16x16x32_bf16 v[152:155], v[36:39], a[168:171], v[152:155]
    buffer_load_dwordx4 v10, s[16:19], s36 offen lds
    v_exp_f32 v109, v109
    v_mfma_f32_16x16x32_bf16 v[156:159], v[36:39], a[172:175], v[156:159]
    s_waitcnt lgkmcnt(6)
    ds_read_b64_tr_b16 v[68:69], v17 offset:24576
    v_mfma_f32_16x16x32_bf16 v[160:163], v[40:43], a[160:163], v[160:163]
    ds_read_b64_tr_b16 v[70:71], v17 offset:25600
    v_exp_f32 v110, v110
    v_mfma_f32_16x16x32_bf16 v[164:167], v[40:43], a[164:167], v[164:167]
    ds_read_b64_tr_b16 v[72:73], v18 offset:24576
    v_mfma_f32_16x16x32_bf16 v[168:171], v[40:43], a[168:171], v[168:171]
    buffer_load_dwordx4 v11, s[16:19], s36 offen offset:1024 lds
    s_mov_b32 s45, 128
    v_exp_f32 v111, v111
    v_mfma_f32_16x16x32_bf16 v[172:175], v[40:43], a[172:175], v[172:175]
    s_lshl_b32 s36, s45, 12
    ds_read_b64_tr_b16 v[74:75], v18 offset:25600
    v_mfma_f32_16x16x32_bf16 v[176:179], v[44:47], a[160:163], v[176:179]
    s_add_u32 s36, s36, s37
    ds_read_b64_tr_b16 v[76:77], v19 offset:24576
    v_exp_f32 v112, v112
    v_mfma_f32_16x16x32_bf16 v[180:183], v[44:47], a[164:167], v[180:183]
    s_add_u32 m0, s39, 8192
    ds_read_b64_tr_b16 v[78:79], v19 offset:25600
    v_mfma_f32_16x16x32_bf16 v[184:187], v[44:47], a[168:171], v[184:187]
    buffer_load_dwordx4 v10, s[16:19], s36 offen lds
    v_exp_f32 v113, v113
    v_mfma_f32_16x16x32_bf16 v[188:191], v[44:47], a[172:175], v[188:191]
    ds_read_b64_tr_b16 v[80:81], v20 offset:24576
    v_mfma_f32_16x16x32_bf16 v[192:195], v[48:51], a[160:163], v[192:195]
    ds_read_b64_tr_b16 v[82:83], v20 offset:25600
    v_exp_f32 v114, v114
    v_mfma_f32_16x16x32_bf16 v[196:199], v[48:51], a[164:167], v[196:199]
    ds_read_b64_tr_b16 v[84:85], v21 offset:24576
    v_mfma_f32_16x16x32_bf16 v[200:203], v[48:51], a[168:171], v[200:203]
    buffer_load_dwordx4 v11, s[16:19], s36 offen offset:1024 lds
    v_exp_f32 v115, v115
    v_mfma_f32_16x16x32_bf16 v[204:207], v[48:51], a[172:175], v[204:207]
    ds_read_b64_tr_b16 v[86:87], v21 offset:25600
    v_cvt_pk_bf16_f32 v108, v108, v109
    v_mfma_f32_16x16x32_bf16 v[208:211], v[52:55], a[160:163], v[208:211]
    ds_read_b64_tr_b16 v[88:89], v22 offset:24576
    v_cvt_pk_bf16_f32 v109, v110, v111
    v_mfma_f32_16x16x32_bf16 v[212:215], v[52:55], a[164:167], v[212:215]
    ds_read_b64_tr_b16 v[90:91], v22 offset:25600
    v_cvt_pk_bf16_f32 v110, v112, v113
    v_mfma_f32_16x16x32_bf16 v[216:219], v[52:55], a[168:171], v[216:219]
    ds_read_b64_tr_b16 v[92:93], v23 offset:24576
    v_cvt_pk_bf16_f32 v111, v114, v115
    v_mfma_f32_16x16x32_bf16 v[220:223], v[52:55], a[172:175], v[220:223]
    ds_read_b64_tr_b16 v[94:95], v23 offset:25600
    v_mfma_f32_16x16x32_bf16 v[224:227], v[56:59], a[160:163], v[224:227]
    v_mfma_f32_16x16x32_bf16 v[112:115], a[224:227], v[108:111], 0
    v_mfma_f32_16x16x32_bf16 v[120:123], a[244:247], v[108:111], 0
    v_mfma_f32_16x16x32_bf16 v[228:231], v[56:59], a[164:167], v[228:231]
    v_mfma_f32_16x16x32_bf16 v[232:235], v[56:59], a[168:171], v[232:235]
    v_mfma_f32_16x16x32_bf16 v[236:239], v[56:59], a[172:175], v[236:239]
    v_mfma_f32_16x16x32_bf16 v[240:243], v[60:63], a[160:163], v[240:243]
    v_mfma_f32_16x16x32_bf16 v[244:247], v[60:63], a[164:167], v[244:247]
    v_mfma_f32_16x16x32_bf16 v[248:251], v[60:63], a[168:171], v[248:251]
    v_min_u32 v14, 15, v1
    v_lshlrev_b32 v14, 7, v14
    s_lshl2_add_u32 s100, s2, s28
    s_mul_i32 s100, s100, 2048
    v_add_u32 v14, s100, v14
    global_load_dword v3, v14, s[62:63]
    v_mfma_f32_16x16x32_bf16 v[252:255], v[60:63], a[172:175], v[252:255]
    v_rcp_f32 v116, v112
    s_waitcnt lgkmcnt(12)
    v_mfma_f32_16x16x32_bf16 v[128:131], v[64:67], a[176:179], v[128:131]
    v_mul_f32 v120, v116, v120
    v_mul_f32 v121, v116, v121
    v_mfma_f32_16x16x32_bf16 v[132:135], v[64:67], a[180:183], v[132:135]
    v_mul_f32 v122, v116, v122
    v_mul_f32 v123, v116, v123
    v_mfma_f32_16x16x32_bf16 v[136:139], v[64:67], a[184:187], v[136:139]
    v_cvt_pk_bf16_f32 v118, v120, v121
    v_cvt_pk_bf16_f32 v119, v122, v123
    v_mfma_f32_16x16x32_bf16 v[140:143], v[64:67], a[188:191], v[140:143]
    s_waitcnt vmcnt(19) lgkmcnt(0)
    s_barrier
    s_add_u32 s54, s52, 49152
    buffer_store_dwordx2 v[118:119], v26, s[20:23], s54 offen sc1
    v_mfma_f32_16x16x32_bf16 v[144:147], v[68:71], a[176:179], v[144:147]
    ds_read_b128 a[192:195], v12 offset:16384
    v_mfma_f32_16x16x32_bf16 v[148:151], v[68:71], a[180:183], v[148:151]
    ds_read_b128 a[196:199], v12 offset:18432
    v_mfma_f32_16x16x32_bf16 v[152:155], v[68:71], a[184:187], v[152:155]
    ds_read_b128 a[200:203], v12 offset:20480
    v_mfma_f32_16x16x32_bf16 v[156:159], v[68:71], a[188:191], v[156:159]
    ds_read_b128 a[204:207], v12 offset:22528
    v_mfma_f32_16x16x32_bf16 v[160:163], v[72:75], a[176:179], v[160:163]
    ds_read_b64_tr_b16 v[32:33], v16 offset:32768
    v_mfma_f32_16x16x32_bf16 v[164:167], v[72:75], a[180:183], v[164:167]
    ds_read_b64_tr_b16 v[34:35], v16 offset:33792
    v_mfma_f32_16x16x32_bf16 v[168:171], v[72:75], a[184:187], v[168:171]
    ds_read_b64_tr_b16 v[36:37], v17 offset:32768
    v_mfma_f32_16x16x32_bf16 v[172:175], v[72:75], a[188:191], v[172:175]
    ds_read_b64_tr_b16 v[38:39], v17 offset:33792
    v_mfma_f32_16x16x32_bf16 v[176:179], v[76:79], a[176:179], v[176:179]
    ds_read_b64_tr_b16 v[40:41], v18 offset:32768
    v_mfma_f32_16x16x32_bf16 v[180:183], v[76:79], a[180:183], v[180:183]
    ds_read_b64_tr_b16 v[42:43], v18 offset:33792
    v_mfma_f32_16x16x32_bf16 v[184:187], v[76:79], a[184:187], v[184:187]
    ds_read_b64_tr_b16 v[44:45], v19 offset:32768
    v_mfma_f32_16x16x32_bf16 v[188:191], v[76:79], a[188:191], v[188:191]
    ds_read_b64_tr_b16 v[46:47], v19 offset:33792
    v_mfma_f32_16x16x32_bf16 v[192:195], v[80:83], a[176:179], v[192:195]
    ds_read_b64_tr_b16 v[48:49], v20 offset:32768
    v_mfma_f32_16x16x32_bf16 v[196:199], v[80:83], a[180:183], v[196:199]
    ds_read_b64_tr_b16 v[50:51], v20 offset:33792
    v_mfma_f32_16x16x32_bf16 v[200:203], v[80:83], a[184:187], v[200:203]
    ds_read_b64_tr_b16 v[52:53], v21 offset:32768
    v_mfma_f32_16x16x32_bf16 v[204:207], v[80:83], a[188:191], v[204:207]
    ds_read_b64_tr_b16 v[54:55], v21 offset:33792
    v_mfma_f32_16x16x32_bf16 v[208:211], v[84:87], a[176:179], v[208:211]
    ds_read_b64_tr_b16 v[56:57], v22 offset:32768
    v_mfma_f32_16x16x32_bf16 v[212:215], v[84:87], a[180:183], v[212:215]
    ds_read_b64_tr_b16 v[58:59], v22 offset:33792
    v_mfma_f32_16x16x32_bf16 v[216:219], v[84:87], a[184:187], v[216:219]
    ds_read_b64_tr_b16 v[60:61], v23 offset:32768
    v_mfma_f32_16x16x32_bf16 v[220:223], v[84:87], a[188:191], v[220:223]
    ds_read_b64_tr_b16 v[62:63], v23 offset:33792
    v_mfma_f32_16x16x32_bf16 v[224:227], v[88:91], a[176:179], v[224:227]
    v_mfma_f32_16x16x32_bf16 v[228:231], v[88:91], a[180:183], v[228:231]
    v_mfma_f32_16x16x32_bf16 v[232:235], v[88:91], a[184:187], v[232:235]
    v_mfma_f32_16x16x32_bf16 v[236:239], v[88:91], a[188:191], v[236:239]
    v_mfma_f32_16x16x32_bf16 v[240:243], v[92:95], a[176:179], v[240:243]
    s_mov_b32 s12, s66
    v_mfma_f32_16x16x32_bf16 v[244:247], v[92:95], a[180:183], v[244:247]
    s_mov_b32 s13, s67
    v_mfma_f32_16x16x32_bf16 v[248:251], v[92:95], a[184:187], v[248:251]
    v_mfma_f32_16x16x32_bf16 v[252:255], v[92:95], a[188:191], v[252:255]
    v_bfe_u32 v14, v1, 1, 4
    v_lshlrev_b32 v14, 13, v14
    v_and_b32 v15, 1, v1
    v_lshl_add_u32 v14, v15, 7, v14
    s_lshl2_add_u32 s100, s30, s28
    s_lshl_b32 s100, s100, 17
    s_add_u32 s100, s100, s37
    v_add_u32 v14, s100, v14
    global_load_dword v3, v14, s[66:67]
    s_waitcnt lgkmcnt(12)
    v_mfma_f32_16x16x32_bf16 v[128:131], v[32:35], a[192:195], v[128:131]
    ds_read_b128 a[208:211], v13 offset:16384
    v_mfma_f32_16x16x32_bf16 v[132:135], v[32:35], a[196:199], v[132:135]
    s_bfe_u32 s45, s1, 196616
    ds_read_b128 a[212:215], v13 offset:18432
    v_mfma_f32_16x16x32_bf16 v[136:139], v[32:35], a[200:203], v[136:139]
    s_lshl_b32 s45, s45, 7
    ds_read_b128 a[216:219], v13 offset:20480
    v_mfma_f32_16x16x32_bf16 v[140:143], v[32:35], a[204:207], v[140:143]
    s_lshl_b32 s36, s45, 12
    ds_read_b128 a[220:223], v13 offset:22528
    v_mfma_f32_16x16x32_bf16 v[144:147], v[36:39], a[192:195], v[144:147]
    s_add_u32 s36, s36, s37
    ds_read_b64_tr_b16 v[64:65], v16 offset:40960
    v_mfma_f32_16x16x32_bf16 v[148:151], v[36:39], a[196:199], v[148:151]
    s_add_u32 m0, s39, 16384
    ds_read_b64_tr_b16 v[66:67], v16 offset:41984
    v_mfma_f32_16x16x32_bf16 v[152:155], v[36:39], a[200:203], v[152:155]
    buffer_load_dwordx4 v10, s[16:19], s36 offen lds
    v_mfma_f32_16x16x32_bf16 v[156:159], v[36:39], a[204:207], v[156:159]
    s_waitcnt lgkmcnt(6)
    ds_read_b64_tr_b16 v[68:69], v17 offset:40960
    v_mfma_f32_16x16x32_bf16 v[160:163], v[40:43], a[192:195], v[160:163]
    ds_read_b64_tr_b16 v[70:71], v17 offset:41984
    v_mfma_f32_16x16x32_bf16 v[164:167], v[40:43], a[196:199], v[164:167]
    ds_read_b64_tr_b16 v[72:73], v18 offset:40960
    v_mfma_f32_16x16x32_bf16 v[168:171], v[40:43], a[200:203], v[168:171]
    buffer_load_dwordx4 v11, s[16:19], s36 offen offset:1024 lds
    s_bfe_u32 s45, s1, 196620
    s_lshl_b32 s45, s45, 7
    v_mfma_f32_16x16x32_bf16 v[172:175], v[40:43], a[204:207], v[172:175]
    s_lshl_b32 s36, s45, 12
    ds_read_b64_tr_b16 v[74:75], v18 offset:41984
    v_mfma_f32_16x16x32_bf16 v[176:179], v[44:47], a[192:195], v[176:179]
    s_add_u32 s36, s36, s37
    ds_read_b64_tr_b16 v[76:77], v19 offset:40960
    v_mfma_f32_16x16x32_bf16 v[180:183], v[44:47], a[196:199], v[180:183]
    s_add_u32 m0, s39, 24576
    ds_read_b64_tr_b16 v[78:79], v19 offset:41984
    v_mfma_f32_16x16x32_bf16 v[184:187], v[44:47], a[200:203], v[184:187]
    buffer_load_dwordx4 v10, s[16:19], s36 offen lds
    v_mfma_f32_16x16x32_bf16 v[188:191], v[44:47], a[204:207], v[188:191]
    ds_read_b64_tr_b16 v[80:81], v20 offset:40960
    v_mfma_f32_16x16x32_bf16 v[192:195], v[48:51], a[192:195], v[192:195]
    ds_read_b64_tr_b16 v[82:83], v20 offset:41984
    v_mfma_f32_16x16x32_bf16 v[196:199], v[48:51], a[196:199], v[196:199]
    ds_read_b64_tr_b16 v[84:85], v21 offset:40960
    v_mfma_f32_16x16x32_bf16 v[200:203], v[48:51], a[200:203], v[200:203]
    buffer_load_dwordx4 v11, s[16:19], s36 offen offset:1024 lds
    v_mfma_f32_16x16x32_bf16 v[204:207], v[48:51], a[204:207], v[204:207]
    ds_read_b64_tr_b16 v[86:87], v21 offset:41984
    v_mfma_f32_16x16x32_bf16 v[208:211], v[52:55], a[192:195], v[208:211]
    s_add_u32 s32, s30, s29
    ds_read_b64_tr_b16 v[88:89], v22 offset:40960
    v_mfma_f32_16x16x32_bf16 v[212:215], v[52:55], a[196:199], v[212:215]
    s_and_b32 s32, s32, 7
    ds_read_b64_tr_b16 v[90:91], v22 offset:41984
    v_mfma_f32_16x16x32_bf16 v[216:219], v[52:55], a[200:203], v[216:219]
    s_mul_i32 s32, s32, 0x11111111
    ds_read_b64_tr_b16 v[92:93], v23 offset:40960
    v_mfma_f32_16x16x32_bf16 v[220:223], v[52:55], a[204:207], v[220:223]
    s_add_u32 s32, s32, 0x76543210
    ds_read_b64_tr_b16 v[94:95], v23 offset:41984
    v_mfma_f32_16x16x32_bf16 v[224:227], v[56:59], a[192:195], v[224:227]
    v_mfma_f32_16x16x32_bf16 v[228:231], v[56:59], a[196:199], v[228:231]
    v_mfma_f32_16x16x32_bf16 v[232:235], v[56:59], a[200:203], v[232:235]
    v_mfma_f32_16x16x32_bf16 v[236:239], v[56:59], a[204:207], v[236:239]
    v_mfma_f32_16x16x32_bf16 v[240:243], v[60:63], a[192:195], v[240:243]
    v_mfma_f32_16x16x32_bf16 v[244:247], v[60:63], a[196:199], v[244:247]
    v_mfma_f32_16x16x32_bf16 v[248:251], v[60:63], a[200:203], v[248:251]
    v_mfma_f32_16x16x32_bf16 v[252:255], v[60:63], a[204:207], v[252:255]
    s_waitcnt lgkmcnt(12)
    v_mfma_f32_16x16x32_bf16 v[128:131], v[64:67], a[208:211], v[128:131]
    v_mfma_f32_16x16x32_bf16 v[132:135], v[64:67], a[212:215], v[132:135]
    v_mfma_f32_16x16x32_bf16 v[136:139], v[64:67], a[216:219], v[136:139]
    v_mfma_f32_16x16x32_bf16 v[140:143], v[64:67], a[220:223], v[140:143]
    s_waitcnt vmcnt(5) lgkmcnt(0)
    s_barrier
    v_mfma_f32_16x16x32_bf16 v[144:147], v[68:71], a[208:211], v[144:147]
    ds_read_b128 a[224:227], v12 offset:0
    s_cmp_lg_u32 s28, 0
    s_cbranch_scc1 SG2
    s_lshr_b32 s100, s53, 2
    v_mov_b32 v124, s100
    s_and_b32 s100, s53, 3
    v_lshl_add_u32 v125, v1, 2, s100
    v_lshl_add_u32 v126, v125, 3, v124
    v_lshlrev_b32 v126, 9, v126
    s_and_b32 s100, s29, 7
    s_lshl_b32 s100, s100, 2
    s_add_u32 s100, s100, 57671744
    v_mov_b32 v124, s3
    s_mov_b64 exec, 0xff
    buffer_store_dword v124, v126, s[20:23], s100 offen sc1
    s_mov_b64 exec, -1
SG2:
    v_mfma_f32_16x16x32_bf16 v[148:151], v[68:71], a[212:215], v[148:151]
    ds_read_b128 a[228:231], v12 offset:2048
    v_mfma_f32_16x16x32_bf16 v[152:155], v[68:71], a[216:219], v[152:155]
    ds_read_b128 a[232:235], v12 offset:4096
    v_mfma_f32_16x16x32_bf16 v[156:159], v[68:71], a[220:223], v[156:159]
    ds_read_b128 a[236:239], v12 offset:6144
    v_mfma_f32_16x16x32_bf16 v[160:163], v[72:75], a[208:211], v[160:163]
    ds_read_b64_tr_b16 v[32:33], v16 offset:49152
    v_mfma_f32_16x16x32_bf16 v[164:167], v[72:75], a[212:215], v[164:167]
    ds_read_b64_tr_b16 v[34:35], v16 offset:50176
    v_mfma_f32_16x16x32_bf16 v[168:171], v[72:75], a[216:219], v[168:171]
    ds_read_b64_tr_b16 v[36:37], v17 offset:49152
    v_mfma_f32_16x16x32_bf16 v[172:175], v[72:75], a[220:223], v[172:175]
    ds_read_b64_tr_b16 v[38:39], v17 offset:50176
    v_mfma_f32_16x16x32_bf16 v[176:179], v[76:79], a[208:211], v[176:179]
    ds_read_b64_tr_b16 v[40:41], v18 offset:49152
    v_mfma_f32_16x16x32_bf16 v[180:183], v[76:79], a[212:215], v[180:183]
    ds_read_b64_tr_b16 v[42:43], v18 offset:50176
    v_mfma_f32_16x16x32_bf16 v[184:187], v[76:79], a[216:219], v[184:187]
    ds_read_b64_tr_b16 v[44:45], v19 offset:49152
    v_mfma_f32_16x16x32_bf16 v[188:191], v[76:79], a[220:223], v[188:191]
    ds_read_b64_tr_b16 v[46:47], v19 offset:50176
    v_mfma_f32_16x16x32_bf16 v[192:195], v[80:83], a[208:211], v[192:195]
    ds_read_b64_tr_b16 v[48:49], v20 offset:49152
    v_mfma_f32_16x16x32_bf16 v[196:199], v[80:83], a[212:215], v[196:199]
    ds_read_b64_tr_b16 v[50:51], v20 offset:50176
    v_mfma_f32_16x16x32_bf16 v[200:203], v[80:83], a[216:219], v[200:203]
    ds_read_b64_tr_b16 v[52:53], v21 offset:49152
    v_mfma_f32_16x16x32_bf16 v[204:207], v[80:83], a[220:223], v[204:207]
    ds_read_b64_tr_b16 v[54:55], v21 offset:50176
    v_mfma_f32_16x16x32_bf16 v[208:211], v[84:87], a[208:211], v[208:211]
    s_lshl_b32 s41, s28, 15
    ds_read_b64_tr_b16 v[56:57], v22 offset:49152
    v_mfma_f32_16x16x32_bf16 v[212:215], v[84:87], a[212:215], v[212:215]
    s_sub_u32 s41, s33, s41
    ds_read_b64_tr_b16 v[58:59], v22 offset:50176
    v_mfma_f32_16x16x32_bf16 v[216:219], v[84:87], a[216:219], v[216:219]
    s_add_u32 s41, s41, 114688
    ds_read_b64_tr_b16 v[60:61], v23 offset:49152
    v_mfma_f32_16x16x32_bf16 v[220:223], v[84:87], a[220:223], v[220:223]
    ds_read_b64_tr_b16 v[62:63], v23 offset:50176
    v_mfma_f32_16x16x32_bf16 v[224:227], v[88:91], a[208:211], v[224:227]
    v_mfma_f32_16x16x32_bf16 v[228:231], v[88:91], a[212:215], v[228:231]
    v_mfma_f32_16x16x32_bf16 v[232:235], v[88:91], a[216:219], v[232:235]
    v_mfma_f32_16x16x32_bf16 v[236:239], v[88:91], a[220:223], v[236:239]
    v_mfma_f32_16x16x32_bf16 v[240:243], v[92:95], a[208:211], v[240:243]
    v_mfma_f32_16x16x32_bf16 v[244:247], v[92:95], a[212:215], v[244:247]
    v_mfma_f32_16x16x32_bf16 v[248:251], v[92:95], a[216:219], v[248:251]
    v_mfma_f32_16x16x32_bf16 v[252:255], v[92:95], a[220:223], v[252:255]
    s_waitcnt lgkmcnt(12)
    v_mfma_f32_16x16x32_bf16 v[128:131], v[32:35], a[224:227], v[128:131]
    ds_read_b128 a[240:243], v13 offset:0
    v_mfma_f32_16x16x32_bf16 v[132:135], v[32:35], a[228:231], v[132:135]
    s_bfe_u32 s45, s1, 196624
    ds_read_b128 a[244:247], v13 offset:2048
    v_mfma_f32_16x16x32_bf16 v[136:139], v[32:35], a[232:235], v[136:139]
    s_lshl_b32 s45, s45, 7
    ds_read_b128 a[248:251], v13 offset:4096
    v_mfma_f32_16x16x32_bf16 v[140:143], v[32:35], a[236:239], v[140:143]
    s_lshl_b32 s36, s45, 12
    ds_read_b128 a[252:255], v13 offset:6144
    v_mfma_f32_16x16x32_bf16 v[144:147], v[36:39], a[224:227], v[144:147]
    s_add_u32 s36, s36, s37
    ds_read_b64_tr_b16 v[64:65], v16 offset:57344
    v_mfma_f32_16x16x32_bf16 v[148:151], v[36:39], a[228:231], v[148:151]
    s_add_u32 m0, s39, 32768
    ds_read_b64_tr_b16 v[66:67], v16 offset:58368
    v_mfma_f32_16x16x32_bf16 v[152:155], v[36:39], a[232:235], v[152:155]
    buffer_load_dwordx4 v10, s[16:19], s36 offen lds
    v_mfma_f32_16x16x32_bf16 v[156:159], v[36:39], a[236:239], v[156:159]
    s_waitcnt lgkmcnt(6)
    ds_read_b64_tr_b16 v[68:69], v17 offset:57344
    v_mfma_f32_16x16x32_bf16 v[160:163], v[40:43], a[224:227], v[160:163]
    ds_read_b64_tr_b16 v[70:71], v17 offset:58368
    v_mfma_f32_16x16x32_bf16 v[164:167], v[40:43], a[228:231], v[164:167]
    ds_read_b64_tr_b16 v[72:73], v18 offset:57344
    v_mfma_f32_16x16x32_bf16 v[168:171], v[40:43], a[232:235], v[168:171]
    buffer_load_dwordx4 v11, s[16:19], s36 offen offset:1024 lds
    s_bfe_u32 s45, s1, 196628
    s_lshl_b32 s45, s45, 7
    v_mfma_f32_16x16x32_bf16 v[172:175], v[40:43], a[236:239], v[172:175]
    s_lshl_b32 s36, s45, 12
    ds_read_b64_tr_b16 v[74:75], v18 offset:58368
    v_mfma_f32_16x16x32_bf16 v[176:179], v[44:47], a[224:227], v[176:179]
    s_add_u32 s36, s36, s37
    ds_read_b64_tr_b16 v[76:77], v19 offset:57344
    v_mfma_f32_16x16x32_bf16 v[180:183], v[44:47], a[228:231], v[180:183]
    s_add_u32 m0, s39, 40960
    ds_read_b64_tr_b16 v[78:79], v19 offset:58368
    v_mfma_f32_16x16x32_bf16 v[184:187], v[44:47], a[232:235], v[184:187]
    buffer_load_dwordx4 v10, s[16:19], s36 offen lds
    v_mfma_f32_16x16x32_bf16 v[188:191], v[44:47], a[236:239], v[188:191]
    ds_read_b64_tr_b16 v[80:81], v20 offset:57344
    v_mfma_f32_16x16x32_bf16 v[192:195], v[48:51], a[224:227], v[192:195]
    ds_read_b64_tr_b16 v[82:83], v20 offset:58368
    v_mfma_f32_16x16x32_bf16 v[196:199], v[48:51], a[228:231], v[196:199]
    ds_read_b64_tr_b16 v[84:85], v21 offset:57344
    v_mfma_f32_16x16x32_bf16 v[200:203], v[48:51], a[232:235], v[200:203]
    buffer_load_dwordx4 v11, s[16:19], s36 offen offset:1024 lds
    v_mfma_f32_16x16x32_bf16 v[204:207], v[48:51], a[236:239], v[204:207]
    ds_read_b64_tr_b16 v[86:87], v21 offset:58368
    v_mfma_f32_16x16x32_bf16 v[208:211], v[52:55], a[224:227], v[208:211]
    ds_read_b64_tr_b16 v[88:89], v22 offset:57344
    v_mfma_f32_16x16x32_bf16 v[212:215], v[52:55], a[228:231], v[212:215]
    ds_read_b64_tr_b16 v[90:91], v22 offset:58368
    v_mfma_f32_16x16x32_bf16 v[216:219], v[52:55], a[232:235], v[216:219]
    ds_read_b64_tr_b16 v[92:93], v23 offset:57344
    v_mfma_f32_16x16x32_bf16 v[220:223], v[52:55], a[236:239], v[220:223]
    ds_read_b64_tr_b16 v[94:95], v23 offset:58368
    v_mfma_f32_16x16x32_bf16 v[224:227], v[56:59], a[224:227], v[224:227]
    v_mfma_f32_16x16x32_bf16 v[228:231], v[56:59], a[228:231], v[228:231]
    v_mfma_f32_16x16x32_bf16 v[232:235], v[56:59], a[232:235], v[232:235]
    v_mfma_f32_16x16x32_bf16 v[236:239], v[56:59], a[236:239], v[236:239]
    v_mfma_f32_16x16x32_bf16 v[240:243], v[60:63], a[224:227], v[240:243]
    v_mfma_f32_16x16x32_bf16 v[244:247], v[60:63], a[228:231], v[244:247]
    v_mfma_f32_16x16x32_bf16 v[248:251], v[60:63], a[232:235], v[248:251]
    v_mfma_f32_16x16x32_bf16 v[252:255], v[60:63], a[236:239], v[252:255]
    s_waitcnt lgkmcnt(12)
    v_mfma_f32_16x16x32_bf16 v[128:131], v[64:67], a[240:243], v[128:131]
    v_mfma_f32_16x16x32_bf16 v[132:135], v[64:67], a[244:247], v[132:135]
    s_lshl2_add_u32 s40, s29, s28
    v_mfma_f32_16x16x32_bf16 v[136:139], v[64:67], a[248:251], v[136:139]
    s_lshl_b32 s40, s40, 15
    s_mov_b32 s8, s60
    s_mov_b32 s9, s61
    s_mov_b32 s10, 524288
    s_and_b32 s100, s29, 7
    s_cmp_lg_u32 s100, 0
    s_cbranch_scc1 RL_a
    s_lshr_b32 s100, s29, 1
    s_add_u32 s100, s100, s28
    s_lshl_b32 s100, s100, 15
    s_lshl_b32 s101, s30, 7
    s_add_u32 s100, s100, s101
    s_add_u32 m0, s38, 4096
    s_nop 0
    buffer_load_dwordx4 v4, s[8:11], s100 offen offset:0 lds
    buffer_load_dwordx4 v5, s[8:11], s100 offen offset:1024 lds
    buffer_load_dwordx4 v6, s[8:11], s100 offen offset:2048 lds
    buffer_load_dwordx4 v7, s[8:11], s100 offen offset:3072 lds
RL_a:
    s_mov_b32 s8, s72
    s_mov_b32 s9, s73
    s_mov_b32 s10, 4194304
    v_mfma_f32_16x16x32_bf16 v[140:143], v[64:67], a[252:255], v[140:143]
    s_waitcnt vmcnt(11) lgkmcnt(0)
    s_barrier
    s_lshl_b32 s101, s30, 7
    v_mfma_f32_16x16x32_bf16 v[144:147], v[68:71], a[240:243], v[144:147]
    s_add_u32 s40, s40, s101
    ds_read_b64_tr_b16 v[32:33], v28 offset:0
    v_mfma_f32_16x16x32_bf16 v[148:151], v[68:71], a[244:247], v[148:151]
    s_mov_b32 m0, s38
    ds_read_b64_tr_b16 v[34:35], v28 offset:512
    v_mfma_f32_16x16x32_bf16 v[152:155], v[68:71], a[248:251], v[152:155]
    buffer_load_dwordx4 v4, s[8:11], s40 offen offset:0 lds
    v_mfma_f32_16x16x32_bf16 v[156:159], v[68:71], a[252:255], v[156:159]
    ds_read_b64_tr_b16 v[36:37], v29 offset:0
    v_mfma_f32_16x16x32_bf16 v[160:163], v[72:75], a[240:243], v[160:163]
    ds_read_b64_tr_b16 v[38:39], v29 offset:512
    v_mfma_f32_16x16x32_bf16 v[164:167], v[72:75], a[244:247], v[164:167]
    ds_read_b64_tr_b16 v[40:41], v30 offset:0
    v_mfma_f32_16x16x32_bf16 v[168:171], v[72:75], a[248:251], v[168:171]
    buffer_load_dwordx4 v5, s[8:11], s40 offen offset:1024 lds
    v_mfma_f32_16x16x32_bf16 v[172:175], v[72:75], a[252:255], v[172:175]
    ds_read_b64_tr_b16 v[42:43], v30 offset:512
    v_mfma_f32_16x16x32_bf16 v[176:179], v[76:79], a[240:243], v[176:179]
    ds_read_b64_tr_b16 v[44:45], v31 offset:0
    v_mfma_f32_16x16x32_bf16 v[180:183], v[76:79], a[244:247], v[180:183]
    ds_read_b64_tr_b16 v[46:47], v31 offset:512
    v_mfma_f32_16x16x32_bf16 v[184:187], v[76:79], a[248:251], v[184:187]
    buffer_load_dwordx4 v6, s[8:11], s40 offen offset:2048 lds
    v_mfma_f32_16x16x32_bf16 v[188:191], v[76:79], a[252:255], v[188:191]
    v_mfma_f32_16x16x32_bf16 v[192:195], v[80:83], a[240:243], v[192:195]
    v_mfma_f32_16x16x32_bf16 v[196:199], v[80:83], a[244:247], v[196:199]
    v_mfma_f32_16x16x32_bf16 v[200:203], v[80:83], a[248:251], v[200:203]
    buffer_load_dwordx4 v7, s[8:11], s40 offen offset:3072 lds
    v_mfma_f32_16x16x32_bf16 v[204:207], v[80:83], a[252:255], v[204:207]
    v_mfma_f32_16x16x32_bf16 v[208:211], v[84:87], a[240:243], v[208:211]
    v_mfma_f32_16x16x32_bf16 v[212:215], v[84:87], a[244:247], v[212:215]
    v_mfma_f32_16x16x32_bf16 v[216:219], v[84:87], a[248:251], v[216:219]
    v_mfma_f32_16x16x32_bf16 v[220:223], v[84:87], a[252:255], v[220:223]
    v_mfma_f32_16x16x32_bf16 v[224:227], v[88:91], a[240:243], v[224:227]
    v_mfma_f32_16x16x32_bf16 v[228:231], v[88:91], a[244:247], v[228:231]
    v_mfma_f32_16x16x32_bf16 v[232:235], v[88:91], a[248:251], v[232:235]
    v_mfma_f32_16x16x32_bf16 v[236:239], v[88:91], a[252:255], v[236:239]
    v_mfma_f32_16x16x32_bf16 v[240:243], v[92:95], a[240:243], v[240:243]
    v_mfma_f32_16x16x32_bf16 v[244:247], v[92:95], a[244:247], v[244:247]
    v_mfma_f32_16x16x32_bf16 v[248:251], v[92:95], a[248:251], v[248:251]
    v_mfma_f32_16x16x32_bf16 v[252:255], v[92:95], a[252:255], v[252:255]
    s_waitcnt lgkmcnt(0)
    v_mfma_f32_16x16x32_bf16 v[64:67], a[0:3], v[32:35], 0
    s_bfe_u32 s45, s1, 196632
    s_lshl_b32 s45, s45, 7
    ds_read_b64_tr_b16 v[48:49], v28 offset:4096
    v_mfma_f32_16x16x32_bf16 v[68:71], a[4:7], v[32:35], 0
    s_lshl_b32 s36, s45, 12
    ds_read_b64_tr_b16 v[50:51], v28 offset:4608
    v_mfma_f32_16x16x32_bf16 v[72:75], a[8:11], v[32:35], 0
    s_add_u32 s36, s36, s37
    ds_read_b64_tr_b16 v[52:53], v29 offset:4096
    v_mul_f32 v128, s50, v128
    v_mfma_f32_16x16x32_bf16 v[76:79], a[12:15], v[32:35], 0
    s_add_u32 m0, s39, 49152
    ds_read_b64_tr_b16 v[54:55], v29 offset:4608
    v_mul_f32 v129, s50, v129
    v_mfma_f32_16x16x32_bf16 v[80:83], a[0:3], v[36:39], 0
    buffer_load_dwordx4 v10, s[16:19], s36 offen lds
    v_mul_f32 v130, s50, v130
    v_mfma_f32_16x16x32_bf16 v[84:87], a[4:7], v[36:39], 0
    ds_read_b64_tr_b16 v[56:57], v30 offset:4096
    v_mul_f32 v131, s50, v131
    v_mfma_f32_16x16x32_bf16 v[88:91], a[8:11], v[36:39], 0
    ds_read_b64_tr_b16 v[58:59], v30 offset:4608
    v_mul_f32 v144, s50, v144
    v_mfma_f32_16x16x32_bf16 v[92:95], a[12:15], v[36:39], 0
    ds_read_b64_tr_b16 v[60:61], v31 offset:4096
    v_mul_f32 v145, s50, v145
    v_mfma_f32_16x16x32_bf16 v[96:99], a[0:3], v[40:43], 0
    ds_read_b64_tr_b16 v[62:63], v31 offset:4608
    v_mul_f32 v146, s50, v146
    v_mfma_f32_16x16x32_bf16 v[100:103], a[4:7], v[40:43], 0
    v_mul_f32 v147, s50, v147
    v_cvt_pk_bf16_f32 v24, v128, v129
    v_mfma_f32_16x16x32_bf16 v[104:107], a[8:11], v[40:43], 0
    buffer_load_dwordx4 v11, s[16:19], s36 offen offset:1024 lds
    v_cvt_pk_bf16_f32 v25, v130, v131
    v_mfma_f32_16x16x32_bf16 v[108:111], a[12:15], v[40:43], 0
    v_cvt_pk_bf16_f32 v26, v144, v145
    v_cvt_pk_bf16_f32 v27, v146, v147
    v_mfma_f32_16x16x32_bf16 v[112:115], a[0:3], v[44:47], 0
    s_add_u32 s54, s46, 0
    buffer_store_dwordx4 v[24:27], v2, s[20:23], s54 offen sc1
    v_mfma_f32_16x16x32_bf16 v[116:119], a[4:7], v[44:47], 0
    v_mfma_f32_16x16x32_bf16 v[120:123], a[8:11], v[44:47], 0
    v_mfma_f32_16x16x32_bf16 v[124:127], a[12:15], v[44:47], 0
    s_waitcnt lgkmcnt(0)
    s_bfe_u32 s45, s1, 196636
    v_mfma_f32_16x16x32_bf16 v[64:67], a[16:19], v[48:51], v[64:67]
    s_lshl_b32 s45, s45, 7
    ds_read_b64_tr_b16 v[32:33], v28 offset:8192
    v_mfma_f32_16x16x32_bf16 v[68:71], a[20:23], v[48:51], v[68:71]
    s_lshl_b32 s36, s45, 12
    ds_read_b64_tr_b16 v[34:35], v28 offset:8704
    v_mfma_f32_16x16x32_bf16 v[72:75], a[24:27], v[48:51], v[72:75]
    s_add_u32 s36, s36, s37
    ds_read_b64_tr_b16 v[36:37], v29 offset:8192
    v_mfma_f32_16x16x32_bf16 v[76:79], a[28:31], v[48:51], v[76:79]
    s_add_u32 m0, s39, 57344
    ds_read_b64_tr_b16 v[38:39], v29 offset:8704
    v_mfma_f32_16x16x32_bf16 v[80:83], a[16:19], v[52:55], v[80:83]
    buffer_load_dwordx4 v10, s[16:19], s36 offen lds
    v_mfma_f32_16x16x32_bf16 v[84:87], a[20:23], v[52:55], v[84:87]
    ds_read_b64_tr_b16 v[40:41], v30 offset:8192
    v_mfma_f32_16x16x32_bf16 v[88:91], a[24:27], v[52:55], v[88:91]
    ds_read_b64_tr_b16 v[42:43], v30 offset:8704
    v_mfma_f32_16x16x32_bf16 v[92:95], a[28:31], v[52:55], v[92:95]
    ds_read_b64_tr_b16 v[44:45], v31 offset:8192
    v_mfma_f32_16x16x32_bf16 v[96:99], a[16:19], v[56:59], v[96:99]
    ds_read_b64_tr_b16 v[46:47], v31 offset:8704
    v_mfma_f32_16x16x32_bf16 v[100:103], a[20:23], v[56:59], v[100:103]
    v_mfma_f32_16x16x32_bf16 v[104:107], a[24:27], v[56:59], v[104:107]
    buffer_load_dwordx4 v11, s[16:19], s36 offen offset:1024 lds
    v_mfma_f32_16x16x32_bf16 v[108:111], a[28:31], v[56:59], v[108:111]
    v_mfma_f32_16x16x32_bf16 v[112:115], a[16:19], v[60:63], v[112:115]
    v_mfma_f32_16x16x32_bf16 v[116:119], a[20:23], v[60:63], v[116:119]
    v_mfma_f32_16x16x32_bf16 v[120:123], a[24:27], v[60:63], v[120:123]
    v_mfma_f32_16x16x32_bf16 v[124:127], a[28:31], v[60:63], v[124:127]
    s_waitcnt lgkmcnt(0)
    v_mfma_f32_16x16x32_bf16 v[64:67], a[32:35], v[32:35], v[64:67]
    s_bfe_u32 s35, s32, 196608
    ds_read_b64_tr_b16 v[48:49], v28 offset:12288
    v_mfma_f32_16x16x32_bf16 v[68:71], a[36:39], v[32:35], v[68:71]
    s_lshl_b32 s35, s35, 7
    ds_read_b64_tr_b16 v[50:51], v28 offset:12800
    v_mfma_f32_16x16x32_bf16 v[72:75], a[40:43], v[32:35], v[72:75]
    s_add_u32 s47, s33, s35
    ds_read_b64_tr_b16 v[52:53], v29 offset:12288
    v_mul_f32 v132, s50, v132
    v_mfma_f32_16x16x32_bf16 v[76:79], a[44:47], v[32:35], v[76:79]
    s_add_u32 m0, s38, 8192
    ds_read_b64_tr_b16 v[54:55], v29 offset:12800
    v_mul_f32 v133, s50, v133
    v_mfma_f32_16x16x32_bf16 v[80:83], a[32:35], v[36:39], v[80:83]
    buffer_load_dwordx4 v4, s[4:7], s47 offen offset:0 lds
    v_mul_f32 v134, s50, v134
    v_mfma_f32_16x16x32_bf16 v[84:87], a[36:39], v[36:39], v[84:87]
    ds_read_b64_tr_b16 v[56:57], v30 offset:12288
    v_mul_f32 v135, s50, v135
    v_mfma_f32_16x16x32_bf16 v[88:91], a[40:43], v[36:39], v[88:91]
    ds_read_b64_tr_b16 v[58:59], v30 offset:12800
    v_mul_f32 v148, s50, v148
    v_mfma_f32_16x16x32_bf16 v[92:95], a[44:47], v[36:39], v[92:95]
    ds_read_b64_tr_b16 v[60:61], v31 offset:12288
    v_mul_f32 v149, s50, v149
    v_mfma_f32_16x16x32_bf16 v[96:99], a[32:35], v[40:43], v[96:99]
    ds_read_b64_tr_b16 v[62:63], v31 offset:12800
    v_mul_f32 v150, s50, v150
    v_mfma_f32_16x16x32_bf16 v[100:103], a[36:39], v[40:43], v[100:103]
    v_mul_f32 v151, s50, v151
    v_cvt_pk_bf16_f32 v24, v132, v133
    v_mfma_f32_16x16x32_bf16 v[104:107], a[40:43], v[40:43], v[104:107]
    buffer_load_dwordx4 v5, s[4:7], s47 offen offset:1024 lds
    v_cvt_pk_bf16_f32 v25, v134, v135
    v_mfma_f32_16x16x32_bf16 v[108:111], a[44:47], v[40:43], v[108:111]
    v_cvt_pk_bf16_f32 v26, v148, v149
    v_cvt_pk_bf16_f32 v27, v150, v151
    v_mfma_f32_16x16x32_bf16 v[112:115], a[32:35], v[44:47], v[112:115]
    s_add_u32 s54, s46, 4096
    buffer_store_dwordx4 v[24:27], v2, s[20:23], s54 offen sc1
    v_mfma_f32_16x16x32_bf16 v[116:119], a[36:39], v[44:47], v[116:119]
    v_mfma_f32_16x16x32_bf16 v[120:123], a[40:43], v[44:47], v[120:123]
    v_mul_f32 v136, s50, v136
    v_mul_f32 v137, s50, v137
    v_mfma_f32_16x16x32_bf16 v[124:127], a[44:47], v[44:47], v[124:127]
    s_waitcnt vmcnt(16) lgkmcnt(0)
    s_barrier
    v_mul_f32 v138, s50, v138
    v_mul_f32 v139, s50, v139
    v_mfma_f32_16x16x32_bf16 v[64:67], a[48:51], v[48:51], v[64:67]
    ds_read_b64_tr_b16 v[32:33], v28 offset:16384
    v_mul_f32 v152, s50, v152
    v_mfma_f32_16x16x32_bf16 v[68:71], a[52:55], v[48:51], v[68:71]
    ds_read_b64_tr_b16 v[34:35], v28 offset:16896
    v_mul_f32 v153, s50, v153
    v_mfma_f32_16x16x32_bf16 v[72:75], a[56:59], v[48:51], v[72:75]
    s_add_u32 s47, s41, s35
    ds_read_b64_tr_b16 v[36:37], v29 offset:16384
    v_mul_f32 v154, s50, v154
    v_mfma_f32_16x16x32_bf16 v[76:79], a[60:63], v[48:51], v[76:79]
    s_add_u32 m0, s38, 10240
    ds_read_b64_tr_b16 v[38:39], v29 offset:16896
    v_mul_f32 v155, s50, v155
    v_mfma_f32_16x16x32_bf16 v[80:83], a[48:51], v[52:55], v[80:83]
    buffer_load_dwordx4 v4, s[4:7], s47 offen offset:0 lds
    v_cvt_pk_bf16_f32 v24, v136, v137
    v_mfma_f32_16x16x32_bf16 v[84:87], a[52:55], v[52:55], v[84:87]
    ds_read_b64_tr_b16 v[40:41], v30 offset:16384
    v_cvt_pk_bf16_f32 v25, v138, v139
    v_mfma_f32_16x16x32_bf16 v[88:91], a[56:59], v[52:55], v[88:91]
    ds_read_b64_tr_b16 v[42:43], v30 offset:16896
    v_cvt_pk_bf16_f32 v26, v152, v153
    v_mfma_f32_16x16x32_bf16 v[92:95], a[60:63], v[52:55], v[92:95]
    ds_read_b64_tr_b16 v[44:45], v31 offset:16384
    v_cvt_pk_bf16_f32 v27, v154, v155
    v_mfma_f32_16x16x32_bf16 v[96:99], a[48:51], v[56:59], v[96:99]
    s_add_u32 s54, s46, 16384
    ds_read_b64_tr_b16 v[46:47], v31 offset:16896
    v_mfma_f32_16x16x32_bf16 v[100:103], a[52:55], v[56:59], v[100:103]
    buffer_store_dwordx4 v[24:27], v2, s[20:23], s54 offen sc1
    v_mfma_f32_16x16x32_bf16 v[104:107], a[56:59], v[56:59], v[104:107]
    buffer_load_dwordx4 v5, s[4:7], s47 offen offset:1024 lds
    v_mfma_f32_16x16x32_bf16 v[108:111], a[60:63], v[56:59], v[108:111]
    v_mfma_f32_16x16x32_bf16 v[112:115], a[48:51], v[60:63], v[112:115]
    v_mfma_f32_16x16x32_bf16 v[116:119], a[52:55], v[60:63], v[116:119]
    v_mfma_f32_16x16x32_bf16 v[120:123], a[56:59], v[60:63], v[120:123]
    v_mfma_f32_16x16x32_bf16 v[124:127], a[60:63], v[60:63], v[124:127]
    s_waitcnt lgkmcnt(0)
    v_mfma_f32_16x16x32_bf16 v[64:67], a[64:67], v[32:35], v[64:67]
    s_mov_b32 s45, 0
    s_lshl_b32 s36, s45, 12
    ds_read_b64_tr_b16 v[48:49], v28 offset:20480
    v_mfma_f32_16x16x32_bf16 v[68:71], a[68:71], v[32:35], v[68:71]
    s_add_u32 s36, s36, s37
    ds_read_b64_tr_b16 v[50:51], v28 offset:20992
    v_mfma_f32_16x16x32_bf16 v[72:75], a[72:75], v[32:35], v[72:75]
    s_add_u32 s36, s36, 128
    ds_read_b64_tr_b16 v[52:53], v29 offset:20480
    v_mul_f32 v140, s50, v140
    v_mfma_f32_16x16x32_bf16 v[76:79], a[76:79], v[32:35], v[76:79]
    s_add_u32 m0, s39, 0
    ds_read_b64_tr_b16 v[54:55], v29 offset:20992
    v_mul_f32 v141, s50, v141
    v_mfma_f32_16x16x32_bf16 v[80:83], a[64:67], v[36:39], v[80:83]
    buffer_load_dwordx4 v10, s[16:19], s36 offen lds
    v_mul_f32 v142, s50, v142
    v_mfma_f32_16x16x32_bf16 v[84:87], a[68:71], v[36:39], v[84:87]
    ds_read_b64_tr_b16 v[56:57], v30 offset:20480
    v_mul_f32 v143, s50, v143
    v_mfma_f32_16x16x32_bf16 v[88:91], a[72:75], v[36:39], v[88:91]
    ds_read_b64_tr_b16 v[58:59], v30 offset:20992
    v_mul_f32 v156, s50, v156
    v_mfma_f32_16x16x32_bf16 v[92:95], a[76:79], v[36:39], v[92:95]
    ds_read_b64_tr_b16 v[60:61], v31 offset:20480
    v_mul_f32 v157, s50, v157
    v_mfma_f32_16x16x32_bf16 v[96:99], a[64:67], v[40:43], v[96:99]
    ds_read_b64_tr_b16 v[62:63], v31 offset:20992
    v_mul_f32 v158, s50, v158
    v_mfma_f32_16x16x32_bf16 v[100:103], a[68:71], v[40:43], v[100:103]
    v_mul_f32 v159, s50, v159
    v_cvt_pk_bf16_f32 v24, v140, v141
    v_mfma_f32_16x16x32_bf16 v[104:107], a[72:75], v[40:43], v[104:107]
    buffer_load_dwordx4 v11, s[16:19], s36 offen offset:1024 lds
    v_cvt_pk_bf16_f32 v25, v142, v143
    v_mfma_f32_16x16x32_bf16 v[108:111], a[76:79], v[40:43], v[108:111]
    v_cvt_pk_bf16_f32 v26, v156, v157
    v_cvt_pk_bf16_f32 v27, v158, v159
    v_mfma_f32_16x16x32_bf16 v[112:115], a[64:67], v[44:47], v[112:115]
    s_add_u32 s54, s46, 20480
    buffer_store_dwordx4 v[24:27], v2, s[20:23], s54 offen sc1
    v_mfma_f32_16x16x32_bf16 v[116:119], a[68:71], v[44:47], v[116:119]
    v_mfma_f32_16x16x32_bf16 v[120:123], a[72:75], v[44:47], v[120:123]
    v_mfma_f32_16x16x32_bf16 v[124:127], a[76:79], v[44:47], v[124:127]
    s_waitcnt lgkmcnt(0)
    s_mov_b32 s45, 128
    v_mfma_f32_16x16x32_bf16 v[64:67], a[80:83], v[48:51], v[64:67]
    s_lshl_b32 s36, s45, 12
    ds_read_b64_tr_b16 v[32:33], v28 offset:24576
    v_mfma_f32_16x16x32_bf16 v[68:71], a[84:87], v[48:51], v[68:71]
    s_add_u32 s36, s36, s37
    ds_read_b64_tr_b16 v[34:35], v28 offset:25088
    v_mfma_f32_16x16x32_bf16 v[72:75], a[88:91], v[48:51], v[72:75]
    s_add_u32 s36, s36, 128
    ds_read_b64_tr_b16 v[36:37], v29 offset:24576
    v_mfma_f32_16x16x32_bf16 v[76:79], a[92:95], v[48:51], v[76:79]
    s_add_u32 m0, s39, 8192
    ds_read_b64_tr_b16 v[38:39], v29 offset:25088
    v_mfma_f32_16x16x32_bf16 v[80:83], a[80:83], v[52:55], v[80:83]
    buffer_load_dwordx4 v10, s[16:19], s36 offen lds
    v_mfma_f32_16x16x32_bf16 v[84:87], a[84:87], v[52:55], v[84:87]
    ds_read_b64_tr_b16 v[40:41], v30 offset:24576
    v_mfma_f32_16x16x32_bf16 v[88:91], a[88:91], v[52:55], v[88:91]
    ds_read_b64_tr_b16 v[42:43], v30 offset:25088
    v_mfma_f32_16x16x32_bf16 v[92:95], a[92:95], v[52:55], v[92:95]
    ds_read_b64_tr_b16 v[44:45], v31 offset:24576
    v_mfma_f32_16x16x32_bf16 v[96:99], a[80:83], v[56:59], v[96:99]
    ds_read_b64_tr_b16 v[46:47], v31 offset:25088
    v_mfma_f32_16x16x32_bf16 v[100:103], a[84:87], v[56:59], v[100:103]
    v_mfma_f32_16x16x32_bf16 v[104:107], a[88:91], v[56:59], v[104:107]
    buffer_load_dwordx4 v11, s[16:19], s36 offen offset:1024 lds
    v_mfma_f32_16x16x32_bf16 v[108:111], a[92:95], v[56:59], v[108:111]
    v_mfma_f32_16x16x32_bf16 v[112:115], a[80:83], v[60:63], v[112:115]
    v_mfma_f32_16x16x32_bf16 v[116:119], a[84:87], v[60:63], v[116:119]
    v_mfma_f32_16x16x32_bf16 v[120:123], a[88:91], v[60:63], v[120:123]
    v_mfma_f32_16x16x32_bf16 v[124:127], a[92:95], v[60:63], v[124:127]
    s_waitcnt lgkmcnt(0)
    v_mfma_f32_16x16x32_bf16 v[64:67], a[96:99], v[32:35], v[64:67]
    ds_read_b64_tr_b16 v[48:49], v28 offset:28672
    v_mfma_f32_16x16x32_bf16 v[68:71], a[100:103], v[32:35], v[68:71]
    ds_read_b64_tr_b16 v[50:51], v28 offset:29184
    v_mfma_f32_16x16x32_bf16 v[72:75], a[104:107], v[32:35], v[72:75]
    s_add_u32 s47, s34, s35
    ds_read_b64_tr_b16 v[52:53], v29 offset:28672
    v_mul_f32 v160, s50, v160
    v_mfma_f32_16x16x32_bf16 v[76:79], a[108:111], v[32:35], v[76:79]
    s_add_u32 m0, s38, 12288
    ds_read_b64_tr_b16 v[54:55], v29 offset:29184
    v_mul_f32 v161, s50, v161
    v_mfma_f32_16x16x32_bf16 v[80:83], a[96:99], v[36:39], v[80:83]
    buffer_load_dwordx4 v4, s[4:7], s47 offen offset:0 lds
    v_mul_f32 v162, s50, v162
    v_mfma_f32_16x16x32_bf16 v[84:87], a[100:103], v[36:39], v[84:87]
    ds_read_b64_tr_b16 v[56:57], v30 offset:28672
    v_mul_f32 v163, s50, v163
    v_mfma_f32_16x16x32_bf16 v[88:91], a[104:107], v[36:39], v[88:91]
    ds_read_b64_tr_b16 v[58:59], v30 offset:29184
    v_mul_f32 v176, s50, v176
    v_mfma_f32_16x16x32_bf16 v[92:95], a[108:111], v[36:39], v[92:95]
    ds_read_b64_tr_b16 v[60:61], v31 offset:28672
    v_mul_f32 v177, s50, v177
    v_mfma_f32_16x16x32_bf16 v[96:99], a[96:99], v[40:43], v[96:99]
    ds_read_b64_tr_b16 v[62:63], v31 offset:29184
    v_mul_f32 v178, s50, v178
    v_mfma_f32_16x16x32_bf16 v[100:103], a[100:103], v[40:43], v[100:103]
    v_mul_f32 v179, s50, v179
    v_cvt_pk_bf16_f32 v24, v160, v161
    v_mfma_f32_16x16x32_bf16 v[104:107], a[104:107], v[40:43], v[104:107]
    buffer_load_dwordx4 v5, s[4:7], s47 offen offset:1024 lds
    v_cvt_pk_bf16_f32 v25, v162, v163
    v_mfma_f32_16x16x32_bf16 v[108:111], a[108:111], v[40:43], v[108:111]
    v_cvt_pk_bf16_f32 v26, v176, v177
    v_cvt_pk_bf16_f32 v27, v178, v179
    v_mfma_f32_16x16x32_bf16 v[112:115], a[96:99], v[44:47], v[112:115]
    s_add_u32 s54, s46, 1024
    buffer_store_dwordx4 v[24:27], v2, s[20:23], s54 offen sc1
    v_mfma_f32_16x16x32_bf16 v[116:119], a[100:103], v[44:47], v[116:119]
    v_mfma_f32_16x16x32_bf16 v[120:123], a[104:107], v[44:47], v[120:123]
    v_mul_f32 v164, s50, v164
    v_mul_f32 v165, s50, v165
    v_mfma_f32_16x16x32_bf16 v[124:127], a[108:111], v[44:47], v[124:127]
    s_waitcnt vmcnt(23) lgkmcnt(0)
    s_barrier
    v_mul_f32 v166, s50, v166
    v_mul_f32 v167, s50, v167
    v_mfma_f32_16x16x32_bf16 v[64:67], a[112:115], v[48:51], v[64:67]
    ds_read_b64_tr_b16 v[32:33], v28 offset:32768
    v_mul_f32 v180, s50, v180
    v_mfma_f32_16x16x32_bf16 v[68:71], a[116:119], v[48:51], v[68:71]
    ds_read_b64_tr_b16 v[34:35], v28 offset:33280
    v_mul_f32 v181, s50, v181
    v_mfma_f32_16x16x32_bf16 v[72:75], a[120:123], v[48:51], v[72:75]
    ds_read_b64_tr_b16 v[36:37], v29 offset:32768
    v_mul_f32 v182, s50, v182
    v_mfma_f32_16x16x32_bf16 v[76:79], a[124:127], v[48:51], v[76:79]
    ds_read_b64_tr_b16 v[38:39], v29 offset:33280
    v_mul_f32 v183, s50, v183
    v_mfma_f32_16x16x32_bf16 v[80:83], a[112:115], v[52:55], v[80:83]
    buffer_load_dwordx4 v6, s[4:7], s47 offen offset:2048 lds
    v_cvt_pk_bf16_f32 v24, v164, v165
    v_mfma_f32_16x16x32_bf16 v[84:87], a[116:119], v[52:55], v[84:87]
    ds_read_b64_tr_b16 v[40:41], v30 offset:32768
    v_cvt_pk_bf16_f32 v25, v166, v167
    v_mfma_f32_16x16x32_bf16 v[88:91], a[120:123], v[52:55], v[88:91]
    ds_read_b64_tr_b16 v[42:43], v30 offset:33280
    v_cvt_pk_bf16_f32 v26, v180, v181
    v_mfma_f32_16x16x32_bf16 v[92:95], a[124:127], v[52:55], v[92:95]
    ds_read_b64_tr_b16 v[44:45], v31 offset:32768
    v_cvt_pk_bf16_f32 v27, v182, v183
    v_mfma_f32_16x16x32_bf16 v[96:99], a[112:115], v[56:59], v[96:99]
    s_add_u32 s54, s46, 5120
    ds_read_b64_tr_b16 v[46:47], v31 offset:33280
    v_mfma_f32_16x16x32_bf16 v[100:103], a[116:119], v[56:59], v[100:103]
    buffer_store_dwordx4 v[24:27], v2, s[20:23], s54 offen sc1
    v_mfma_f32_16x16x32_bf16 v[104:107], a[120:123], v[56:59], v[104:107]
    buffer_load_dwordx4 v7, s[4:7], s47 offen offset:3072 lds
    v_mfma_f32_16x16x32_bf16 v[108:111], a[124:127], v[56:59], v[108:111]
    v_mfma_f32_16x16x32_bf16 v[112:115], a[112:115], v[60:63], v[112:115]
    v_mfma_f32_16x16x32_bf16 v[116:119], a[116:119], v[60:63], v[116:119]
    v_mfma_f32_16x16x32_bf16 v[120:123], a[120:123], v[60:63], v[120:123]
    v_mfma_f32_16x16x32_bf16 v[124:127], a[124:127], v[60:63], v[124:127]
    s_waitcnt lgkmcnt(0)
    v_mfma_f32_16x16x32_bf16 v[64:67], a[128:131], v[32:35], v[64:67]
    s_bfe_u32 s45, s1, 196616
    s_lshl_b32 s45, s45, 7
    s_lshl_b32 s36, s45, 12
    ds_read_b64_tr_b16 v[48:49], v28 offset:36864
    v_mfma_f32_16x16x32_bf16 v[68:71], a[132:135], v[32:35], v[68:71]
    s_add_u32 s36, s36, s37
    ds_read_b64_tr_b16 v[50:51], v28 offset:37376
    v_mfma_f32_16x16x32_bf16 v[72:75], a[136:139], v[32:35], v[72:75]
    s_add_u32 s36, s36, 128
    ds_read_b64_tr_b16 v[52:53], v29 offset:36864
    v_mul_f32 v168, s50, v168
    v_mfma_f32_16x16x32_bf16 v[76:79], a[140:143], v[32:35], v[76:79]
    s_add_u32 m0, s39, 16384
    ds_read_b64_tr_b16 v[54:55], v29 offset:37376
    v_mul_f32 v169, s50, v169
    v_mfma_f32_16x16x32_bf16 v[80:83], a[128:131], v[36:39], v[80:83]
    buffer_load_dwordx4 v10, s[16:19], s36 offen lds
    v_mul_f32 v170, s50, v170
    v_mfma_f32_16x16x32_bf16 v[84:87], a[132:135], v[36:39], v[84:87]
    ds_read_b64_tr_b16 v[56:57], v30 offset:36864
    v_mul_f32 v171, s50, v171
    v_mfma_f32_16x16x32_bf16 v[88:91], a[136:139], v[36:39], v[88:91]
    ds_read_b64_tr_b16 v[58:59], v30 offset:37376
    v_mul_f32 v184, s50, v184
    v_mfma_f32_16x16x32_bf16 v[92:95], a[140:143], v[36:39], v[92:95]
    ds_read_b64_tr_b16 v[60:61], v31 offset:36864
    v_mul_f32 v185, s50, v185
    v_mfma_f32_16x16x32_bf16 v[96:99], a[128:131], v[40:43], v[96:99]
    ds_read_b64_tr_b16 v[62:63], v31 offset:37376
    v_mul_f32 v186, s50, v186
    v_mfma_f32_16x16x32_bf16 v[100:103], a[132:135], v[40:43], v[100:103]
    v_mul_f32 v187, s50, v187
    v_cvt_pk_bf16_f32 v24, v168, v169
    v_mfma_f32_16x16x32_bf16 v[104:107], a[136:139], v[40:43], v[104:107]
    buffer_load_dwordx4 v11, s[16:19], s36 offen offset:1024 lds
    v_cvt_pk_bf16_f32 v25, v170, v171
    v_mfma_f32_16x16x32_bf16 v[108:111], a[140:143], v[40:43], v[108:111]
    v_cvt_pk_bf16_f32 v26, v184, v185
    v_cvt_pk_bf16_f32 v27, v186, v187
    v_mfma_f32_16x16x32_bf16 v[112:115], a[128:131], v[44:47], v[112:115]
    s_add_u32 s54, s46, 17408
    buffer_store_dwordx4 v[24:27], v2, s[20:23], s54 offen sc1
    v_mfma_f32_16x16x32_bf16 v[116:119], a[132:135], v[44:47], v[116:119]
    v_mfma_f32_16x16x32_bf16 v[120:123], a[136:139], v[44:47], v[120:123]
    s_bfe_u32 s45, s1, 196620
    v_mfma_f32_16x16x32_bf16 v[124:127], a[140:143], v[44:47], v[124:127]
    s_waitcnt lgkmcnt(0)
    s_lshl_b32 s45, s45, 7
    v_mfma_f32_16x16x32_bf16 v[64:67], a[144:147], v[48:51], v[64:67]
    s_lshl_b32 s36, s45, 12
    ds_read_b64_tr_b16 v[32:33], v28 offset:40960
    v_mfma_f32_16x16x32_bf16 v[68:71], a[148:151], v[48:51], v[68:71]
    s_add_u32 s36, s36, s37
    ds_read_b64_tr_b16 v[34:35], v28 offset:41472
    v_mfma_f32_16x16x32_bf16 v[72:75], a[152:155], v[48:51], v[72:75]
    s_add_u32 s36, s36, 128
    ds_read_b64_tr_b16 v[36:37], v29 offset:40960
    v_mfma_f32_16x16x32_bf16 v[76:79], a[156:159], v[48:51], v[76:79]
    s_add_u32 m0, s39, 24576
    ds_read_b64_tr_b16 v[38:39], v29 offset:41472
    v_mfma_f32_16x16x32_bf16 v[80:83], a[144:147], v[52:55], v[80:83]
    buffer_load_dwordx4 v10, s[16:19], s36 offen lds
    v_mfma_f32_16x16x32_bf16 v[84:87], a[148:151], v[52:55], v[84:87]
    ds_read_b64_tr_b16 v[40:41], v30 offset:40960
    v_mfma_f32_16x16x32_bf16 v[88:91], a[152:155], v[52:55], v[88:91]
    ds_read_b64_tr_b16 v[42:43], v30 offset:41472
    v_mfma_f32_16x16x32_bf16 v[92:95], a[156:159], v[52:55], v[92:95]
    ds_read_b64_tr_b16 v[44:45], v31 offset:40960
    v_mfma_f32_16x16x32_bf16 v[96:99], a[144:147], v[56:59], v[96:99]
    ds_read_b64_tr_b16 v[46:47], v31 offset:41472
    v_mfma_f32_16x16x32_bf16 v[100:103], a[148:151], v[56:59], v[100:103]
    v_mfma_f32_16x16x32_bf16 v[104:107], a[152:155], v[56:59], v[104:107]
    buffer_load_dwordx4 v11, s[16:19], s36 offen offset:1024 lds
    v_mfma_f32_16x16x32_bf16 v[108:111], a[156:159], v[56:59], v[108:111]
    v_mfma_f32_16x16x32_bf16 v[112:115], a[144:147], v[60:63], v[112:115]
    v_mfma_f32_16x16x32_bf16 v[116:119], a[148:151], v[60:63], v[116:119]
    v_mfma_f32_16x16x32_bf16 v[120:123], a[152:155], v[60:63], v[120:123]
    v_mfma_f32_16x16x32_bf16 v[124:127], a[156:159], v[60:63], v[124:127]
    s_waitcnt lgkmcnt(0)
    v_mfma_f32_16x16x32_bf16 v[64:67], a[160:163], v[32:35], v[64:67]
    s_bfe_u32 s35, s32, 196612
    ds_read_b64_tr_b16 v[48:49], v28 offset:45056
    v_mfma_f32_16x16x32_bf16 v[68:71], a[164:167], v[32:35], v[68:71]
    s_lshl_b32 s35, s35, 7
    ds_read_b64_tr_b16 v[50:51], v28 offset:45568
    v_mfma_f32_16x16x32_bf16 v[72:75], a[168:171], v[32:35], v[72:75]
    s_add_u32 s47, s33, s35
    ds_read_b64_tr_b16 v[52:53], v29 offset:45056
    v_mul_f32 v172, s50, v172
    v_mfma_f32_16x16x32_bf16 v[76:79], a[172:175], v[32:35], v[76:79]
    s_add_u32 m0, s38, 16384
    ds_read_b64_tr_b16 v[54:55], v29 offset:45568
    v_mul_f32 v173, s50, v173
    v_mfma_f32_16x16x32_bf16 v[80:83], a[160:163], v[36:39], v[80:83]
    buffer_load_dwordx4 v4, s[4:7], s47 offen offset:0 lds
    v_mul_f32 v174, s50, v174
    v_mfma_f32_16x16x32_bf16 v[84:87], a[164:167], v[36:39], v[84:87]
    ds_read_b64_tr_b16 v[56:57], v30 offset:45056
    v_mul_f32 v175, s50, v175
    v_mfma_f32_16x16x32_bf16 v[88:91], a[168:171], v[36:39], v[88:91]
    ds_read_b64_tr_b16 v[58:59], v30 offset:45568
    v_mul_f32 v188, s50, v188
    v_mfma_f32_16x16x32_bf16 v[92:95], a[172:175], v[36:39], v[92:95]
    ds_read_b64_tr_b16 v[60:61], v31 offset:45056
    v_mul_f32 v189, s50, v189
    v_mfma_f32_16x16x32_bf16 v[96:99], a[160:163], v[40:43], v[96:99]
    ds_read_b64_tr_b16 v[62:63], v31 offset:45568
    v_mul_f32 v190, s50, v190
    v_mfma_f32_16x16x32_bf16 v[100:103], a[164:167], v[40:43], v[100:103]
    v_mul_f32 v191, s50, v191
    v_cvt_pk_bf16_f32 v24, v172, v173
    v_mfma_f32_16x16x32_bf16 v[104:107], a[168:171], v[40:43], v[104:107]
    buffer_load_dwordx4 v5, s[4:7], s47 offen offset:1024 lds
    v_cvt_pk_bf16_f32 v25, v174, v175
    v_mfma_f32_16x16x32_bf16 v[108:111], a[172:175], v[40:43], v[108:111]
    v_cvt_pk_bf16_f32 v26, v188, v189
    v_cvt_pk_bf16_f32 v27, v190, v191
    v_mfma_f32_16x16x32_bf16 v[112:115], a[160:163], v[44:47], v[112:115]
    s_add_u32 s54, s46, 21504
    buffer_store_dwordx4 v[24:27], v2, s[20:23], s54 offen sc1
    v_mfma_f32_16x16x32_bf16 v[116:119], a[164:167], v[44:47], v[116:119]
    v_mfma_f32_16x16x32_bf16 v[120:123], a[168:171], v[44:47], v[120:123]
    v_mul_f32 v192, s50, v192
    v_mul_f32 v193, s50, v193
    v_mfma_f32_16x16x32_bf16 v[124:127], a[172:175], v[44:47], v[124:127]
    s_waitcnt vmcnt(25) lgkmcnt(0)
    s_barrier
    v_mul_f32 v194, s50, v194
    v_mul_f32 v195, s50, v195
    v_mfma_f32_16x16x32_bf16 v[64:67], a[176:179], v[48:51], v[64:67]
    ds_read_b64_tr_b16 v[32:33], v28 offset:49152
    v_mul_f32 v208, s50, v208
    v_mfma_f32_16x16x32_bf16 v[68:71], a[180:183], v[48:51], v[68:71]
    ds_read_b64_tr_b16 v[34:35], v28 offset:49664
    v_mul_f32 v209, s50, v209
    v_mfma_f32_16x16x32_bf16 v[72:75], a[184:187], v[48:51], v[72:75]
    s_add_u32 s47, s41, s35
    ds_read_b64_tr_b16 v[36:37], v29 offset:49152
    v_mul_f32 v210, s50, v210
    v_mfma_f32_16x16x32_bf16 v[76:79], a[188:191], v[48:51], v[76:79]
    s_add_u32 m0, s38, 18432
    ds_read_b64_tr_b16 v[38:39], v29 offset:49664
    v_mul_f32 v211, s50, v211
    v_mfma_f32_16x16x32_bf16 v[80:83], a[176:179], v[52:55], v[80:83]
    buffer_load_dwordx4 v4, s[4:7], s47 offen offset:0 lds
    v_cvt_pk_bf16_f32 v24, v192, v193
    v_mfma_f32_16x16x32_bf16 v[84:87], a[180:183], v[52:55], v[84:87]
    ds_read_b64_tr_b16 v[40:41], v30 offset:49152
    v_cvt_pk_bf16_f32 v25, v194, v195
    v_mfma_f32_16x16x32_bf16 v[88:91], a[184:187], v[52:55], v[88:91]
    ds_read_b64_tr_b16 v[42:43], v30 offset:49664
    v_cvt_pk_bf16_f32 v26, v208, v209
    v_mfma_f32_16x16x32_bf16 v[92:95], a[188:191], v[52:55], v[92:95]
    ds_read_b64_tr_b16 v[44:45], v31 offset:49152
    v_cvt_pk_bf16_f32 v27, v210, v211
    v_mfma_f32_16x16x32_bf16 v[96:99], a[176:179], v[56:59], v[96:99]
    s_add_u32 s54, s46, 2048
    ds_read_b64_tr_b16 v[46:47], v31 offset:49664
    v_mfma_f32_16x16x32_bf16 v[100:103], a[180:183], v[56:59], v[100:103]
    buffer_store_dwordx4 v[24:27], v2, s[20:23], s54 offen sc1
    v_mfma_f32_16x16x32_bf16 v[104:107], a[184:187], v[56:59], v[104:107]
    buffer_load_dwordx4 v5, s[4:7], s47 offen offset:1024 lds
    v_mfma_f32_16x16x32_bf16 v[108:111], a[188:191], v[56:59], v[108:111]
    v_mfma_f32_16x16x32_bf16 v[112:115], a[176:179], v[60:63], v[112:115]
    v_mfma_f32_16x16x32_bf16 v[116:119], a[180:183], v[60:63], v[116:119]
    v_mfma_f32_16x16x32_bf16 v[120:123], a[184:187], v[60:63], v[120:123]
    v_mfma_f32_16x16x32_bf16 v[124:127], a[188:191], v[60:63], v[124:127]
    s_waitcnt lgkmcnt(0)
    v_mfma_f32_16x16x32_bf16 v[64:67], a[192:195], v[32:35], v[64:67]
    s_bfe_u32 s45, s1, 196624
    s_lshl_b32 s45, s45, 7
    s_lshl_b32 s36, s45, 12
    ds_read_b64_tr_b16 v[48:49], v28 offset:53248
    v_mfma_f32_16x16x32_bf16 v[68:71], a[196:199], v[32:35], v[68:71]
    s_add_u32 s36, s36, s37
    ds_read_b64_tr_b16 v[50:51], v28 offset:53760
    v_mfma_f32_16x16x32_bf16 v[72:75], a[200:203], v[32:35], v[72:75]
    s_add_u32 s36, s36, 128
    ds_read_b64_tr_b16 v[52:53], v29 offset:53248
    v_mul_f32 v196, s50, v196
    v_mfma_f32_16x16x32_bf16 v[76:79], a[204:207], v[32:35], v[76:79]
    s_add_u32 m0, s39, 32768
    ds_read_b64_tr_b16 v[54:55], v29 offset:53760
    v_mul_f32 v197, s50, v197
    v_mfma_f32_16x16x32_bf16 v[80:83], a[192:195], v[36:39], v[80:83]
    buffer_load_dwordx4 v10, s[16:19], s36 offen lds
    v_mul_f32 v198, s50, v198
    v_mfma_f32_16x16x32_bf16 v[84:87], a[196:199], v[36:39], v[84:87]
    ds_read_b64_tr_b16 v[56:57], v30 offset:53248
    v_mul_f32 v199, s50, v199
    v_mfma_f32_16x16x32_bf16 v[88:91], a[200:203], v[36:39], v[88:91]
    ds_read_b64_tr_b16 v[58:59], v30 offset:53760
    v_mul_f32 v212, s50, v212
    v_mfma_f32_16x16x32_bf16 v[92:95], a[204:207], v[36:39], v[92:95]
    ds_read_b64_tr_b16 v[60:61], v31 offset:53248
    v_mul_f32 v213, s50, v213
    v_mfma_f32_16x16x32_bf16 v[96:99], a[192:195], v[40:43], v[96:99]
    ds_read_b64_tr_b16 v[62:63], v31 offset:53760
    v_mul_f32 v214, s50, v214
    v_mfma_f32_16x16x32_bf16 v[100:103], a[196:199], v[40:43], v[100:103]
    v_mul_f32 v215, s50, v215
    v_cvt_pk_bf16_f32 v24, v196, v197
    v_mfma_f32_16x16x32_bf16 v[104:107], a[200:203], v[40:43], v[104:107]
    buffer_load_dwordx4 v11, s[16:19], s36 offen offset:1024 lds
    v_cvt_pk_bf16_f32 v25, v198, v199
    v_mfma_f32_16x16x32_bf16 v[108:111], a[204:207], v[40:43], v[108:111]
    v_cvt_pk_bf16_f32 v26, v212, v213
    v_cvt_pk_bf16_f32 v27, v214, v215
    v_mfma_f32_16x16x32_bf16 v[112:115], a[192:195], v[44:47], v[112:115]
    s_add_u32 s54, s46, 6144
    buffer_store_dwordx4 v[24:27], v2, s[20:23], s54 offen sc1
    v_mfma_f32_16x16x32_bf16 v[116:119], a[196:199], v[44:47], v[116:119]
    v_mfma_f32_16x16x32_bf16 v[120:123], a[200:203], v[44:47], v[120:123]
    s_bfe_u32 s45, s1, 196628
    v_mfma_f32_16x16x32_bf16 v[124:127], a[204:207], v[44:47], v[124:127]
    s_waitcnt lgkmcnt(0)
    s_lshl_b32 s45, s45, 7
    v_mfma_f32_16x16x32_bf16 v[64:67], a[208:211], v[48:51], v[64:67]
    s_lshl_b32 s36, s45, 12
    ds_read_b64_tr_b16 v[32:33], v28 offset:57344
    v_mfma_f32_16x16x32_bf16 v[68:71], a[212:215], v[48:51], v[68:71]
    s_add_u32 s36, s36, s37
    ds_read_b64_tr_b16 v[34:35], v28 offset:57856
    v_mfma_f32_16x16x32_bf16 v[72:75], a[216:219], v[48:51], v[72:75]
    s_add_u32 s36, s36, 128
    ds_read_b64_tr_b16 v[36:37], v29 offset:57344
    v_mfma_f32_16x16x32_bf16 v[76:79], a[220:223], v[48:51], v[76:79]
    s_add_u32 m0, s39, 40960
    ds_read_b64_tr_b16 v[38:39], v29 offset:57856
    v_mfma_f32_16x16x32_bf16 v[80:83], a[208:211], v[52:55], v[80:83]
    buffer_load_dwordx4 v10, s[16:19], s36 offen lds
    v_mfma_f32_16x16x32_bf16 v[84:87], a[212:215], v[52:55], v[84:87]
    ds_read_b64_tr_b16 v[40:41], v30 offset:57344
    v_mfma_f32_16x16x32_bf16 v[88:91], a[216:219], v[52:55], v[88:91]
    ds_read_b64_tr_b16 v[42:43], v30 offset:57856
    v_mfma_f32_16x16x32_bf16 v[92:95], a[220:223], v[52:55], v[92:95]
    ds_read_b64_tr_b16 v[44:45], v31 offset:57344
    v_mfma_f32_16x16x32_bf16 v[96:99], a[208:211], v[56:59], v[96:99]
    ds_read_b64_tr_b16 v[46:47], v31 offset:57856
    v_mfma_f32_16x16x32_bf16 v[100:103], a[212:215], v[56:59], v[100:103]
    v_mfma_f32_16x16x32_bf16 v[104:107], a[216:219], v[56:59], v[104:107]
    buffer_load_dwordx4 v11, s[16:19], s36 offen offset:1024 lds
    v_mfma_f32_16x16x32_bf16 v[108:111], a[220:223], v[56:59], v[108:111]
    v_mfma_f32_16x16x32_bf16 v[112:115], a[208:211], v[60:63], v[112:115]
    v_mfma_f32_16x16x32_bf16 v[116:119], a[212:215], v[60:63], v[116:119]
    v_mfma_f32_16x16x32_bf16 v[120:123], a[216:219], v[60:63], v[120:123]
    v_mfma_f32_16x16x32_bf16 v[124:127], a[220:223], v[60:63], v[124:127]
    s_waitcnt lgkmcnt(0)
    v_mfma_f32_16x16x32_bf16 v[64:67], a[224:227], v[32:35], v[64:67]
    ds_read_b64_tr_b16 v[48:49], v28 offset:61440
    v_mfma_f32_16x16x32_bf16 v[68:71], a[228:231], v[32:35], v[68:71]
    ds_read_b64_tr_b16 v[50:51], v28 offset:61952
    v_mfma_f32_16x16x32_bf16 v[72:75], a[232:235], v[32:35], v[72:75]
    s_add_u32 s47, s34, s35
    ds_read_b64_tr_b16 v[52:53], v29 offset:61440
    v_mul_f32 v200, s50, v200
    v_mfma_f32_16x16x32_bf16 v[76:79], a[236:239], v[32:35], v[76:79]
    s_add_u32 m0, s38, 20480
    ds_read_b64_tr_b16 v[54:55], v29 offset:61952
    v_mul_f32 v201, s50, v201
    v_mfma_f32_16x16x32_bf16 v[80:83], a[224:227], v[36:39], v[80:83]
    buffer_load_dwordx4 v4, s[4:7], s47 offen offset:0 lds
    v_mul_f32 v202, s50, v202
    v_mfma_f32_16x16x32_bf16 v[84:87], a[228:231], v[36:39], v[84:87]
    ds_read_b64_tr_b16 v[56:57], v30 offset:61440
    v_mul_f32 v203, s50, v203
    v_mfma_f32_16x16x32_bf16 v[88:91], a[232:235], v[36:39], v[88:91]
    ds_read_b64_tr_b16 v[58:59], v30 offset:61952
    v_mul_f32 v216, s50, v216
    v_mfma_f32_16x16x32_bf16 v[92:95], a[236:239], v[36:39], v[92:95]
    ds_read_b64_tr_b16 v[60:61], v31 offset:61440
    v_mul_f32 v217, s50, v217
    v_mfma_f32_16x16x32_bf16 v[96:99], a[224:227], v[40:43], v[96:99]
    ds_read_b64_tr_b16 v[62:63], v31 offset:61952
    v_mul_f32 v218, s50, v218
    v_mfma_f32_16x16x32_bf16 v[100:103], a[228:231], v[40:43], v[100:103]
    v_mul_f32 v219, s50, v219
    v_cvt_pk_bf16_f32 v24, v200, v201
    v_mfma_f32_16x16x32_bf16 v[104:107], a[232:235], v[40:43], v[104:107]
    buffer_load_dwordx4 v5, s[4:7], s47 offen offset:1024 lds
    v_cvt_pk_bf16_f32 v25, v202, v203
    v_mfma_f32_16x16x32_bf16 v[108:111], a[236:239], v[40:43], v[108:111]
    v_cvt_pk_bf16_f32 v26, v216, v217
    v_cvt_pk_bf16_f32 v27, v218, v219
    v_mfma_f32_16x16x32_bf16 v[112:115], a[224:227], v[44:47], v[112:115]
    s_add_u32 s54, s46, 18432
    buffer_store_dwordx4 v[24:27], v2, s[20:23], s54 offen sc1
    v_mfma_f32_16x16x32_bf16 v[116:119], a[228:231], v[44:47], v[116:119]
    v_mfma_f32_16x16x32_bf16 v[120:123], a[232:235], v[44:47], v[120:123]
    v_mul_f32 v204, s50, v204
    v_mul_f32 v205, s50, v205
    v_mfma_f32_16x16x32_bf16 v[124:127], a[236:239], v[44:47], v[124:127]
    s_waitcnt vmcnt(25) lgkmcnt(0)
    s_barrier
    v_mul_f32 v206, s50, v206
    v_mul_f32 v207, s50, v207
    v_mfma_f32_16x16x32_bf16 v[64:67], a[240:243], v[48:51], v[64:67]
    ds_read_b64_tr_b16 v[32:33], v28 offset:0
    v_mul_f32 v220, s50, v220
    v_mfma_f32_16x16x32_bf16 v[68:71], a[244:247], v[48:51], v[68:71]
    ds_read_b64_tr_b16 v[34:35], v28 offset:512
    v_mul_f32 v221, s50, v221
    v_mfma_f32_16x16x32_bf16 v[72:75], a[248:251], v[48:51], v[72:75]
    ds_read_b64_tr_b16 v[36:37], v29 offset:0
    v_mul_f32 v222, s50, v222
    v_mfma_f32_16x16x32_bf16 v[76:79], a[252:255], v[48:51], v[76:79]
    ds_read_b64_tr_b16 v[38:39], v29 offset:512
    v_mul_f32 v223, s50, v223
    v_mfma_f32_16x16x32_bf16 v[80:83], a[240:243], v[52:55], v[80:83]
    buffer_load_dwordx4 v6, s[4:7], s47 offen offset:2048 lds
    v_cvt_pk_bf16_f32 v24, v204, v205
    v_mfma_f32_16x16x32_bf16 v[84:87], a[244:247], v[52:55], v[84:87]
    ds_read_b64_tr_b16 v[40:41], v30 offset:0
    v_cvt_pk_bf16_f32 v25, v206, v207
    v_mfma_f32_16x16x32_bf16 v[88:91], a[248:251], v[52:55], v[88:91]
    ds_read_b64_tr_b16 v[42:43], v30 offset:512
    v_cvt_pk_bf16_f32 v26, v220, v221
    v_mfma_f32_16x16x32_bf16 v[92:95], a[252:255], v[52:55], v[92:95]
    ds_read_b64_tr_b16 v[44:45], v31 offset:0
    v_cvt_pk_bf16_f32 v27, v222, v223
    v_mfma_f32_16x16x32_bf16 v[96:99], a[240:243], v[56:59], v[96:99]
    s_add_u32 s54, s46, 22528
    ds_read_b64_tr_b16 v[46:47], v31 offset:512
    v_mfma_f32_16x16x32_bf16 v[100:103], a[244:247], v[56:59], v[100:103]
    buffer_store_dwordx4 v[24:27], v2, s[20:23], s54 offen sc1
    v_mfma_f32_16x16x32_bf16 v[104:107], a[248:251], v[56:59], v[104:107]
    buffer_load_dwordx4 v7, s[4:7], s47 offen offset:3072 lds
    v_mfma_f32_16x16x32_bf16 v[108:111], a[252:255], v[56:59], v[108:111]
    v_mfma_f32_16x16x32_bf16 v[112:115], a[240:243], v[60:63], v[112:115]
    v_mfma_f32_16x16x32_bf16 v[116:119], a[244:247], v[60:63], v[116:119]
    v_mfma_f32_16x16x32_bf16 v[120:123], a[248:251], v[60:63], v[120:123]
    v_mfma_f32_16x16x32_bf16 v[124:127], a[252:255], v[60:63], v[124:127]
    s_waitcnt lgkmcnt(0)
    v_mfma_f32_16x16x32_bf16 v[128:131], a[0:3], v[32:35], 0
    s_bfe_u32 s45, s1, 196632
    s_lshl_b32 s45, s45, 7
    s_lshl_b32 s36, s45, 12
    ds_read_b64_tr_b16 v[48:49], v28 offset:4096
    v_mfma_f32_16x16x32_bf16 v[132:135], a[4:7], v[32:35], 0
    s_add_u32 s36, s36, s37
    ds_read_b64_tr_b16 v[50:51], v28 offset:4608
    v_mfma_f32_16x16x32_bf16 v[136:139], a[8:11], v[32:35], 0
    s_add_u32 s36, s36, 128
    ds_read_b64_tr_b16 v[52:53], v29 offset:4096
    v_cvt_pk_bf16_f32 v24, v64, v65
    v_mfma_f32_16x16x32_bf16 v[140:143], a[12:15], v[32:35], 0
    s_add_u32 m0, s39, 49152
    ds_read_b64_tr_b16 v[54:55], v29 offset:4608
    v_cvt_pk_bf16_f32 v25, v66, v67
    v_mfma_f32_16x16x32_bf16 v[144:147], a[0:3], v[36:39], 0
    buffer_load_dwordx4 v10, s[16:19], s36 offen lds
    v_cvt_pk_bf16_f32 v26, v68, v69
    v_mfma_f32_16x16x32_bf16 v[148:151], a[4:7], v[36:39], 0
    ds_read_b64_tr_b16 v[56:57], v30 offset:4096
    v_cvt_pk_bf16_f32 v27, v70, v71
    v_mfma_f32_16x16x32_bf16 v[152:155], a[8:11], v[36:39], 0
    s_add_u32 s54, s46, 24576
    ds_read_b64_tr_b16 v[58:59], v30 offset:4608
    v_mfma_f32_16x16x32_bf16 v[156:159], a[12:15], v[36:39], 0
    ds_read_b64_tr_b16 v[60:61], v31 offset:4096
    v_mfma_f32_16x16x32_bf16 v[160:163], a[0:3], v[40:43], 0
    ds_read_b64_tr_b16 v[62:63], v31 offset:4608
    buffer_store_dwordx4 v[24:27], v2, s[20:23], s54 offen sc1
    v_mfma_f32_16x16x32_bf16 v[164:167], a[4:7], v[40:43], 0
    v_mfma_f32_16x16x32_bf16 v[168:171], a[8:11], v[40:43], 0
    buffer_load_dwordx4 v11, s[16:19], s36 offen offset:1024 lds
    v_cvt_pk_bf16_f32 v24, v72, v73
    v_mfma_f32_16x16x32_bf16 v[172:175], a[12:15], v[40:43], 0
    v_cvt_pk_bf16_f32 v25, v74, v75
    v_cvt_pk_bf16_f32 v26, v76, v77
    v_mfma_f32_16x16x32_bf16 v[176:179], a[0:3], v[44:47], 0
    v_cvt_pk_bf16_f32 v27, v78, v79
    v_mfma_f32_16x16x32_bf16 v[180:183], a[4:7], v[44:47], 0
    s_add_u32 s54, s46, 40960
    buffer_store_dwordx4 v[24:27], v2, s[20:23], s54 offen sc1
    v_mfma_f32_16x16x32_bf16 v[184:187], a[8:11], v[44:47], 0
    s_bfe_u32 s45, s1, 196636
    v_mfma_f32_16x16x32_bf16 v[188:191], a[12:15], v[44:47], 0
    s_waitcnt lgkmcnt(0)
    s_lshl_b32 s45, s45, 7
    v_mfma_f32_16x16x32_bf16 v[128:131], a[16:19], v[48:51], v[128:131]
    s_lshl_b32 s36, s45, 12
    ds_read_b64_tr_b16 v[32:33], v28 offset:8192
    v_mfma_f32_16x16x32_bf16 v[132:135], a[20:23], v[48:51], v[132:135]
    s_add_u32 s36, s36, s37
    ds_read_b64_tr_b16 v[34:35], v28 offset:8704
    v_mfma_f32_16x16x32_bf16 v[136:139], a[24:27], v[48:51], v[136:139]
    s_add_u32 s36, s36, 128
    ds_read_b64_tr_b16 v[36:37], v29 offset:8192
    v_mfma_f32_16x16x32_bf16 v[140:143], a[28:31], v[48:51], v[140:143]
    s_add_u32 m0, s39, 57344
    ds_read_b64_tr_b16 v[38:39], v29 offset:8704
    v_mfma_f32_16x16x32_bf16 v[144:147], a[16:19], v[52:55], v[144:147]
    buffer_load_dwordx4 v10, s[16:19], s36 offen lds
    v_mfma_f32_16x16x32_bf16 v[148:151], a[20:23], v[52:55], v[148:151]
    ds_read_b64_tr_b16 v[40:41], v30 offset:8192
    v_mfma_f32_16x16x32_bf16 v[152:155], a[24:27], v[52:55], v[152:155]
    ds_read_b64_tr_b16 v[42:43], v30 offset:8704
    v_mfma_f32_16x16x32_bf16 v[156:159], a[28:31], v[52:55], v[156:159]
    ds_read_b64_tr_b16 v[44:45], v31 offset:8192
    v_mfma_f32_16x16x32_bf16 v[160:163], a[16:19], v[56:59], v[160:163]
    ds_read_b64_tr_b16 v[46:47], v31 offset:8704
    v_mfma_f32_16x16x32_bf16 v[164:167], a[20:23], v[56:59], v[164:167]
    v_mfma_f32_16x16x32_bf16 v[168:171], a[24:27], v[56:59], v[168:171]
    buffer_load_dwordx4 v11, s[16:19], s36 offen offset:1024 lds
    v_mfma_f32_16x16x32_bf16 v[172:175], a[28:31], v[56:59], v[172:175]
    v_mfma_f32_16x16x32_bf16 v[176:179], a[16:19], v[60:63], v[176:179]
    v_mfma_f32_16x16x32_bf16 v[180:183], a[20:23], v[60:63], v[180:183]
    v_mfma_f32_16x16x32_bf16 v[184:187], a[24:27], v[60:63], v[184:187]
    v_mfma_f32_16x16x32_bf16 v[188:191], a[28:31], v[60:63], v[188:191]
    s_waitcnt lgkmcnt(0)
    v_mfma_f32_16x16x32_bf16 v[128:131], a[32:35], v[32:35], v[128:131]
    ds_read_b64_tr_b16 v[48:49], v28 offset:12288
    v_mfma_f32_16x16x32_bf16 v[132:135], a[36:39], v[32:35], v[132:135]
    ds_read_b64_tr_b16 v[50:51], v28 offset:12800
    v_mfma_f32_16x16x32_bf16 v[136:139], a[40:43], v[32:35], v[136:139]
    ds_read_b64_tr_b16 v[52:53], v29 offset:12288
    v_cvt_pk_bf16_f32 v24, v80, v81
    v_mfma_f32_16x16x32_bf16 v[140:143], a[44:47], v[32:35], v[140:143]
    ds_read_b64_tr_b16 v[54:55], v29 offset:12800
    v_cvt_pk_bf16_f32 v25, v82, v83
    v_mfma_f32_16x16x32_bf16 v[144:147], a[32:35], v[36:39], v[144:147]
    ds_read_b64_tr_b16 v[56:57], v30 offset:12288
    v_cvt_pk_bf16_f32 v26, v84, v85
    v_mfma_f32_16x16x32_bf16 v[148:151], a[36:39], v[36:39], v[148:151]
    ds_read_b64_tr_b16 v[58:59], v30 offset:12800
    v_cvt_pk_bf16_f32 v27, v86, v87
    v_mfma_f32_16x16x32_bf16 v[152:155], a[40:43], v[36:39], v[152:155]
    s_add_u32 s54, s46, 25600
    ds_read_b64_tr_b16 v[60:61], v31 offset:12288
    v_mfma_f32_16x16x32_bf16 v[156:159], a[44:47], v[36:39], v[156:159]
    ds_read_b64_tr_b16 v[62:63], v31 offset:12800
    v_mfma_f32_16x16x32_bf16 v[160:163], a[32:35], v[40:43], v[160:163]
    buffer_store_dwordx4 v[24:27], v2, s[20:23], s54 offen sc1
    v_mfma_f32_16x16x32_bf16 v[164:167], a[36:39], v[40:43], v[164:167]
    v_mfma_f32_16x16x32_bf16 v[168:171], a[40:43], v[40:43], v[168:171]
    v_cvt_pk_bf16_f32 v24, v88, v89
    v_cvt_pk_bf16_f32 v25, v90, v91
    v_mfma_f32_16x16x32_bf16 v[172:175], a[44:47], v[40:43], v[172:175]
    v_cvt_pk_bf16_f32 v26, v92, v93
    v_cvt_pk_bf16_f32 v27, v94, v95
    v_mfma_f32_16x16x32_bf16 v[176:179], a[32:35], v[44:47], v[176:179]
    s_add_u32 s54, s46, 41984
    buffer_store_dwordx4 v[24:27], v2, s[20:23], s54 offen sc1
    v_mfma_f32_16x16x32_bf16 v[180:183], a[36:39], v[44:47], v[180:183]
    v_mfma_f32_16x16x32_bf16 v[184:187], a[40:43], v[44:47], v[184:187]
    v_mfma_f32_16x16x32_bf16 v[188:191], a[44:47], v[44:47], v[188:191]
    s_waitcnt vmcnt(25) lgkmcnt(0)
    s_barrier
    v_mfma_f32_16x16x32_bf16 v[128:131], a[48:51], v[48:51], v[128:131]
    ds_read_b64_tr_b16 v[32:33], v28 offset:16384
    v_mfma_f32_16x16x32_bf16 v[132:135], a[52:55], v[48:51], v[132:135]
    ds_read_b64_tr_b16 v[34:35], v28 offset:16896
    v_mfma_f32_16x16x32_bf16 v[136:139], a[56:59], v[48:51], v[136:139]
    ds_read_b64_tr_b16 v[36:37], v29 offset:16384
    v_mfma_f32_16x16x32_bf16 v[140:143], a[60:63], v[48:51], v[140:143]
    ds_read_b64_tr_b16 v[38:39], v29 offset:16896
    v_mfma_f32_16x16x32_bf16 v[144:147], a[48:51], v[52:55], v[144:147]
    ds_read_b64_tr_b16 v[40:41], v30 offset:16384
    v_mfma_f32_16x16x32_bf16 v[148:151], a[52:55], v[52:55], v[148:151]
    ds_read_b64_tr_b16 v[42:43], v30 offset:16896
    v_mfma_f32_16x16x32_bf16 v[152:155], a[56:59], v[52:55], v[152:155]
    ds_read_b64_tr_b16 v[44:45], v31 offset:16384
    v_mfma_f32_16x16x32_bf16 v[156:159], a[60:63], v[52:55], v[156:159]
    ds_read_b64_tr_b16 v[46:47], v31 offset:16896
    v_mfma_f32_16x16x32_bf16 v[160:163], a[48:51], v[56:59], v[160:163]
    v_mfma_f32_16x16x32_bf16 v[164:167], a[52:55], v[56:59], v[164:167]
    v_mfma_f32_16x16x32_bf16 v[168:171], a[56:59], v[56:59], v[168:171]
    v_mfma_f32_16x16x32_bf16 v[172:175], a[60:63], v[56:59], v[172:175]
    v_mfma_f32_16x16x32_bf16 v[176:179], a[48:51], v[60:63], v[176:179]
    v_mfma_f32_16x16x32_bf16 v[180:183], a[52:55], v[60:63], v[180:183]
    v_mfma_f32_16x16x32_bf16 v[184:187], a[56:59], v[60:63], v[184:187]
    v_mfma_f32_16x16x32_bf16 v[188:191], a[60:63], v[60:63], v[188:191]
    s_waitcnt lgkmcnt(0)
    v_mfma_f32_16x16x32_bf16 v[128:131], a[64:67], v[32:35], v[128:131]
    s_bfe_u32 s45, s32, 196608
    s_lshl_b32 s45, s45, 7
    ds_read_b64_tr_b16 v[48:49], v28 offset:20480
    v_mfma_f32_16x16x32_bf16 v[132:135], a[68:71], v[32:35], v[132:135]
    s_lshl_b32 s36, s45, 12
    ds_read_b64_tr_b16 v[50:51], v28 offset:20992
    v_mfma_f32_16x16x32_bf16 v[136:139], a[72:75], v[32:35], v[136:139]
    s_add_u32 s36, s36, s37
    ds_read_b64_tr_b16 v[52:53], v29 offset:20480
    v_cvt_pk_bf16_f32 v24, v96, v97
    v_mfma_f32_16x16x32_bf16 v[140:143], a[76:79], v[32:35], v[140:143]
    s_add_u32 m0, s39, 0
    ds_read_b64_tr_b16 v[54:55], v29 offset:20992
    v_cvt_pk_bf16_f32 v25, v98, v99
    v_mfma_f32_16x16x32_bf16 v[144:147], a[64:67], v[36:39], v[144:147]
    buffer_load_dwordx4 v8, s[12:15], s36 offen lds
    v_cvt_pk_bf16_f32 v26, v100, v101
    v_mfma_f32_16x16x32_bf16 v[148:151], a[68:71], v[36:39], v[148:151]
    ds_read_b64_tr_b16 v[56:57], v30 offset:20480
    v_cvt_pk_bf16_f32 v27, v102, v103
    v_mfma_f32_16x16x32_bf16 v[152:155], a[72:75], v[36:39], v[152:155]
    s_add_u32 s54, s46, 26624
    ds_read_b64_tr_b16 v[58:59], v30 offset:20992
    v_mfma_f32_16x16x32_bf16 v[156:159], a[76:79], v[36:39], v[156:159]
    ds_read_b64_tr_b16 v[60:61], v31 offset:20480
    v_mfma_f32_16x16x32_bf16 v[160:163], a[64:67], v[40:43], v[160:163]
    ds_read_b64_tr_b16 v[62:63], v31 offset:20992
    buffer_store_dwordx4 v[24:27], v2, s[20:23], s54 offen sc1
    v_mfma_f32_16x16x32_bf16 v[164:167], a[68:71], v[40:43], v[164:167]
    v_mfma_f32_16x16x32_bf16 v[168:171], a[72:75], v[40:43], v[168:171]
    buffer_load_dwordx4 v9, s[12:15], s36 offen offset:1024 lds
    v_cvt_pk_bf16_f32 v24, v104, v105
    v_mfma_f32_16x16x32_bf16 v[172:175], a[76:79], v[40:43], v[172:175]
    v_cvt_pk_bf16_f32 v25, v106, v107
    v_cvt_pk_bf16_f32 v26, v108, v109
    v_mfma_f32_16x16x32_bf16 v[176:179], a[64:67], v[44:47], v[176:179]
    v_cvt_pk_bf16_f32 v27, v110, v111
    v_mfma_f32_16x16x32_bf16 v[180:183], a[68:71], v[44:47], v[180:183]
    s_add_u32 s54, s46, 43008
    buffer_store_dwordx4 v[24:27], v2, s[20:23], s54 offen sc1
    v_mfma_f32_16x16x32_bf16 v[184:187], a[72:75], v[44:47], v[184:187]
    v_mfma_f32_16x16x32_bf16 v[188:191], a[76:79], v[44:47], v[188:191]
    s_waitcnt lgkmcnt(0)
    v_mfma_f32_16x16x32_bf16 v[128:131], a[80:83], v[48:51], v[128:131]
    ds_read_b64_tr_b16 v[32:33], v28 offset:24576
    v_mfma_f32_16x16x32_bf16 v[132:135], a[84:87], v[48:51], v[132:135]
    ds_read_b64_tr_b16 v[34:35], v28 offset:25088
    v_mfma_f32_16x16x32_bf16 v[136:139], a[88:91], v[48:51], v[136:139]
    s_add_u32 s36, s36, 262144
    ds_read_b64_tr_b16 v[36:37], v29 offset:24576
    v_mfma_f32_16x16x32_bf16 v[140:143], a[92:95], v[48:51], v[140:143]
    s_add_u32 m0, s39, 8192
    ds_read_b64_tr_b16 v[38:39], v29 offset:25088
    v_mfma_f32_16x16x32_bf16 v[144:147], a[80:83], v[52:55], v[144:147]
    buffer_load_dwordx4 v8, s[12:15], s36 offen lds
    v_mfma_f32_16x16x32_bf16 v[148:151], a[84:87], v[52:55], v[148:151]
    ds_read_b64_tr_b16 v[40:41], v30 offset:24576
    v_mfma_f32_16x16x32_bf16 v[152:155], a[88:91], v[52:55], v[152:155]
    ds_read_b64_tr_b16 v[42:43], v30 offset:25088
    v_mfma_f32_16x16x32_bf16 v[156:159], a[92:95], v[52:55], v[156:159]
    ds_read_b64_tr_b16 v[44:45], v31 offset:24576
    v_mfma_f32_16x16x32_bf16 v[160:163], a[80:83], v[56:59], v[160:163]
    ds_read_b64_tr_b16 v[46:47], v31 offset:25088
    v_mfma_f32_16x16x32_bf16 v[164:167], a[84:87], v[56:59], v[164:167]
    v_mfma_f32_16x16x32_bf16 v[168:171], a[88:91], v[56:59], v[168:171]
    buffer_load_dwordx4 v9, s[12:15], s36 offen offset:1024 lds
    v_mfma_f32_16x16x32_bf16 v[172:175], a[92:95], v[56:59], v[172:175]
    v_mfma_f32_16x16x32_bf16 v[176:179], a[80:83], v[60:63], v[176:179]
    v_mfma_f32_16x16x32_bf16 v[180:183], a[84:87], v[60:63], v[180:183]
    v_mfma_f32_16x16x32_bf16 v[184:187], a[88:91], v[60:63], v[184:187]
    v_mfma_f32_16x16x32_bf16 v[188:191], a[92:95], v[60:63], v[188:191]
    s_waitcnt lgkmcnt(0)
    v_mfma_f32_16x16x32_bf16 v[128:131], a[96:99], v[32:35], v[128:131]
    ds_read_b64_tr_b16 v[48:49], v28 offset:28672
    v_mfma_f32_16x16x32_bf16 v[132:135], a[100:103], v[32:35], v[132:135]
    ds_read_b64_tr_b16 v[50:51], v28 offset:29184
    v_mfma_f32_16x16x32_bf16 v[136:139], a[104:107], v[32:35], v[136:139]
    ds_read_b64_tr_b16 v[52:53], v29 offset:28672
    v_cvt_pk_bf16_f32 v24, v112, v113
    v_mfma_f32_16x16x32_bf16 v[140:143], a[108:111], v[32:35], v[140:143]
    ds_read_b64_tr_b16 v[54:55], v29 offset:29184
    v_cvt_pk_bf16_f32 v25, v114, v115
    v_mfma_f32_16x16x32_bf16 v[144:147], a[96:99], v[36:39], v[144:147]
    ds_read_b64_tr_b16 v[56:57], v30 offset:28672
    v_cvt_pk_bf16_f32 v26, v116, v117
    v_mfma_f32_16x16x32_bf16 v[148:151], a[100:103], v[36:39], v[148:151]
    ds_read_b64_tr_b16 v[58:59], v30 offset:29184
    v_cvt_pk_bf16_f32 v27, v118, v119
    v_mfma_f32_16x16x32_bf16 v[152:155], a[104:107], v[36:39], v[152:155]
    s_add_u32 s54, s46, 27648
    ds_read_b64_tr_b16 v[60:61], v31 offset:28672
    v_mfma_f32_16x16x32_bf16 v[156:159], a[108:111], v[36:39], v[156:159]
    ds_read_b64_tr_b16 v[62:63], v31 offset:29184
    v_mfma_f32_16x16x32_bf16 v[160:163], a[96:99], v[40:43], v[160:163]
    buffer_store_dwordx4 v[24:27], v2, s[20:23], s54 offen sc1
    v_mfma_f32_16x16x32_bf16 v[164:167], a[100:103], v[40:43], v[164:167]
    v_mfma_f32_16x16x32_bf16 v[168:171], a[104:107], v[40:43], v[168:171]
    v_cvt_pk_bf16_f32 v24, v120, v121
    v_cvt_pk_bf16_f32 v25, v122, v123
    v_mfma_f32_16x16x32_bf16 v[172:175], a[108:111], v[40:43], v[172:175]
    v_cvt_pk_bf16_f32 v26, v124, v125
    v_cvt_pk_bf16_f32 v27, v126, v127
    v_mfma_f32_16x16x32_bf16 v[176:179], a[96:99], v[44:47], v[176:179]
    s_add_u32 s54, s46, 44032
    buffer_store_dwordx4 v[24:27], v2, s[20:23], s54 offen sc1
    v_mfma_f32_16x16x32_bf16 v[180:183], a[100:103], v[44:47], v[180:183]
    v_mfma_f32_16x16x32_bf16 v[184:187], a[104:107], v[44:47], v[184:187]
    v_mfma_f32_16x16x32_bf16 v[188:191], a[108:111], v[44:47], v[188:191]
    s_waitcnt vmcnt(22) lgkmcnt(0)
    s_barrier
    v_mfma_f32_16x16x32_bf16 v[128:131], a[112:115], v[48:51], v[128:131]
    ds_read_b64_tr_b16 v[32:33], v28 offset:32768
    v_mfma_f32_16x16x32_bf16 v[132:135], a[116:119], v[48:51], v[132:135]
    ds_read_b64_tr_b16 v[34:35], v28 offset:33280
    v_mfma_f32_16x16x32_bf16 v[136:139], a[120:123], v[48:51], v[136:139]
    ds_read_b64_tr_b16 v[36:37], v29 offset:32768
    v_mfma_f32_16x16x32_bf16 v[140:143], a[124:127], v[48:51], v[140:143]
    ds_read_b64_tr_b16 v[38:39], v29 offset:33280
    v_mfma_f32_16x16x32_bf16 v[144:147], a[112:115], v[52:55], v[144:147]
    ds_read_b64_tr_b16 v[40:41], v30 offset:32768
    v_mfma_f32_16x16x32_bf16 v[148:151], a[116:119], v[52:55], v[148:151]
    ds_read_b64_tr_b16 v[42:43], v30 offset:33280
    v_mfma_f32_16x16x32_bf16 v[152:155], a[120:123], v[52:55], v[152:155]
    ds_read_b64_tr_b16 v[44:45], v31 offset:32768
    v_mfma_f32_16x16x32_bf16 v[156:159], a[124:127], v[52:55], v[156:159]
    ds_read_b64_tr_b16 v[46:47], v31 offset:33280
    v_mfma_f32_16x16x32_bf16 v[160:163], a[112:115], v[56:59], v[160:163]
    v_mfma_f32_16x16x32_bf16 v[164:167], a[116:119], v[56:59], v[164:167]
    v_mfma_f32_16x16x32_bf16 v[168:171], a[120:123], v[56:59], v[168:171]
    v_mfma_f32_16x16x32_bf16 v[172:175], a[124:127], v[56:59], v[172:175]
    v_mfma_f32_16x16x32_bf16 v[176:179], a[112:115], v[60:63], v[176:179]
    v_mfma_f32_16x16x32_bf16 v[180:183], a[116:119], v[60:63], v[180:183]
    v_mfma_f32_16x16x32_bf16 v[184:187], a[120:123], v[60:63], v[184:187]
    v_mfma_f32_16x16x32_bf16 v[188:191], a[124:127], v[60:63], v[188:191]
    s_waitcnt lgkmcnt(0)
    v_mfma_f32_16x16x32_bf16 v[128:131], a[128:131], v[32:35], v[128:131]
    s_bfe_u32 s45, s32, 196612
    s_lshl_b32 s45, s45, 7
    ds_read_b64_tr_b16 v[48:49], v28 offset:36864
    v_mfma_f32_16x16x32_bf16 v[132:135], a[132:135], v[32:35], v[132:135]
    s_lshl_b32 s36, s45, 12
    ds_read_b64_tr_b16 v[50:51], v28 offset:37376
    v_mfma_f32_16x16x32_bf16 v[136:139], a[136:139], v[32:35], v[136:139]
    s_add_u32 s36, s36, s37
    ds_read_b64_tr_b16 v[52:53], v29 offset:36864
    v_mul_f32 v224, s50, v224
    v_mfma_f32_16x16x32_bf16 v[140:143], a[140:143], v[32:35], v[140:143]
    s_add_u32 m0, s39, 16384
    ds_read_b64_tr_b16 v[54:55], v29 offset:37376
    v_mul_f32 v225, s50, v225
    v_mfma_f32_16x16x32_bf16 v[144:147], a[128:131], v[36:39], v[144:147]
    buffer_load_dwordx4 v8, s[12:15], s36 offen lds
    v_mul_f32 v226, s50, v226
    v_mfma_f32_16x16x32_bf16 v[148:151], a[132:135], v[36:39], v[148:151]
    ds_read_b64_tr_b16 v[56:57], v30 offset:36864
    v_mul_f32 v227, s50, v227
    v_mfma_f32_16x16x32_bf16 v[152:155], a[136:139], v[36:39], v[152:155]
    ds_read_b64_tr_b16 v[58:59], v30 offset:37376
    v_mul_f32 v240, s50, v240
    v_mfma_f32_16x16x32_bf16 v[156:159], a[140:143], v[36:39], v[156:159]
    ds_read_b64_tr_b16 v[60:61], v31 offset:36864
    v_mul_f32 v241, s50, v241
    v_mfma_f32_16x16x32_bf16 v[160:163], a[128:131], v[40:43], v[160:163]
    ds_read_b64_tr_b16 v[62:63], v31 offset:37376
    v_mul_f32 v242, s50, v242
    v_mfma_f32_16x16x32_bf16 v[164:167], a[132:135], v[40:43], v[164:167]
    v_mul_f32 v243, s50, v243
    v_cvt_pk_bf16_f32 v24, v224, v225
    v_mfma_f32_16x16x32_bf16 v[168:171], a[136:139], v[40:43], v[168:171]
    buffer_load_dwordx4 v9, s[12:15], s36 offen offset:1024 lds
    v_cvt_pk_bf16_f32 v25, v226, v227
    v_mfma_f32_16x16x32_bf16 v[172:175], a[140:143], v[40:43], v[172:175]
    v_cvt_pk_bf16_f32 v26, v240, v241
    v_cvt_pk_bf16_f32 v27, v242, v243
    v_mfma_f32_16x16x32_bf16 v[176:179], a[128:131], v[44:47], v[176:179]
    s_add_u32 s54, s46, 3072
    buffer_store_dwordx4 v[24:27], v2, s[20:23], s54 offen sc1
    v_mfma_f32_16x16x32_bf16 v[180:183], a[132:135], v[44:47], v[180:183]
    v_mfma_f32_16x16x32_bf16 v[184:187], a[136:139], v[44:47], v[184:187]
    v_mul_f32 v228, s50, v228
    v_mul_f32 v229, s50, v229
    v_mfma_f32_16x16x32_bf16 v[188:191], a[140:143], v[44:47], v[188:191]
    s_waitcnt lgkmcnt(0)
    v_mul_f32 v230, s50, v230
    v_mul_f32 v231, s50, v231
    v_mfma_f32_16x16x32_bf16 v[128:131], a[144:147], v[48:51], v[128:131]
    ds_read_b64_tr_b16 v[32:33], v28 offset:40960
    v_mul_f32 v244, s50, v244
    v_mfma_f32_16x16x32_bf16 v[132:135], a[148:151], v[48:51], v[132:135]
    ds_read_b64_tr_b16 v[34:35], v28 offset:41472
    v_mul_f32 v245, s50, v245
    v_mfma_f32_16x16x32_bf16 v[136:139], a[152:155], v[48:51], v[136:139]
    s_add_u32 s36, s36, 262144
    ds_read_b64_tr_b16 v[36:37], v29 offset:40960
    v_mul_f32 v246, s50, v246
    v_mfma_f32_16x16x32_bf16 v[140:143], a[156:159], v[48:51], v[140:143]
    s_add_u32 m0, s39, 24576
    ds_read_b64_tr_b16 v[38:39], v29 offset:41472
    v_mul_f32 v247, s50, v247
    v_mfma_f32_16x16x32_bf16 v[144:147], a[144:147], v[52:55], v[144:147]
    buffer_load_dwordx4 v8, s[12:15], s36 offen lds
    v_cvt_pk_bf16_f32 v24, v228, v229
    v_mfma_f32_16x16x32_bf16 v[148:151], a[148:151], v[52:55], v[148:151]
    ds_read_b64_tr_b16 v[40:41], v30 offset:40960
    v_cvt_pk_bf16_f32 v25, v230, v231
    v_mfma_f32_16x16x32_bf16 v[152:155], a[152:155], v[52:55], v[152:155]
    ds_read_b64_tr_b16 v[42:43], v30 offset:41472
    v_cvt_pk_bf16_f32 v26, v244, v245
    v_mfma_f32_16x16x32_bf16 v[156:159], a[156:159], v[52:55], v[156:159]
    ds_read_b64_tr_b16 v[44:45], v31 offset:40960
    v_cvt_pk_bf16_f32 v27, v246, v247
    v_mfma_f32_16x16x32_bf16 v[160:163], a[144:147], v[56:59], v[160:163]
    s_add_u32 s54, s46, 7168
    ds_read_b64_tr_b16 v[46:47], v31 offset:41472
    v_mfma_f32_16x16x32_bf16 v[164:167], a[148:151], v[56:59], v[164:167]
    buffer_store_dwordx4 v[24:27], v2, s[20:23], s54 offen sc1
    v_mfma_f32_16x16x32_bf16 v[168:171], a[152:155], v[56:59], v[168:171]
    buffer_load_dwordx4 v9, s[12:15], s36 offen offset:1024 lds
    v_mfma_f32_16x16x32_bf16 v[172:175], a[156:159], v[56:59], v[172:175]
    v_mfma_f32_16x16x32_bf16 v[176:179], a[144:147], v[60:63], v[176:179]
    v_mfma_f32_16x16x32_bf16 v[180:183], a[148:151], v[60:63], v[180:183]
    v_mfma_f32_16x16x32_bf16 v[184:187], a[152:155], v[60:63], v[184:187]
    v_mfma_f32_16x16x32_bf16 v[188:191], a[156:159], v[60:63], v[188:191]
    s_waitcnt lgkmcnt(0)
    v_mfma_f32_16x16x32_bf16 v[128:131], a[160:163], v[32:35], v[128:131]
    ds_read_b64_tr_b16 v[48:49], v28 offset:45056
    v_lshrrev_b32 v96, 2, v1
    v_mfma_f32_16x16x32_bf16 v[132:135], a[164:167], v[32:35], v[132:135]
    ds_read_b64_tr_b16 v[50:51], v28 offset:45568
    v_lshrrev_b32 v97, 3, v1
    v_mfma_f32_16x16x32_bf16 v[136:139], a[168:171], v[32:35], v[136:139]
    ds_read_b64_tr_b16 v[52:53], v29 offset:45056
    v_mul_f32 v232, s50, v232
    v_mfma_f32_16x16x32_bf16 v[140:143], a[172:175], v[32:35], v[140:143]
    ds_read_b64_tr_b16 v[54:55], v29 offset:45568
    v_mul_f32 v233, s50, v233
    v_mfma_f32_16x16x32_bf16 v[144:147], a[160:163], v[36:39], v[144:147]
    ds_read_b64_tr_b16 v[56:57], v30 offset:45056
    v_mul_f32 v234, s50, v234
    v_mfma_f32_16x16x32_bf16 v[148:151], a[164:167], v[36:39], v[148:151]
    ds_read_b64_tr_b16 v[58:59], v30 offset:45568
    v_mul_f32 v235, s50, v235
    v_mfma_f32_16x16x32_bf16 v[152:155], a[168:171], v[36:39], v[152:155]
    ds_read_b64_tr_b16 v[60:61], v31 offset:45056
    v_mul_f32 v248, s50, v248
    v_mfma_f32_16x16x32_bf16 v[156:159], a[172:175], v[36:39], v[156:159]
    ds_read_b64_tr_b16 v[62:63], v31 offset:45568
    v_mul_f32 v249, s50, v249
    v_mfma_f32_16x16x32_bf16 v[160:163], a[160:163], v[40:43], v[160:163]
    v_mul_f32 v250, s50, v250
    v_mul_f32 v251, s50, v251
    v_mfma_f32_16x16x32_bf16 v[164:167], a[164:167], v[40:43], v[164:167]
    v_cvt_pk_bf16_f32 v24, v232, v233
    v_cvt_pk_bf16_f32 v25, v234, v235
    v_mfma_f32_16x16x32_bf16 v[168:171], a[168:171], v[40:43], v[168:171]
    v_cvt_pk_bf16_f32 v26, v248, v249
    v_cvt_pk_bf16_f32 v27, v250, v251
    v_mfma_f32_16x16x32_bf16 v[172:175], a[172:175], v[40:43], v[172:175]
    s_add_u32 s54, s46, 19456
    buffer_store_dwordx4 v[24:27], v2, s[20:23], s54 offen sc1
    v_and_b32 v98, 3, v1
    v_mfma_f32_16x16x32_bf16 v[176:179], a[160:163], v[44:47], v[176:179]
    v_xor_b32 v97, v97, v98
    v_lshlrev_b32 v97, 4, v97
    v_mfma_f32_16x16x32_bf16 v[180:183], a[164:167], v[44:47], v[180:183]
    v_lshl_add_u32 v97, v96, 7, v97
    v_add_u32 v96, s38, v97
    v_mfma_f32_16x16x32_bf16 v[184:187], a[168:171], v[44:47], v[184:187]
    v_xor_b32 v97, 64, v96
    v_mfma_f32_16x16x32_bf16 v[188:191], a[172:175], v[44:47], v[188:191]
    s_waitcnt vmcnt(17) lgkmcnt(0)
    s_barrier
    ds_read_b64_tr_b16 v[64:65], v96 offset:0
    ds_read_b64_tr_b16 v[66:67], v96 offset:2048
    v_mfma_f32_16x16x32_bf16 v[128:131], a[176:179], v[48:51], v[128:131]
    ds_read_b64_tr_b16 v[32:33], v28 offset:49152
    ds_read_b64_tr_b16 v[68:69], v96 offset:8
    v_mfma_f32_16x16x32_bf16 v[132:135], a[180:183], v[48:51], v[132:135]
    ds_read_b64_tr_b16 v[34:35], v28 offset:49664
    ds_read_b64_tr_b16 v[70:71], v96 offset:2056
    v_mfma_f32_16x16x32_bf16 v[136:139], a[184:187], v[48:51], v[136:139]
    ds_read_b64_tr_b16 v[36:37], v29 offset:49152
    ds_read_b64_tr_b16 v[72:73], v97 offset:0
    v_mfma_f32_16x16x32_bf16 v[140:143], a[188:191], v[48:51], v[140:143]
    ds_read_b64_tr_b16 v[38:39], v29 offset:49664
    ds_read_b64_tr_b16 v[74:75], v97 offset:2048
    v_mfma_f32_16x16x32_bf16 v[144:147], a[176:179], v[52:55], v[144:147]
    ds_read_b64_tr_b16 v[40:41], v30 offset:49152
    ds_read_b64_tr_b16 v[76:77], v97 offset:8
    v_mfma_f32_16x16x32_bf16 v[148:151], a[180:183], v[52:55], v[148:151]
    ds_read_b64_tr_b16 v[42:43], v30 offset:49664
    ds_read_b64_tr_b16 v[78:79], v97 offset:2056
    v_mfma_f32_16x16x32_bf16 v[152:155], a[184:187], v[52:55], v[152:155]
    ds_read_b64_tr_b16 v[44:45], v31 offset:49152
    v_mfma_f32_16x16x32_bf16 v[156:159], a[188:191], v[52:55], v[156:159]
    ds_read_b64_tr_b16 v[46:47], v31 offset:49664
    v_mfma_f32_16x16x32_bf16 v[160:163], a[176:179], v[56:59], v[160:163]
    v_mfma_f32_16x16x32_bf16 v[164:167], a[180:183], v[56:59], v[164:167]
    v_mfma_f32_16x16x32_bf16 v[168:171], a[184:187], v[56:59], v[168:171]
    v_mfma_f32_16x16x32_bf16 v[172:175], a[188:191], v[56:59], v[172:175]
    v_mfma_f32_16x16x32_bf16 v[176:179], a[176:179], v[60:63], v[176:179]
    v_mfma_f32_16x16x32_bf16 v[180:183], a[180:183], v[60:63], v[180:183]
    v_mfma_f32_16x16x32_bf16 v[184:187], a[184:187], v[60:63], v[184:187]
    v_mfma_f32_16x16x32_bf16 v[188:191], a[188:191], v[60:63], v[188:191]
    s_and_b32 s100, s29, 7
    s_cmp_lg_u32 s100, 0
    s_cbranch_scc1 RL_b
    ds_read_b64_tr_b16 v[80:81], v96 offset:4096
    ds_read_b64_tr_b16 v[82:83], v96 offset:6144
    ds_read_b64_tr_b16 v[84:85], v96 offset:4104
    ds_read_b64_tr_b16 v[86:87], v96 offset:6152
    ds_read_b64_tr_b16 v[88:89], v97 offset:4096
    ds_read_b64_tr_b16 v[90:91], v97 offset:6144
    ds_read_b64_tr_b16 v[92:93], v97 offset:4104
    ds_read_b64_tr_b16 v[94:95], v97 offset:6152
RL_b:
    s_waitcnt lgkmcnt(0)
    v_mfma_f32_16x16x32_bf16 v[128:131], a[192:195], v[32:35], v[128:131]
    s_bfe_u32 s45, s32, 196616
    s_lshl_b32 s45, s45, 7
    ds_read_b64_tr_b16 v[48:49], v28 offset:53248
    v_mfma_f32_16x16x32_bf16 v[132:135], a[196:199], v[32:35], v[132:135]
    s_lshl_b32 s36, s45, 12
    ds_read_b64_tr_b16 v[50:51], v28 offset:53760
    v_mfma_f32_16x16x32_bf16 v[136:139], a[200:203], v[32:35], v[136:139]
    s_add_u32 s36, s36, s37
    ds_read_b64_tr_b16 v[52:53], v29 offset:53248
    v_mul_f32 v236, s50, v236
    v_mfma_f32_16x16x32_bf16 v[140:143], a[204:207], v[32:35], v[140:143]
    s_add_u32 m0, s39, 32768
    ds_read_b64_tr_b16 v[54:55], v29 offset:53760
    v_mul_f32 v237, s50, v237
    v_mfma_f32_16x16x32_bf16 v[144:147], a[192:195], v[36:39], v[144:147]
    buffer_load_dwordx4 v8, s[12:15], s36 offen lds
    v_mul_f32 v238, s50, v238
    v_mfma_f32_16x16x32_bf16 v[148:151], a[196:199], v[36:39], v[148:151]
    ds_read_b64_tr_b16 v[56:57], v30 offset:53248
    v_mul_f32 v239, s50, v239
    v_mfma_f32_16x16x32_bf16 v[152:155], a[200:203], v[36:39], v[152:155]
    ds_read_b64_tr_b16 v[58:59], v30 offset:53760
    v_mul_f32 v252, s50, v252
    v_mfma_f32_16x16x32_bf16 v[156:159], a[204:207], v[36:39], v[156:159]
    ds_read_b64_tr_b16 v[60:61], v31 offset:53248
    v_mul_f32 v253, s50, v253
    v_mfma_f32_16x16x32_bf16 v[160:163], a[192:195], v[40:43], v[160:163]
    ds_read_b64_tr_b16 v[62:63], v31 offset:53760
    v_mul_f32 v254, s50, v254
    v_mfma_f32_16x16x32_bf16 v[164:167], a[196:199], v[40:43], v[164:167]
    v_mul_f32 v255, s50, v255
    v_cvt_pk_bf16_f32 v24, v236, v237
    v_mfma_f32_16x16x32_bf16 v[168:171], a[200:203], v[40:43], v[168:171]
    buffer_load_dwordx4 v9, s[12:15], s36 offen offset:1024 lds
    v_cvt_pk_bf16_f32 v25, v238, v239
    v_mfma_f32_16x16x32_bf16 v[172:175], a[204:207], v[40:43], v[172:175]
    v_cvt_pk_bf16_f32 v26, v252, v253
    v_cvt_pk_bf16_f32 v27, v254, v255
    v_mfma_f32_16x16x32_bf16 v[176:179], a[192:195], v[44:47], v[176:179]
    s_add_u32 s54, s46, 23552
    buffer_store_dwordx4 v[24:27], v2, s[20:23], s54 offen sc1
    v_mfma_f32_16x16x32_bf16 v[180:183], a[196:199], v[44:47], v[180:183]
    v_mfma_f32_16x16x32_bf16 v[184:187], a[200:203], v[44:47], v[184:187]
    v_mfma_f32_16x16x32_bf16 v[188:191], a[204:207], v[44:47], v[188:191]
    s_waitcnt lgkmcnt(0)
    v_mfma_f32_16x16x32_bf16 v[128:131], a[208:211], v[48:51], v[128:131]
    s_lshr_b32 s40, s29, 3
    s_lshl_b32 s40, s40, 2
    s_lshr_b32 s101, s30, 1
    s_add_u32 s40, s40, s101
    s_lshl_b32 s40, s40, 3
    s_and_b32 s101, s29, 7
    s_add_u32 s40, s40, s101
    s_lshl2_add_u32 s40, s40, s28
    s_and_b32 s101, s30, 1
    s_lshl1_add_u32 s40, s40, s101
    s_lshl_b32 s40, s40, 12
    s_add_u32 s40, s40, 58720256
    ds_read_b64_tr_b16 v[32:33], v28 offset:57344
    v_mfma_f32_16x16x32_bf16 v[132:135], a[212:215], v[48:51], v[132:135]
    ds_read_b64_tr_b16 v[34:35], v28 offset:57856
    v_mfma_f32_16x16x32_bf16 v[136:139], a[216:219], v[48:51], v[136:139]
    s_add_u32 s36, s36, 262144
    ds_read_b64_tr_b16 v[36:37], v29 offset:57344
    buffer_store_dwordx4 v[64:67], v2, s[20:23], s40 offen offset:0 sc1
    v_mfma_f32_16x16x32_bf16 v[140:143], a[220:223], v[48:51], v[140:143]
    s_add_u32 m0, s39, 40960
    ds_read_b64_tr_b16 v[38:39], v29 offset:57856
    v_mfma_f32_16x16x32_bf16 v[144:147], a[208:211], v[52:55], v[144:147]
    buffer_load_dwordx4 v8, s[12:15], s36 offen lds
    v_mfma_f32_16x16x32_bf16 v[148:151], a[212:215], v[52:55], v[148:151]
    ds_read_b64_tr_b16 v[40:41], v30 offset:57344
    v_mfma_f32_16x16x32_bf16 v[152:155], a[216:219], v[52:55], v[152:155]
    ds_read_b64_tr_b16 v[42:43], v30 offset:57856
    buffer_store_dwordx4 v[68:71], v2, s[20:23], s40 offen offset:1024 sc1
    v_mfma_f32_16x16x32_bf16 v[156:159], a[220:223], v[52:55], v[156:159]
    ds_read_b64_tr_b16 v[44:45], v31 offset:57344
    v_mfma_f32_16x16x32_bf16 v[160:163], a[208:211], v[56:59], v[160:163]
    ds_read_b64_tr_b16 v[46:47], v31 offset:57856
    v_mfma_f32_16x16x32_bf16 v[164:167], a[212:215], v[56:59], v[164:167]
    buffer_store_dwordx4 v[72:75], v2, s[20:23], s40 offen offset:2048 sc1
    v_mfma_f32_16x16x32_bf16 v[168:171], a[216:219], v[56:59], v[168:171]
    buffer_load_dwordx4 v9, s[12:15], s36 offen offset:1024 lds
    v_mfma_f32_16x16x32_bf16 v[172:175], a[220:223], v[56:59], v[172:175]
    buffer_store_dwordx4 v[76:79], v2, s[20:23], s40 offen offset:3072 sc1
    v_mfma_f32_16x16x32_bf16 v[176:179], a[208:211], v[60:63], v[176:179]
    v_mfma_f32_16x16x32_bf16 v[180:183], a[212:215], v[60:63], v[180:183]
    v_mfma_f32_16x16x32_bf16 v[184:187], a[216:219], v[60:63], v[184:187]
    v_mfma_f32_16x16x32_bf16 v[188:191], a[220:223], v[60:63], v[188:191]
    s_waitcnt lgkmcnt(0)
    v_mfma_f32_16x16x32_bf16 v[128:131], a[224:227], v[32:35], v[128:131]
    s_bfe_u32 s35, s32, 196616
    ds_read_b64_tr_b16 v[48:49], v28 offset:61440
    v_mfma_f32_16x16x32_bf16 v[132:135], a[228:231], v[32:35], v[132:135]
    s_lshl_b32 s35, s35, 7
    ds_read_b64_tr_b16 v[50:51], v28 offset:61952
    v_mfma_f32_16x16x32_bf16 v[136:139], a[232:235], v[32:35], v[136:139]
    s_add_u32 s47, s33, s35
    ds_read_b64_tr_b16 v[52:53], v29 offset:61440
    v_mfma_f32_16x16x32_bf16 v[140:143], a[236:239], v[32:35], v[140:143]
    s_add_u32 m0, s38, 0
    ds_read_b64_tr_b16 v[54:55], v29 offset:61952
    v_mfma_f32_16x16x32_bf16 v[144:147], a[224:227], v[36:39], v[144:147]
    buffer_load_dwordx4 v4, s[4:7], s47 offen offset:0 lds
    v_mfma_f32_16x16x32_bf16 v[148:151], a[228:231], v[36:39], v[148:151]
    ds_read_b64_tr_b16 v[56:57], v30 offset:61440
    v_mfma_f32_16x16x32_bf16 v[152:155], a[232:235], v[36:39], v[152:155]
    buffer_load_dwordx4 v5, s[4:7], s47 offen offset:1024 lds
    s_add_u32 s47, s41, s35
    v_mfma_f32_16x16x32_bf16 v[156:159], a[236:239], v[36:39], v[156:159]
    s_add_u32 m0, s38, 2048
    ds_read_b64_tr_b16 v[58:59], v30 offset:61952
    v_mfma_f32_16x16x32_bf16 v[160:163], a[224:227], v[40:43], v[160:163]
    buffer_load_dwordx4 v4, s[4:7], s47 offen offset:0 lds
    v_mfma_f32_16x16x32_bf16 v[164:167], a[228:231], v[40:43], v[164:167]
    ds_read_b64_tr_b16 v[60:61], v31 offset:61440
    v_mfma_f32_16x16x32_bf16 v[168:171], a[232:235], v[40:43], v[168:171]
    buffer_load_dwordx4 v5, s[4:7], s47 offen offset:1024 lds
    v_mfma_f32_16x16x32_bf16 v[172:175], a[236:239], v[40:43], v[172:175]
    ds_read_b64_tr_b16 v[62:63], v31 offset:61952
    v_mfma_f32_16x16x32_bf16 v[176:179], a[224:227], v[44:47], v[176:179]
    s_and_b32 s100, s29, 7
    s_cmp_lg_u32 s100, 0
    s_cbranch_scc1 RL_c
    s_lshl_b32 s100, s30, 4
    s_lshr_b32 s101, s29, 1
    s_add_u32 s100, s100, s101
    s_add_u32 s100, s100, s28
    s_lshl_b32 s100, s100, 12
    s_add_u32 s100, s100, 62914560
    buffer_store_dwordx4 v[80:83], v2, s[20:23], s100 offen offset:0 sc1
    buffer_store_dwordx4 v[84:87], v2, s[20:23], s100 offen offset:1024 sc1
    buffer_store_dwordx4 v[88:91], v2, s[20:23], s100 offen offset:2048 sc1
    buffer_store_dwordx4 v[92:95], v2, s[20:23], s100 offen offset:3072 sc1
RL_c:
    v_mfma_f32_16x16x32_bf16 v[180:183], a[228:231], v[44:47], v[180:183]
    v_mfma_f32_16x16x32_bf16 v[184:187], a[232:235], v[44:47], v[184:187]
    v_mfma_f32_16x16x32_bf16 v[188:191], a[236:239], v[44:47], v[188:191]
    s_waitcnt vmcnt(22) lgkmcnt(0)
    s_barrier
    v_mfma_f32_16x16x32_bf16 v[128:131], a[240:243], v[48:51], v[128:131]
    s_add_u32 s47, s34, s35
    ds_read_b128 a[0:3], v12 offset:8192
    ds_read_b128 a[4:7], v12 offset:10240
    v_mfma_f32_16x16x32_bf16 v[132:135], a[244:247], v[48:51], v[132:135]
    s_add_u32 m0, s38, 4096
    ds_read_b128 a[8:11], v12 offset:12288
    ds_read_b128 a[12:15], v12 offset:14336
    v_mfma_f32_16x16x32_bf16 v[136:139], a[248:251], v[48:51], v[136:139]
    buffer_load_dwordx4 v4, s[4:7], s47 offen offset:0 lds
    v_mfma_f32_16x16x32_bf16 v[140:143], a[252:255], v[48:51], v[140:143]
    ds_read_b64_tr_b16 a[40:41], v16 offset:0
    v_mfma_f32_16x16x32_bf16 v[144:147], a[240:243], v[52:55], v[144:147]
    ds_read_b64_tr_b16 a[42:43], v16 offset:1024
    ds_read_b64_tr_b16 a[44:45], v17 offset:0
    v_mfma_f32_16x16x32_bf16 v[148:151], a[244:247], v[52:55], v[148:151]
    buffer_load_dwordx4 v5, s[4:7], s47 offen offset:1024 lds
    v_mfma_f32_16x16x32_bf16 v[152:155], a[248:251], v[52:55], v[152:155]
    ds_read_b64_tr_b16 a[46:47], v17 offset:1024
    ds_read_b64_tr_b16 a[48:49], v18 offset:0
    v_mfma_f32_16x16x32_bf16 v[156:159], a[252:255], v[52:55], v[156:159]
    ds_read_b64_tr_b16 a[50:51], v18 offset:1024
    v_mfma_f32_16x16x32_bf16 v[160:163], a[240:243], v[56:59], v[160:163]
    buffer_load_dwordx4 v6, s[4:7], s47 offen offset:2048 lds
    v_mfma_f32_16x16x32_bf16 v[164:167], a[244:247], v[56:59], v[164:167]
    ds_read_b64_tr_b16 a[52:53], v19 offset:0
    ds_read_b64_tr_b16 a[54:55], v19 offset:1024
    v_mfma_f32_16x16x32_bf16 v[168:171], a[248:251], v[56:59], v[168:171]
    ds_read_b64_tr_b16 a[56:57], v20 offset:0
    ds_read_b64_tr_b16 a[58:59], v20 offset:1024
    v_mfma_f32_16x16x32_bf16 v[172:175], a[252:255], v[56:59], v[172:175]
    buffer_load_dwordx4 v7, s[4:7], s47 offen offset:3072 lds
    v_mfma_f32_16x16x32_bf16 v[176:179], a[240:243], v[60:63], v[176:179]
    ds_read_b64_tr_b16 a[60:61], v21 offset:0
    v_mfma_f32_16x16x32_bf16 v[180:183], a[244:247], v[60:63], v[180:183]
    ds_read_b64_tr_b16 a[62:63], v21 offset:1024
    ds_read_b64_tr_b16 a[64:65], v22 offset:0
    v_mfma_f32_16x16x32_bf16 v[184:187], a[248:251], v[60:63], v[184:187]
    ds_read_b64_tr_b16 a[66:67], v22 offset:1024
    ds_read_b64_tr_b16 a[68:69], v23 offset:0
    v_mfma_f32_16x16x32_bf16 v[188:191], a[252:255], v[60:63], v[188:191]
    ds_read_b64_tr_b16 a[70:71], v23 offset:1024
    s_waitcnt lgkmcnt(12)
    v_mfma_f32_16x16x32_bf16 v[64:67], a[40:43], a[0:3], 0
    ds_read_b128 a[20:23], v13 offset:8192
    v_mfma_f32_16x16x32_bf16 v[68:71], a[40:43], a[4:7], 0
    s_bfe_u32 s45, s32, 196620
    ds_read_b128 a[24:27], v13 offset:10240
    v_mfma_f32_16x16x32_bf16 v[72:75], a[40:43], a[8:11], 0
    s_lshl_b32 s45, s45, 7
    ds_read_b128 a[28:31], v13 offset:12288
    v_cvt_pk_bf16_f32 v24, v128, v129
    v_mfma_f32_16x16x32_bf16 v[76:79], a[40:43], a[12:15], 0
    s_lshl_b32 s36, s45, 12
    ds_read_b128 a[32:35], v13 offset:14336
    v_cvt_pk_bf16_f32 v25, v130, v131
    v_mfma_f32_16x16x32_bf16 v[80:83], a[44:47], a[0:3], 0
    s_add_u32 s36, s36, s37
    ds_read_b64_tr_b16 a[72:73], v16 offset:8192
    v_cvt_pk_bf16_f32 v26, v132, v133
    v_mfma_f32_16x16x32_bf16 v[84:87], a[44:47], a[4:7], 0
    s_add_u32 m0, s39, 49152
    ds_read_b64_tr_b16 a[74:75], v16 offset:9216
    v_cvt_pk_bf16_f32 v27, v134, v135
    v_mfma_f32_16x16x32_bf16 v[88:91], a[44:47], a[8:11], 0
    s_add_u32 s54, s46, 28672
    buffer_load_dwordx4 v8, s[12:15], s36 offen lds
    v_mfma_f32_16x16x32_bf16 v[92:95], a[44:47], a[12:15], 0
    s_waitcnt lgkmcnt(6)
    ds_read_b64_tr_b16 a[76:77], v17 offset:8192
    v_mfma_f32_16x16x32_bf16 v[96:99], a[48:51], a[0:3], 0
    ds_read_b64_tr_b16 a[78:79], v17 offset:9216
    buffer_store_dwordx4 v[24:27], v2, s[20:23], s54 offen sc1
    v_mfma_f32_16x16x32_bf16 v[100:103], a[48:51], a[4:7], 0
    ds_read_b64_tr_b16 a[80:81], v18 offset:8192
    v_mfma_f32_16x16x32_bf16 v[104:107], a[48:51], a[8:11], 0
    buffer_load_dwordx4 v9, s[12:15], s36 offen offset:1024 lds
    v_cvt_pk_bf16_f32 v24, v136, v137
    v_mfma_f32_16x16x32_bf16 v[108:111], a[48:51], a[12:15], 0
    ds_read_b64_tr_b16 a[82:83], v18 offset:9216
    v_cvt_pk_bf16_f32 v25, v138, v139
    v_mfma_f32_16x16x32_bf16 v[112:115], a[52:55], a[0:3], 0
    s_add_u32 s36, s36, 262144
    ds_read_b64_tr_b16 a[84:85], v19 offset:8192
    v_cvt_pk_bf16_f32 v26, v140, v141
    v_mfma_f32_16x16x32_bf16 v[116:119], a[52:55], a[4:7], 0
    s_add_u32 m0, s39, 57344
    ds_read_b64_tr_b16 a[86:87], v19 offset:9216
    v_cvt_pk_bf16_f32 v27, v142, v143
    v_mfma_f32_16x16x32_bf16 v[120:123], a[52:55], a[8:11], 0
    s_add_u32 s54, s46, 45056
    buffer_load_dwordx4 v8, s[12:15], s36 offen lds
    v_mfma_f32_16x16x32_bf16 v[124:127], a[52:55], a[12:15], 0
    ds_read_b64_tr_b16 a[88:89], v20 offset:8192
    v_mfma_f32_16x16x32_bf16 v[192:195], a[56:59], a[0:3], 0
    ds_read_b64_tr_b16 a[90:91], v20 offset:9216
    buffer_store_dwordx4 v[24:27], v2, s[20:23], s54 offen sc1
    v_mfma_f32_16x16x32_bf16 v[196:199], a[56:59], a[4:7], 0
    ds_read_b64_tr_b16 a[92:93], v21 offset:8192
    v_mfma_f32_16x16x32_bf16 v[200:203], a[56:59], a[8:11], 0
    buffer_load_dwordx4 v9, s[12:15], s36 offen offset:1024 lds
    v_mfma_f32_16x16x32_bf16 v[204:207], a[56:59], a[12:15], 0
    ds_read_b64_tr_b16 a[94:95], v21 offset:9216
    v_mfma_f32_16x16x32_bf16 v[208:211], a[60:63], a[0:3], 0
    ds_read_b64_tr_b16 a[96:97], v22 offset:8192
    v_mfma_f32_16x16x32_bf16 v[212:215], a[60:63], a[4:7], 0
    ds_read_b64_tr_b16 a[98:99], v22 offset:9216
    v_mfma_f32_16x16x32_bf16 v[216:219], a[60:63], a[8:11], 0
    ds_read_b64_tr_b16 a[100:101], v23 offset:8192
    v_mfma_f32_16x16x32_bf16 v[220:223], a[60:63], a[12:15], 0
    ds_read_b64_tr_b16 a[102:103], v23 offset:9216
    v_mfma_f32_16x16x32_bf16 v[224:227], a[64:67], a[0:3], 0
    v_mfma_f32_16x16x32_bf16 v[228:231], a[64:67], a[4:7], 0
    v_mfma_f32_16x16x32_bf16 v[232:235], a[64:67], a[8:11], 0
    v_mfma_f32_16x16x32_bf16 v[236:239], a[64:67], a[12:15], 0
    v_mfma_f32_16x16x32_bf16 v[240:243], a[68:71], a[0:3], 0
    v_mfma_f32_16x16x32_bf16 v[244:247], a[68:71], a[4:7], 0
    v_mfma_f32_16x16x32_bf16 v[248:251], a[68:71], a[8:11], 0
    v_mfma_f32_16x16x32_bf16 v[252:255], a[68:71], a[12:15], 0
    s_waitcnt lgkmcnt(12)
    v_mfma_f32_16x16x32_bf16 v[64:67], a[72:75], a[20:23], v[64:67]
    v_mfma_f32_16x16x32_bf16 v[68:71], a[72:75], a[24:27], v[68:71]
    v_mfma_f32_16x16x32_bf16 v[72:75], a[72:75], a[28:31], v[72:75]
    s_bfe_u32 s35, s32, 196620
    v_cvt_pk_bf16_f32 v24, v144, v145
    v_cvt_pk_bf16_f32 v25, v146, v147
    v_mfma_f32_16x16x32_bf16 v[76:79], a[72:75], a[32:35], v[76:79]
    s_waitcnt vmcnt(24) lgkmcnt(0)
    s_barrier
    s_lshl_b32 s35, s35, 7
    v_cvt_pk_bf16_f32 v26, v148, v149
    v_cvt_pk_bf16_f32 v27, v150, v151
    v_mfma_f32_16x16x32_bf16 v[80:83], a[76:79], a[20:23], v[80:83]
    s_add_u32 s47, s33, s35
    s_add_u32 s54, s46, 29696
    ds_read_b128 a[0:3], v12 offset:16384
    v_mfma_f32_16x16x32_bf16 v[84:87], a[76:79], a[24:27], v[84:87]
    s_add_u32 m0, s38, 8192
    ds_read_b128 a[4:7], v12 offset:18432
    v_mfma_f32_16x16x32_bf16 v[88:91], a[76:79], a[28:31], v[88:91]
    buffer_load_dwordx4 v4, s[4:7], s47 offen offset:0 lds
    buffer_store_dwordx4 v[24:27], v2, s[20:23], s54 offen sc1
    v_mfma_f32_16x16x32_bf16 v[92:95], a[76:79], a[32:35], v[92:95]
    ds_read_b128 a[8:11], v12 offset:20480
    v_mfma_f32_16x16x32_bf16 v[96:99], a[80:83], a[20:23], v[96:99]
    ds_read_b128 a[12:15], v12 offset:22528
    v_cvt_pk_bf16_f32 v24, v152, v153
    v_mfma_f32_16x16x32_bf16 v[100:103], a[80:83], a[24:27], v[100:103]
    buffer_load_dwordx4 v5, s[4:7], s47 offen offset:1024 lds
    v_cvt_pk_bf16_f32 v25, v154, v155
    v_mfma_f32_16x16x32_bf16 v[104:107], a[80:83], a[28:31], v[104:107]
    s_add_u32 s47, s41, s35
    ds_read_b64_tr_b16 a[40:41], v16 offset:16384
    v_cvt_pk_bf16_f32 v26, v156, v157
    v_mfma_f32_16x16x32_bf16 v[108:111], a[80:83], a[32:35], v[108:111]
    s_add_u32 m0, s38, 10240
    ds_read_b64_tr_b16 a[42:43], v16 offset:17408
    v_cvt_pk_bf16_f32 v27, v158, v159
    v_mfma_f32_16x16x32_bf16 v[112:115], a[84:87], a[20:23], v[112:115]
    s_add_u32 s54, s46, 46080
    buffer_load_dwordx4 v4, s[4:7], s47 offen offset:0 lds
    v_mfma_f32_16x16x32_bf16 v[116:119], a[84:87], a[24:27], v[116:119]
    ds_read_b64_tr_b16 a[44:45], v17 offset:16384
    v_mfma_f32_16x16x32_bf16 v[120:123], a[84:87], a[28:31], v[120:123]
    ds_read_b64_tr_b16 a[46:47], v17 offset:17408
    buffer_store_dwordx4 v[24:27], v2, s[20:23], s54 offen sc1
    v_mfma_f32_16x16x32_bf16 v[124:127], a[84:87], a[32:35], v[124:127]
    buffer_load_dwordx4 v5, s[4:7], s47 offen offset:1024 lds
    v_mfma_f32_16x16x32_bf16 v[192:195], a[88:91], a[20:23], v[192:195]
    s_add_u32 s47, s34, s35
    ds_read_b64_tr_b16 a[48:49], v18 offset:16384
    v_mfma_f32_16x16x32_bf16 v[196:199], a[88:91], a[24:27], v[196:199]
    s_add_u32 m0, s38, 12288
    ds_read_b64_tr_b16 a[50:51], v18 offset:17408
    v_mfma_f32_16x16x32_bf16 v[200:203], a[88:91], a[28:31], v[200:203]
    buffer_load_dwordx4 v4, s[4:7], s47 offen offset:0 lds
    v_mfma_f32_16x16x32_bf16 v[204:207], a[88:91], a[32:35], v[204:207]
    ds_read_b64_tr_b16 a[52:53], v19 offset:16384
    v_mfma_f32_16x16x32_bf16 v[208:211], a[92:95], a[20:23], v[208:211]
    ds_read_b64_tr_b16 a[54:55], v19 offset:17408
    v_mfma_f32_16x16x32_bf16 v[212:215], a[92:95], a[24:27], v[212:215]
    buffer_load_dwordx4 v5, s[4:7], s47 offen offset:1024 lds
    v_mfma_f32_16x16x32_bf16 v[216:219], a[92:95], a[28:31], v[216:219]
    ds_read_b64_tr_b16 a[56:57], v20 offset:16384
    v_mfma_f32_16x16x32_bf16 v[220:223], a[92:95], a[32:35], v[220:223]
    ds_read_b64_tr_b16 a[58:59], v20 offset:17408
    v_mfma_f32_16x16x32_bf16 v[224:227], a[96:99], a[20:23], v[224:227]
    buffer_load_dwordx4 v6, s[4:7], s47 offen offset:2048 lds
    v_mfma_f32_16x16x32_bf16 v[228:231], a[96:99], a[24:27], v[228:231]
    ds_read_b64_tr_b16 a[60:61], v21 offset:16384
    v_mfma_f32_16x16x32_bf16 v[232:235], a[96:99], a[28:31], v[232:235]
    ds_read_b64_tr_b16 a[62:63], v21 offset:17408
    v_mfma_f32_16x16x32_bf16 v[236:239], a[96:99], a[32:35], v[236:239]
    buffer_load_dwordx4 v7, s[4:7], s47 offen offset:3072 lds
    v_mfma_f32_16x16x32_bf16 v[240:243], a[100:103], a[20:23], v[240:243]
    ds_read_b64_tr_b16 a[64:65], v22 offset:16384
    v_mfma_f32_16x16x32_bf16 v[244:247], a[100:103], a[24:27], v[244:247]
    ds_read_b64_tr_b16 a[66:67], v22 offset:17408
    v_mfma_f32_16x16x32_bf16 v[248:251], a[100:103], a[28:31], v[248:251]
    ds_read_b64_tr_b16 a[68:69], v23 offset:16384
    v_mfma_f32_16x16x32_bf16 v[252:255], a[100:103], a[32:35], v[252:255]
    ds_read_b64_tr_b16 a[70:71], v23 offset:17408
    s_waitcnt lgkmcnt(12)
    v_mfma_f32_16x16x32_bf16 v[64:67], a[40:43], a[0:3], v[64:67]
    ds_read_b128 a[20:23], v13 offset:16384
    v_mfma_f32_16x16x32_bf16 v[68:71], a[40:43], a[4:7], v[68:71]
    s_bfe_u32 s45, s32, 196624
    ds_read_b128 a[24:27], v13 offset:18432
    v_mfma_f32_16x16x32_bf16 v[72:75], a[40:43], a[8:11], v[72:75]
    s_lshl_b32 s45, s45, 7
    ds_read_b128 a[28:31], v13 offset:20480
    v_cvt_pk_bf16_f32 v24, v160, v161
    v_mfma_f32_16x16x32_bf16 v[76:79], a[40:43], a[12:15], v[76:79]
    s_lshl_b32 s36, s45, 12
    ds_read_b128 a[32:35], v13 offset:22528
    v_cvt_pk_bf16_f32 v25, v162, v163
    v_mfma_f32_16x16x32_bf16 v[80:83], a[44:47], a[0:3], v[80:83]
    s_add_u32 s36, s36, s37
    ds_read_b64_tr_b16 a[72:73], v16 offset:24576
    v_cvt_pk_bf16_f32 v26, v164, v165
    v_mfma_f32_16x16x32_bf16 v[84:87], a[44:47], a[4:7], v[84:87]
    s_add_u32 m0, s39, 0
    ds_read_b64_tr_b16 a[74:75], v16 offset:25600
    v_cvt_pk_bf16_f32 v27, v166, v167
    v_mfma_f32_16x16x32_bf16 v[88:91], a[44:47], a[8:11], v[88:91]
    s_add_u32 s54, s46, 30720
    buffer_load_dwordx4 v8, s[12:15], s36 offen lds
    v_mfma_f32_16x16x32_bf16 v[92:95], a[44:47], a[12:15], v[92:95]
    s_waitcnt lgkmcnt(6)
    ds_read_b64_tr_b16 a[76:77], v17 offset:24576
    v_mfma_f32_16x16x32_bf16 v[96:99], a[48:51], a[0:3], v[96:99]
    ds_read_b64_tr_b16 a[78:79], v17 offset:25600
    buffer_store_dwordx4 v[24:27], v2, s[20:23], s54 offen sc1
    v_mfma_f32_16x16x32_bf16 v[100:103], a[48:51], a[4:7], v[100:103]
    ds_read_b64_tr_b16 a[80:81], v18 offset:24576
    v_mfma_f32_16x16x32_bf16 v[104:107], a[48:51], a[8:11], v[104:107]
    buffer_load_dwordx4 v9, s[12:15], s36 offen offset:1024 lds
    v_cvt_pk_bf16_f32 v24, v168, v169
    v_mfma_f32_16x16x32_bf16 v[108:111], a[48:51], a[12:15], v[108:111]
    ds_read_b64_tr_b16 a[82:83], v18 offset:25600
    v_cvt_pk_bf16_f32 v25, v170, v171
    v_mfma_f32_16x16x32_bf16 v[112:115], a[52:55], a[0:3], v[112:115]
    s_add_u32 s36, s36, 262144
    ds_read_b64_tr_b16 a[84:85], v19 offset:24576
    v_cvt_pk_bf16_f32 v26, v172, v173
    v_mfma_f32_16x16x32_bf16 v[116:119], a[52:55], a[4:7], v[116:119]
    s_add_u32 m0, s39, 8192
    ds_read_b64_tr_b16 a[86:87], v19 offset:25600
    v_cvt_pk_bf16_f32 v27, v174, v175
    v_mfma_f32_16x16x32_bf16 v[120:123], a[52:55], a[8:11], v[120:123]
    s_add_u32 s54, s46, 47104
    buffer_load_dwordx4 v8, s[12:15], s36 offen lds
    v_mfma_f32_16x16x32_bf16 v[124:127], a[52:55], a[12:15], v[124:127]
    ds_read_b64_tr_b16 a[88:89], v20 offset:24576
    v_mfma_f32_16x16x32_bf16 v[192:195], a[56:59], a[0:3], v[192:195]
    ds_read_b64_tr_b16 a[90:91], v20 offset:25600
    buffer_store_dwordx4 v[24:27], v2, s[20:23], s54 offen sc1
    v_mfma_f32_16x16x32_bf16 v[196:199], a[56:59], a[4:7], v[196:199]
    ds_read_b64_tr_b16 a[92:93], v21 offset:24576
    v_mfma_f32_16x16x32_bf16 v[200:203], a[56:59], a[8:11], v[200:203]
    buffer_load_dwordx4 v9, s[12:15], s36 offen offset:1024 lds
    v_mfma_f32_16x16x32_bf16 v[204:207], a[56:59], a[12:15], v[204:207]
    ds_read_b64_tr_b16 a[94:95], v21 offset:25600
    v_mfma_f32_16x16x32_bf16 v[208:211], a[60:63], a[0:3], v[208:211]
    ds_read_b64_tr_b16 a[96:97], v22 offset:24576
    v_mfma_f32_16x16x32_bf16 v[212:215], a[60:63], a[4:7], v[212:215]
    ds_read_b64_tr_b16 a[98:99], v22 offset:25600
    v_mfma_f32_16x16x32_bf16 v[216:219], a[60:63], a[8:11], v[216:219]
    ds_read_b64_tr_b16 a[100:101], v23 offset:24576
    v_mfma_f32_16x16x32_bf16 v[220:223], a[60:63], a[12:15], v[220:223]
    ds_read_b64_tr_b16 a[102:103], v23 offset:25600
    v_mfma_f32_16x16x32_bf16 v[224:227], a[64:67], a[0:3], v[224:227]
    v_mfma_f32_16x16x32_bf16 v[228:231], a[64:67], a[4:7], v[228:231]
    v_mfma_f32_16x16x32_bf16 v[232:235], a[64:67], a[8:11], v[232:235]
    v_mfma_f32_16x16x32_bf16 v[236:239], a[64:67], a[12:15], v[236:239]
    v_mfma_f32_16x16x32_bf16 v[240:243], a[68:71], a[0:3], v[240:243]
    s_mul_i32 s55, s29, 1065984
    s_add_u32 s8, s78, s55
    s_addc_u32 s9, s79, 0
    s_mul_i32 s55, s30, 65536
    s_sub_u32 s10, 1064960, s55
    s_lshl_b32 s0, s28, 12
    v_mfma_f32_16x16x32_bf16 v[244:247], a[68:71], a[4:7], v[244:247]
    v_mfma_f32_16x16x32_bf16 v[248:251], a[68:71], a[8:11], v[248:251]
    v_mfma_f32_16x16x32_bf16 v[252:255], a[68:71], a[12:15], v[252:255]
    s_waitcnt lgkmcnt(12)
    v_mfma_f32_16x16x32_bf16 v[64:67], a[72:75], a[20:23], v[64:67]
    v_mfma_f32_16x16x32_bf16 v[68:71], a[72:75], a[24:27], v[68:71]
    v_mfma_f32_16x16x32_bf16 v[72:75], a[72:75], a[28:31], v[72:75]
    s_bfe_u32 s35, s32, 196624
    v_cvt_pk_bf16_f32 v24, v176, v177
    v_cvt_pk_bf16_f32 v25, v178, v179
    v_mfma_f32_16x16x32_bf16 v[76:79], a[72:75], a[32:35], v[76:79]
    s_waitcnt vmcnt(22) lgkmcnt(0)
    s_barrier
    s_lshl_b32 s35, s35, 7
    v_cvt_pk_bf16_f32 v26, v180, v181
    v_cvt_pk_bf16_f32 v27, v182, v183
    v_mfma_f32_16x16x32_bf16 v[80:83], a[76:79], a[20:23], v[80:83]
    s_add_u32 s47, s33, s35
    s_add_u32 s54, s46, 31744
    ds_read_b128 a[0:3], v12 offset:0
    v_mfma_f32_16x16x32_bf16 v[84:87], a[76:79], a[24:27], v[84:87]
    s_add_u32 m0, s38, 16384
    ds_read_b128 a[4:7], v12 offset:2048
    v_mfma_f32_16x16x32_bf16 v[88:91], a[76:79], a[28:31], v[88:91]
    buffer_load_dwordx4 v4, s[4:7], s47 offen offset:0 lds
    buffer_store_dwordx4 v[24:27], v2, s[20:23], s54 offen sc1
    v_mfma_f32_16x16x32_bf16 v[92:95], a[76:79], a[32:35], v[92:95]
    ds_read_b128 a[8:11], v12 offset:4096
    v_mfma_f32_16x16x32_bf16 v[96:99], a[80:83], a[20:23], v[96:99]
    ds_read_b128 a[12:15], v12 offset:6144
    v_cvt_pk_bf16_f32 v24, v184, v185
    v_mfma_f32_16x16x32_bf16 v[100:103], a[80:83], a[24:27], v[100:103]
    buffer_load_dwordx4 v5, s[4:7], s47 offen offset:1024 lds
    v_cvt_pk_bf16_f32 v25, v186, v187
    v_mfma_f32_16x16x32_bf16 v[104:107], a[80:83], a[28:31], v[104:107]
    s_add_u32 s47, s41, s35
    ds_read_b64_tr_b16 a[40:41], v16 offset:32768
    v_cvt_pk_bf16_f32 v26, v188, v189
    v_mfma_f32_16x16x32_bf16 v[108:111], a[80:83], a[32:35], v[108:111]
    s_add_u32 m0, s38, 18432
    ds_read_b64_tr_b16 a[42:43], v16 offset:33792
    v_cvt_pk_bf16_f32 v27, v190, v191
    v_mfma_f32_16x16x32_bf16 v[112:115], a[84:87], a[20:23], v[112:115]
    s_add_u32 s54, s46, 48128
    buffer_load_dwordx4 v4, s[4:7], s47 offen offset:0 lds
    v_mfma_f32_16x16x32_bf16 v[116:119], a[84:87], a[24:27], v[116:119]
    ds_read_b64_tr_b16 a[44:45], v17 offset:32768
    v_mfma_f32_16x16x32_bf16 v[120:123], a[84:87], a[28:31], v[120:123]
    ds_read_b64_tr_b16 a[46:47], v17 offset:33792
    buffer_store_dwordx4 v[24:27], v2, s[20:23], s54 offen sc1
    v_mfma_f32_16x16x32_bf16 v[124:127], a[84:87], a[32:35], v[124:127]
    buffer_load_dwordx4 v5, s[4:7], s47 offen offset:1024 lds
    v_mfma_f32_16x16x32_bf16 v[192:195], a[88:91], a[20:23], v[192:195]
    s_add_u32 s47, s34, s35
    ds_read_b64_tr_b16 a[48:49], v18 offset:32768
    v_mfma_f32_16x16x32_bf16 v[196:199], a[88:91], a[24:27], v[196:199]
    s_add_u32 m0, s38, 20480
    ds_read_b64_tr_b16 a[50:51], v18 offset:33792
    v_mfma_f32_16x16x32_bf16 v[200:203], a[88:91], a[28:31], v[200:203]
    buffer_load_dwordx4 v4, s[4:7], s47 offen offset:0 lds
    v_mfma_f32_16x16x32_bf16 v[204:207], a[88:91], a[32:35], v[204:207]
    ds_read_b64_tr_b16 a[52:53], v19 offset:32768
    v_mfma_f32_16x16x32_bf16 v[208:211], a[92:95], a[20:23], v[208:211]
    ds_read_b64_tr_b16 a[54:55], v19 offset:33792
    v_mfma_f32_16x16x32_bf16 v[212:215], a[92:95], a[24:27], v[212:215]
    buffer_load_dwordx4 v5, s[4:7], s47 offen offset:1024 lds
    v_mfma_f32_16x16x32_bf16 v[216:219], a[92:95], a[28:31], v[216:219]
    ds_read_b64_tr_b16 a[56:57], v20 offset:32768
    v_mfma_f32_16x16x32_bf16 v[220:223], a[92:95], a[32:35], v[220:223]
    ds_read_b64_tr_b16 a[58:59], v20 offset:33792
    v_mfma_f32_16x16x32_bf16 v[224:227], a[96:99], a[20:23], v[224:227]
    buffer_load_dwordx4 v6, s[4:7], s47 offen offset:2048 lds
    v_mfma_f32_16x16x32_bf16 v[228:231], a[96:99], a[24:27], v[228:231]
    ds_read_b64_tr_b16 a[60:61], v21 offset:32768
    v_mfma_f32_16x16x32_bf16 v[232:235], a[96:99], a[28:31], v[232:235]
    ds_read_b64_tr_b16 a[62:63], v21 offset:33792
    v_mfma_f32_16x16x32_bf16 v[236:239], a[96:99], a[32:35], v[236:239]
    buffer_load_dwordx4 v7, s[4:7], s47 offen offset:3072 lds
    v_mfma_f32_16x16x32_bf16 v[240:243], a[100:103], a[20:23], v[240:243]
    ds_read_b64_tr_b16 a[64:65], v22 offset:32768
    v_mfma_f32_16x16x32_bf16 v[244:247], a[100:103], a[24:27], v[244:247]
    ds_read_b64_tr_b16 a[66:67], v22 offset:33792
    v_mfma_f32_16x16x32_bf16 v[248:251], a[100:103], a[28:31], v[248:251]
    ds_read_b64_tr_b16 a[68:69], v23 offset:32768
    v_mfma_f32_16x16x32_bf16 v[252:255], a[100:103], a[32:35], v[252:255]
    ds_read_b64_tr_b16 a[70:71], v23 offset:33792
    s_waitcnt lgkmcnt(12)
    v_mfma_f32_16x16x32_bf16 v[64:67], a[40:43], a[0:3], v[64:67]
    ds_read_b128 a[20:23], v13 offset:0
    v_mfma_f32_16x16x32_bf16 v[68:71], a[40:43], a[4:7], v[68:71]
    s_bfe_u32 s45, s32, 196628
    ds_read_b128 a[24:27], v13 offset:2048
    v_mfma_f32_16x16x32_bf16 v[72:75], a[40:43], a[8:11], v[72:75]
    s_lshl_b32 s45, s45, 7
    ds_read_b128 a[28:31], v13 offset:4096
    v_mfma_f32_16x16x32_bf16 v[76:79], a[40:43], a[12:15], v[76:79]
    s_lshl_b32 s36, s45, 12
    ds_read_b128 a[32:35], v13 offset:6144
    v_mfma_f32_16x16x32_bf16 v[80:83], a[44:47], a[0:3], v[80:83]
    s_add_u32 s36, s36, s37
    ds_read_b64_tr_b16 a[72:73], v16 offset:40960
    v_mfma_f32_16x16x32_bf16 v[84:87], a[44:47], a[4:7], v[84:87]
    s_add_u32 m0, s39, 16384
    ds_read_b64_tr_b16 a[74:75], v16 offset:41984
    v_mfma_f32_16x16x32_bf16 v[88:91], a[44:47], a[8:11], v[88:91]
    buffer_load_dwordx4 v8, s[12:15], s36 offen lds
    v_mfma_f32_16x16x32_bf16 v[92:95], a[44:47], a[12:15], v[92:95]
    s_waitcnt lgkmcnt(6)
    ds_read_b64_tr_b16 a[76:77], v17 offset:40960
    v_mfma_f32_16x16x32_bf16 v[96:99], a[48:51], a[0:3], v[96:99]
    ds_read_b64_tr_b16 a[78:79], v17 offset:41984
    v_mfma_f32_16x16x32_bf16 v[100:103], a[48:51], a[4:7], v[100:103]
    ds_read_b64_tr_b16 a[80:81], v18 offset:40960
    v_mfma_f32_16x16x32_bf16 v[104:107], a[48:51], a[8:11], v[104:107]
    buffer_load_dwordx4 v9, s[12:15], s36 offen offset:1024 lds
    v_mfma_f32_16x16x32_bf16 v[108:111], a[48:51], a[12:15], v[108:111]
    ds_read_b64_tr_b16 a[82:83], v18 offset:41984
    v_mfma_f32_16x16x32_bf16 v[112:115], a[52:55], a[0:3], v[112:115]
    s_add_u32 s36, s36, 262144
    ds_read_b64_tr_b16 a[84:85], v19 offset:40960
    v_mfma_f32_16x16x32_bf16 v[116:119], a[52:55], a[4:7], v[116:119]
    s_add_u32 m0, s39, 24576
    ds_read_b64_tr_b16 a[86:87], v19 offset:41984
    v_mfma_f32_16x16x32_bf16 v[120:123], a[52:55], a[8:11], v[120:123]
    buffer_load_dwordx4 v8, s[12:15], s36 offen lds
    v_mfma_f32_16x16x32_bf16 v[124:127], a[52:55], a[12:15], v[124:127]
    ds_read_b64_tr_b16 a[88:89], v20 offset:40960
    v_mfma_f32_16x16x32_bf16 v[192:195], a[56:59], a[0:3], v[192:195]
    ds_read_b64_tr_b16 a[90:91], v20 offset:41984
    v_mfma_f32_16x16x32_bf16 v[196:199], a[56:59], a[4:7], v[196:199]
    ds_read_b64_tr_b16 a[92:93], v21 offset:40960
    v_mfma_f32_16x16x32_bf16 v[200:203], a[56:59], a[8:11], v[200:203]
    buffer_load_dwordx4 v9, s[12:15], s36 offen offset:1024 lds
    v_mfma_f32_16x16x32_bf16 v[204:207], a[56:59], a[12:15], v[204:207]
    ds_read_b64_tr_b16 a[94:95], v21 offset:41984
    v_mfma_f32_16x16x32_bf16 v[208:211], a[60:63], a[0:3], v[208:211]
    ds_read_b64_tr_b16 a[96:97], v22 offset:40960
    v_mfma_f32_16x16x32_bf16 v[212:215], a[60:63], a[4:7], v[212:215]
    ds_read_b64_tr_b16 a[98:99], v22 offset:41984
    v_mfma_f32_16x16x32_bf16 v[216:219], a[60:63], a[8:11], v[216:219]
    ds_read_b64_tr_b16 a[100:101], v23 offset:40960
    v_mfma_f32_16x16x32_bf16 v[220:223], a[60:63], a[12:15], v[220:223]
    ds_read_b64_tr_b16 a[102:103], v23 offset:41984
    v_mfma_f32_16x16x32_bf16 v[224:227], a[64:67], a[0:3], v[224:227]
    v_mfma_f32_16x16x32_bf16 v[228:231], a[64:67], a[4:7], v[228:231]
    v_mfma_f32_16x16x32_bf16 v[232:235], a[64:67], a[8:11], v[232:235]
    v_mfma_f32_16x16x32_bf16 v[236:239], a[64:67], a[12:15], v[236:239]
    v_mfma_f32_16x16x32_bf16 v[240:243], a[68:71], a[0:3], v[240:243]
    v_mfma_f32_16x16x32_bf16 v[244:247], a[68:71], a[4:7], v[244:247]
    v_mfma_f32_16x16x32_bf16 v[248:251], a[68:71], a[8:11], v[248:251]
    v_mfma_f32_16x16x32_bf16 v[252:255], a[68:71], a[12:15], v[252:255]
    s_waitcnt lgkmcnt(12)
    v_mfma_f32_16x16x32_bf16 v[64:67], a[72:75], a[20:23], v[64:67]
    v_mfma_f32_16x16x32_bf16 v[68:71], a[72:75], a[24:27], v[68:71]
    v_mfma_f32_16x16x32_bf16 v[72:75], a[72:75], a[28:31], v[72:75]
    s_bfe_u32 s35, s32, 196628
    v_mfma_f32_16x16x32_bf16 v[76:79], a[72:75], a[32:35], v[76:79]
    s_waitcnt vmcnt(9) lgkmcnt(0)
    s_barrier
    s_lshl_b32 s35, s35, 7
    v_mfma_f32_16x16x32_bf16 v[80:83], a[76:79], a[20:23], v[80:83]
    s_add_u32 s47, s33, s35
    ds_read_b128 a[0:3], v12 offset:8192
    s_cmp_lg_u32 s28, 0
    s_cbranch_scc1 SG3
    v_mov_b32 v32, s31
    s_and_b32 s100, s29, 3
    v_lshl_add_u32 v33, v1, 2, s100
    v_lshl_add_u32 v34, v33, 3, v32
    v_lshlrev_b32 v34, 9, v34
    s_mov_b32 s100, s30
    s_lshl_b32 s100, s100, 2
    s_add_u32 s100, s100, 57671712
    v_mov_b32 v32, s3
    s_mov_b64 exec, 0xff
    buffer_store_dword v32, v34, s[20:23], s100 offen sc1
    s_mov_b64 exec, -1
SG3:
    s_cmp_lg_u32 s28, 0
    s_cbranch_scc1 SG4
    s_and_b32 s100, s31, 6
    v_and_b32 v32, 1, v1
    v_add_u32 v32, s100, v32
    v_lshrrev_b32 v33, 1, v1
    s_lshr_b32 s100, s30, 1
    v_lshl_add_u32 v33, v33, 2, s100
    v_lshl_add_u32 v34, v33, 3, v32
    v_lshlrev_b32 v34, 9, v34
    s_and_b32 s100, s29, 7
    s_lshl_b32 s100, s100, 1
    s_and_b32 s101, s30, 1
    s_add_u32 s100, s100, s101
    s_lshl_b32 s100, s100, 2
    s_add_u32 s100, s100, 57671808
    v_mov_b32 v32, s3
    s_mov_b64 exec, 0xffff
    buffer_store_dword v32, v34, s[20:23], s100 offen sc1
    s_mov_b64 exec, -1
SG4:
    s_cmp_lg_u32 s28, 0
    s_cbranch_scc1 SG5
    s_and_b32 s100, s29, 7
    s_cmp_lg_u32 s100, 0
    s_cbranch_scc1 SG5
    v_lshrrev_b32 v32, 2, v1
    v_and_b32 v33, 3, v1
    s_lshl_b32 s100, s30, 2
    v_add_u32 v33, s100, v33
    v_lshl_add_u32 v34, v33, 3, v32
    v_lshlrev_b32 v34, 9, v34
    s_lshr_b32 s100, s29, 3
    s_lshl_b32 s100, s100, 2
    s_add_u32 s100, s100, 57671792
    v_mov_b32 v32, s3
    s_mov_b64 exec, 0xffffffff
    buffer_store_dword v32, v34, s[20:23], s100 offen sc1
    s_mov_b64 exec, -1
SG5:
    v_mfma_f32_16x16x32_bf16 v[84:87], a[76:79], a[24:27], v[84:87]
    s_add_u32 m0, s38, 0
    ds_read_b128 a[4:7], v12 offset:10240
    v_mfma_f32_16x16x32_bf16 v[88:91], a[76:79], a[28:31], v[88:91]
    buffer_load_dwordx4 v4, s[4:7], s47 offen offset:0 lds
    v_mfma_f32_16x16x32_bf16 v[92:95], a[76:79], a[32:35], v[92:95]
    ds_read_b128 a[8:11], v12 offset:12288
    v_mfma_f32_16x16x32_bf16 v[96:99], a[80:83], a[20:23], v[96:99]
    ds_read_b128 a[12:15], v12 offset:14336
    v_mfma_f32_16x16x32_bf16 v[100:103], a[80:83], a[24:27], v[100:103]
    buffer_load_dwordx4 v5, s[4:7], s47 offen offset:1024 lds
    v_mfma_f32_16x16x32_bf16 v[104:107], a[80:83], a[28:31], v[104:107]
    s_add_u32 s47, s41, s35
    ds_read_b64_tr_b16 a[40:41], v16 offset:49152
    v_mfma_f32_16x16x32_bf16 v[108:111], a[80:83], a[32:35], v[108:111]
    s_add_u32 m0, s38, 2048
    ds_read_b64_tr_b16 a[42:43], v16 offset:50176
    v_mfma_f32_16x16x32_bf16 v[112:115], a[84:87], a[20:23], v[112:115]
    buffer_load_dwordx4 v4, s[4:7], s47 offen offset:0 lds
    v_mfma_f32_16x16x32_bf16 v[116:119], a[84:87], a[24:27], v[116:119]
    ds_read_b64_tr_b16 a[44:45], v17 offset:49152
    v_mfma_f32_16x16x32_bf16 v[120:123], a[84:87], a[28:31], v[120:123]
    ds_read_b64_tr_b16 a[46:47], v17 offset:50176
    v_mfma_f32_16x16x32_bf16 v[124:127], a[84:87], a[32:35], v[124:127]
    buffer_load_dwordx4 v5, s[4:7], s47 offen offset:1024 lds
    v_mfma_f32_16x16x32_bf16 v[192:195], a[88:91], a[20:23], v[192:195]
    s_add_u32 s47, s34, s35
    ds_read_b64_tr_b16 a[48:49], v18 offset:49152
    v_mfma_f32_16x16x32_bf16 v[196:199], a[88:91], a[24:27], v[196:199]
    s_add_u32 m0, s38, 4096
    ds_read_b64_tr_b16 a[50:51], v18 offset:50176
    v_mfma_f32_16x16x32_bf16 v[200:203], a[88:91], a[28:31], v[200:203]
    buffer_load_dwordx4 v4, s[4:7], s47 offen offset:0 lds
    v_mfma_f32_16x16x32_bf16 v[204:207], a[88:91], a[32:35], v[204:207]
    ds_read_b64_tr_b16 a[52:53], v19 offset:49152
    v_mfma_f32_16x16x32_bf16 v[208:211], a[92:95], a[20:23], v[208:211]
    ds_read_b64_tr_b16 a[54:55], v19 offset:50176
    v_mfma_f32_16x16x32_bf16 v[212:215], a[92:95], a[24:27], v[212:215]
    buffer_load_dwordx4 v5, s[4:7], s47 offen offset:1024 lds
    v_mfma_f32_16x16x32_bf16 v[216:219], a[92:95], a[28:31], v[216:219]
    ds_read_b64_tr_b16 a[56:57], v20 offset:49152
    v_mfma_f32_16x16x32_bf16 v[220:223], a[92:95], a[32:35], v[220:223]
    ds_read_b64_tr_b16 a[58:59], v20 offset:50176
    v_mfma_f32_16x16x32_bf16 v[224:227], a[96:99], a[20:23], v[224:227]
    buffer_load_dwordx4 v6, s[4:7], s47 offen offset:2048 lds
    v_mfma_f32_16x16x32_bf16 v[228:231], a[96:99], a[24:27], v[228:231]
    ds_read_b64_tr_b16 a[60:61], v21 offset:49152
    v_mfma_f32_16x16x32_bf16 v[232:235], a[96:99], a[28:31], v[232:235]
    ds_read_b64_tr_b16 a[62:63], v21 offset:50176
    v_mfma_f32_16x16x32_bf16 v[236:239], a[96:99], a[32:35], v[236:239]
    buffer_load_dwordx4 v7, s[4:7], s47 offen offset:3072 lds
    v_mfma_f32_16x16x32_bf16 v[240:243], a[100:103], a[20:23], v[240:243]
    ds_read_b64_tr_b16 a[64:65], v22 offset:49152
    v_mfma_f32_16x16x32_bf16 v[244:247], a[100:103], a[24:27], v[244:247]
    ds_read_b64_tr_b16 a[66:67], v22 offset:50176
    v_mfma_f32_16x16x32_bf16 v[248:251], a[100:103], a[28:31], v[248:251]
    ds_read_b64_tr_b16 a[68:69], v23 offset:49152
    v_mfma_f32_16x16x32_bf16 v[252:255], a[100:103], a[32:35], v[252:255]
    ds_read_b64_tr_b16 a[70:71], v23 offset:50176
    s_waitcnt lgkmcnt(12)
    v_mfma_f32_16x16x32_bf16 v[64:67], a[40:43], a[0:3], v[64:67]
    ds_read_b128 a[20:23], v13 offset:8192
    v_mfma_f32_16x16x32_bf16 v[68:71], a[40:43], a[4:7], v[68:71]
    s_bfe_u32 s45, s32, 196632
    ds_read_b128 a[24:27], v13 offset:10240
    v_mfma_f32_16x16x32_bf16 v[72:75], a[40:43], a[8:11], v[72:75]
    s_lshl_b32 s45, s45, 7
    ds_read_b128 a[28:31], v13 offset:12288
    v_mfma_f32_16x16x32_bf16 v[76:79], a[40:43], a[12:15], v[76:79]
    s_lshl_b32 s36, s45, 12
    ds_read_b128 a[32:35], v13 offset:14336
    v_mfma_f32_16x16x32_bf16 v[80:83], a[44:47], a[0:3], v[80:83]
    s_add_u32 s36, s36, s37
    ds_read_b64_tr_b16 a[72:73], v16 offset:57344
    v_mfma_f32_16x16x32_bf16 v[84:87], a[44:47], a[4:7], v[84:87]
    s_add_u32 m0, s39, 32768
    ds_read_b64_tr_b16 a[74:75], v16 offset:58368
    v_mfma_f32_16x16x32_bf16 v[88:91], a[44:47], a[8:11], v[88:91]
    buffer_load_dwordx4 v8, s[12:15], s36 offen lds
    v_mfma_f32_16x16x32_bf16 v[92:95], a[44:47], a[12:15], v[92:95]
    s_waitcnt lgkmcnt(6)
    ds_read_b64_tr_b16 a[76:77], v17 offset:57344
    v_mfma_f32_16x16x32_bf16 v[96:99], a[48:51], a[0:3], v[96:99]
    ds_read_b64_tr_b16 a[78:79], v17 offset:58368
    v_mfma_f32_16x16x32_bf16 v[100:103], a[48:51], a[4:7], v[100:103]
    ds_read_b64_tr_b16 a[80:81], v18 offset:57344
    v_mfma_f32_16x16x32_bf16 v[104:107], a[48:51], a[8:11], v[104:107]
    buffer_load_dwordx4 v9, s[12:15], s36 offen offset:1024 lds
    v_mfma_f32_16x16x32_bf16 v[108:111], a[48:51], a[12:15], v[108:111]
    ds_read_b64_tr_b16 a[82:83], v18 offset:58368
    v_mfma_f32_16x16x32_bf16 v[112:115], a[52:55], a[0:3], v[112:115]
    s_add_u32 s36, s36, 262144
    ds_read_b64_tr_b16 a[84:85], v19 offset:57344
    v_mfma_f32_16x16x32_bf16 v[116:119], a[52:55], a[4:7], v[116:119]
    s_add_u32 m0, s39, 40960
    ds_read_b64_tr_b16 a[86:87], v19 offset:58368
    v_mfma_f32_16x16x32_bf16 v[120:123], a[52:55], a[8:11], v[120:123]
    buffer_load_dwordx4 v8, s[12:15], s36 offen lds
    v_mfma_f32_16x16x32_bf16 v[124:127], a[52:55], a[12:15], v[124:127]
    ds_read_b64_tr_b16 a[88:89], v20 offset:57344
    v_mfma_f32_16x16x32_bf16 v[192:195], a[56:59], a[0:3], v[192:195]
    ds_read_b64_tr_b16 a[90:91], v20 offset:58368
    v_mfma_f32_16x16x32_bf16 v[196:199], a[56:59], a[4:7], v[196:199]
    ds_read_b64_tr_b16 a[92:93], v21 offset:57344
    v_mfma_f32_16x16x32_bf16 v[200:203], a[56:59], a[8:11], v[200:203]
    buffer_load_dwordx4 v9, s[12:15], s36 offen offset:1024 lds
    v_mfma_f32_16x16x32_bf16 v[204:207], a[56:59], a[12:15], v[204:207]
    ds_read_b64_tr_b16 a[94:95], v21 offset:58368
    v_mfma_f32_16x16x32_bf16 v[208:211], a[60:63], a[0:3], v[208:211]
    ds_read_b64_tr_b16 a[96:97], v22 offset:57344
    v_mfma_f32_16x16x32_bf16 v[212:215], a[60:63], a[4:7], v[212:215]
    ds_read_b64_tr_b16 a[98:99], v22 offset:58368
    v_mfma_f32_16x16x32_bf16 v[216:219], a[60:63], a[8:11], v[216:219]
    ds_read_b64_tr_b16 a[100:101], v23 offset:57344
    v_mfma_f32_16x16x32_bf16 v[220:223], a[60:63], a[12:15], v[220:223]
    ds_read_b64_tr_b16 a[102:103], v23 offset:58368
    v_mfma_f32_16x16x32_bf16 v[224:227], a[64:67], a[0:3], v[224:227]
    v_mfma_f32_16x16x32_bf16 v[228:231], a[64:67], a[4:7], v[228:231]
    v_mfma_f32_16x16x32_bf16 v[232:235], a[64:67], a[8:11], v[232:235]
    v_mfma_f32_16x16x32_bf16 v[236:239], a[64:67], a[12:15], v[236:239]
    v_mfma_f32_16x16x32_bf16 v[240:243], a[68:71], a[0:3], v[240:243]
    v_mfma_f32_16x16x32_bf16 v[244:247], a[68:71], a[4:7], v[244:247]
    v_mfma_f32_16x16x32_bf16 v[248:251], a[68:71], a[8:11], v[248:251]
    v_mfma_f32_16x16x32_bf16 v[252:255], a[68:71], a[12:15], v[252:255]
    s_waitcnt lgkmcnt(12)
    v_mfma_f32_16x16x32_bf16 v[64:67], a[72:75], a[20:23], v[64:67]
    v_mfma_f32_16x16x32_bf16 v[68:71], a[72:75], a[24:27], v[68:71]
    v_mfma_f32_16x16x32_bf16 v[72:75], a[72:75], a[28:31], v[72:75]
    s_bfe_u32 s35, s32, 196632
    v_mfma_f32_16x16x32_bf16 v[76:79], a[72:75], a[32:35], v[76:79]
    s_waitcnt vmcnt(16) lgkmcnt(0)
    s_barrier
    s_lshl_b32 s35, s35, 7
    v_mfma_f32_16x16x32_bf16 v[80:83], a[76:79], a[20:23], v[80:83]
    s_add_u32 s47, s33, s35
    ds_read_b128 a[0:3], v12 offset:16384
    v_mfma_f32_16x16x32_bf16 v[84:87], a[76:79], a[24:27], v[84:87]
    s_add_u32 m0, s38, 8192
    ds_read_b128 a[4:7], v12 offset:18432
    v_mfma_f32_16x16x32_bf16 v[88:91], a[76:79], a[28:31], v[88:91]
    buffer_load_dwordx4 v4, s[4:7], s47 offen offset:0 lds
    v_mfma_f32_16x16x32_bf16 v[92:95], a[76:79], a[32:35], v[92:95]
    ds_read_b128 a[8:11], v12 offset:20480
    v_mfma_f32_16x16x32_bf16 v[96:99], a[80:83], a[20:23], v[96:99]
    ds_read_b128 a[12:15], v12 offset:22528
    v_mfma_f32_16x16x32_bf16 v[100:103], a[80:83], a[24:27], v[100:103]
    buffer_load_dwordx4 v5, s[4:7], s47 offen offset:1024 lds
    v_mfma_f32_16x16x32_bf16 v[104:107], a[80:83], a[28:31], v[104:107]
    s_add_u32 s47, s41, s35
    ds_read_b64_tr_b16 a[40:41], v16 offset:0
    v_mfma_f32_16x16x32_bf16 v[108:111], a[80:83], a[32:35], v[108:111]
    s_add_u32 m0, s38, 10240
    ds_read_b64_tr_b16 a[42:43], v16 offset:1024
    v_mfma_f32_16x16x32_bf16 v[112:115], a[84:87], a[20:23], v[112:115]
    buffer_load_dwordx4 v4, s[4:7], s47 offen offset:0 lds
    v_mfma_f32_16x16x32_bf16 v[116:119], a[84:87], a[24:27], v[116:119]
    ds_read_b64_tr_b16 a[44:45], v17 offset:0
    v_mfma_f32_16x16x32_bf16 v[120:123], a[84:87], a[28:31], v[120:123]
    ds_read_b64_tr_b16 a[46:47], v17 offset:1024
    v_mfma_f32_16x16x32_bf16 v[124:127], a[84:87], a[32:35], v[124:127]
    buffer_load_dwordx4 v5, s[4:7], s47 offen offset:1024 lds
    v_mfma_f32_16x16x32_bf16 v[192:195], a[88:91], a[20:23], v[192:195]
    s_add_u32 s47, s34, s35
    ds_read_b64_tr_b16 a[48:49], v18 offset:0
    v_mfma_f32_16x16x32_bf16 v[196:199], a[88:91], a[24:27], v[196:199]
    s_add_u32 m0, s38, 12288
    ds_read_b64_tr_b16 a[50:51], v18 offset:1024
    v_mfma_f32_16x16x32_bf16 v[200:203], a[88:91], a[28:31], v[200:203]
    buffer_load_dwordx4 v4, s[4:7], s47 offen offset:0 lds
    v_mfma_f32_16x16x32_bf16 v[204:207], a[88:91], a[32:35], v[204:207]
    ds_read_b64_tr_b16 a[52:53], v19 offset:0
    v_mfma_f32_16x16x32_bf16 v[208:211], a[92:95], a[20:23], v[208:211]
    ds_read_b64_tr_b16 a[54:55], v19 offset:1024
    v_mfma_f32_16x16x32_bf16 v[212:215], a[92:95], a[24:27], v[212:215]
    buffer_load_dwordx4 v5, s[4:7], s47 offen offset:1024 lds
    v_mfma_f32_16x16x32_bf16 v[216:219], a[92:95], a[28:31], v[216:219]
    ds_read_b64_tr_b16 a[56:57], v20 offset:0
    v_mfma_f32_16x16x32_bf16 v[220:223], a[92:95], a[32:35], v[220:223]
    ds_read_b64_tr_b16 a[58:59], v20 offset:1024
    v_mfma_f32_16x16x32_bf16 v[224:227], a[96:99], a[20:23], v[224:227]
    buffer_load_dwordx4 v6, s[4:7], s47 offen offset:2048 lds
    v_mfma_f32_16x16x32_bf16 v[228:231], a[96:99], a[24:27], v[228:231]
    ds_read_b64_tr_b16 a[60:61], v21 offset:0
    v_mfma_f32_16x16x32_bf16 v[232:235], a[96:99], a[28:31], v[232:235]
    ds_read_b64_tr_b16 a[62:63], v21 offset:1024
    v_mfma_f32_16x16x32_bf16 v[236:239], a[96:99], a[32:35], v[236:239]
    buffer_load_dwordx4 v7, s[4:7], s47 offen offset:3072 lds
    v_mfma_f32_16x16x32_bf16 v[240:243], a[100:103], a[20:23], v[240:243]
    ds_read_b64_tr_b16 a[64:65], v22 offset:0
    s_lshl_b32 s100, s2, 9
    s_add_u32 s100, s100, 57671712
    v_and_b32 v15, 7, v1
    v_lshl_add_u32 v15, v15, 2, s100
    buffer_load_dword v14, v15, s[20:23], 0 offen sc1
    v_mfma_f32_16x16x32_bf16 v[244:247], a[100:103], a[24:27], v[244:247]
    ds_read_b64_tr_b16 a[66:67], v22 offset:1024
    v_mfma_f32_16x16x32_bf16 v[248:251], a[100:103], a[28:31], v[248:251]
    ds_read_b64_tr_b16 a[68:69], v23 offset:0
    v_mfma_f32_16x16x32_bf16 v[252:255], a[100:103], a[32:35], v[252:255]
    ds_read_b64_tr_b16 a[70:71], v23 offset:1024
    s_waitcnt lgkmcnt(12)
    v_mfma_f32_16x16x32_bf16 v[64:67], a[40:43], a[0:3], v[64:67]
    ds_read_b128 a[20:23], v13 offset:16384
    v_mfma_f32_16x16x32_bf16 v[68:71], a[40:43], a[4:7], v[68:71]
    s_bfe_u32 s45, s32, 196636
    ds_read_b128 a[24:27], v13 offset:18432
    v_mfma_f32_16x16x32_bf16 v[72:75], a[40:43], a[8:11], v[72:75]
    s_lshl_b32 s45, s45, 7
    ds_read_b128 a[28:31], v13 offset:20480
    v_mov_b32 v128, 0
    v_mfma_f32_16x16x32_bf16 v[76:79], a[40:43], a[12:15], v[76:79]
    s_lshl_b32 s36, s45, 12
    ds_read_b128 a[32:35], v13 offset:22528
    v_mov_b32 v129, 0
    v_mfma_f32_16x16x32_bf16 v[80:83], a[44:47], a[0:3], v[80:83]
    s_add_u32 s36, s36, s37
    ds_read_b64_tr_b16 a[72:73], v16 offset:8192
    v_mov_b32 v130, 0
    v_mfma_f32_16x16x32_bf16 v[84:87], a[44:47], a[4:7], v[84:87]
    s_add_u32 m0, s39, 49152
    ds_read_b64_tr_b16 a[74:75], v16 offset:9216
    v_mov_b32 v131, 0
    v_mfma_f32_16x16x32_bf16 v[88:91], a[44:47], a[8:11], v[88:91]
    buffer_load_dwordx4 v8, s[12:15], s36 offen lds
    v_mov_b32 v132, 0
    v_mfma_f32_16x16x32_bf16 v[92:95], a[44:47], a[12:15], v[92:95]
    s_waitcnt lgkmcnt(6)
    ds_read_b64_tr_b16 a[76:77], v17 offset:8192
    v_mov_b32 v133, 0
    v_mfma_f32_16x16x32_bf16 v[96:99], a[48:51], a[0:3], v[96:99]
    ds_read_b64_tr_b16 a[78:79], v17 offset:9216
    v_mov_b32 v134, 0
    v_mfma_f32_16x16x32_bf16 v[100:103], a[48:51], a[4:7], v[100:103]
    ds_read_b64_tr_b16 a[80:81], v18 offset:8192
    v_mov_b32 v135, 0
    v_mfma_f32_16x16x32_bf16 v[104:107], a[48:51], a[8:11], v[104:107]
    buffer_load_dwordx4 v9, s[12:15], s36 offen offset:1024 lds
    v_mfma_f32_16x16x32_bf16 v[108:111], a[48:51], a[12:15], v[108:111]
    ds_read_b64_tr_b16 a[82:83], v18 offset:9216
    v_mfma_f32_16x16x32_bf16 v[112:115], a[52:55], a[0:3], v[112:115]
    s_add_u32 s36, s36, 262144
    ds_read_b64_tr_b16 a[84:85], v19 offset:8192
    v_mfma_f32_16x16x32_bf16 v[116:119], a[52:55], a[4:7], v[116:119]
    s_add_u32 m0, s39, 57344
    ds_read_b64_tr_b16 a[86:87], v19 offset:9216
    v_mfma_f32_16x16x32_bf16 v[120:123], a[52:55], a[8:11], v[120:123]
    buffer_load_dwordx4 v8, s[12:15], s36 offen lds
    v_mfma_f32_16x16x32_bf16 v[124:127], a[52:55], a[12:15], v[124:127]
    ds_read_b64_tr_b16 a[88:89], v20 offset:8192
    v_mfma_f32_16x16x32_bf16 v[192:195], a[56:59], a[0:3], v[192:195]
    ds_read_b64_tr_b16 a[90:91], v20 offset:9216
    v_mfma_f32_16x16x32_bf16 v[196:199], a[56:59], a[4:7], v[196:199]
    ds_read_b64_tr_b16 a[92:93], v21 offset:8192
    v_mfma_f32_16x16x32_bf16 v[200:203], a[56:59], a[8:11], v[200:203]
    buffer_load_dwordx4 v9, s[12:15], s36 offen offset:1024 lds
    v_mfma_f32_16x16x32_bf16 v[204:207], a[56:59], a[12:15], v[204:207]
    ds_read_b64_tr_b16 a[94:95], v21 offset:9216
    v_mfma_f32_16x16x32_bf16 v[208:211], a[60:63], a[0:3], v[208:211]
    ds_read_b64_tr_b16 a[96:97], v22 offset:8192
    v_mfma_f32_16x16x32_bf16 v[212:215], a[60:63], a[4:7], v[212:215]
    ds_read_b64_tr_b16 a[98:99], v22 offset:9216
    v_mfma_f32_16x16x32_bf16 v[216:219], a[60:63], a[8:11], v[216:219]
    ds_read_b64_tr_b16 a[100:101], v23 offset:8192
    v_mfma_f32_16x16x32_bf16 v[220:223], a[60:63], a[12:15], v[220:223]
    ds_read_b64_tr_b16 a[102:103], v23 offset:9216
    v_mfma_f32_16x16x32_bf16 v[224:227], a[64:67], a[0:3], v[224:227]
    v_mfma_f32_16x16x32_bf16 v[228:231], a[64:67], a[4:7], v[228:231]
    v_mfma_f32_16x16x32_bf16 v[232:235], a[64:67], a[8:11], v[232:235]
    v_mfma_f32_16x16x32_bf16 v[236:239], a[64:67], a[12:15], v[236:239]
    v_mfma_f32_16x16x32_bf16 v[240:243], a[68:71], a[0:3], v[240:243]
    v_mfma_f32_16x16x32_bf16 v[244:247], a[68:71], a[4:7], v[244:247]
    v_mfma_f32_16x16x32_bf16 v[248:251], a[68:71], a[8:11], v[248:251]
    v_mfma_f32_16x16x32_bf16 v[252:255], a[68:71], a[12:15], v[252:255]
    s_waitcnt lgkmcnt(12)
    v_mfma_f32_16x16x32_bf16 v[64:67], a[72:75], a[20:23], v[64:67]
    v_mfma_f32_16x16x32_bf16 v[68:71], a[72:75], a[24:27], v[68:71]
    v_mfma_f32_16x16x32_bf16 v[72:75], a[72:75], a[28:31], v[72:75]
    s_bfe_u32 s35, s32, 196636
    v_mov_b32 v136, 0
    v_mov_b32 v137, 0
    v_mfma_f32_16x16x32_bf16 v[76:79], a[72:75], a[32:35], v[76:79]
    s_waitcnt vmcnt(4) lgkmcnt(0)
    s_barrier
    s_lshl_b32 s35, s35, 7
    v_mov_b32 v138, 0
    v_mov_b32 v139, 0
    v_mfma_f32_16x16x32_bf16 v[80:83], a[76:79], a[20:23], v[80:83]
    s_add_u32 s47, s33, s35
    ds_read_b128 a[0:3], v12 offset:0
    v_mov_b32 v140, 0
    s_mov_b32 s100, 0x20000
PL6:
    v_cmp_ne_u32 vcc, s3, v14
    s_cbranch_vccz PL6x
    s_sub_u32 s100, s100, 1
    s_cbranch_scc1 PL6x
    s_sleep 4
    buffer_load_dword v14, v15, s[20:23], 0 offen sc1
    s_waitcnt vmcnt(0)
    s_branch PL6
PL6x:
    v_mfma_f32_16x16x32_bf16 v[84:87], a[76:79], a[24:27], v[84:87]
    s_add_u32 m0, s38, 16384
    ds_read_b128 a[4:7], v12 offset:2048
    v_mov_b32 v141, 0
    v_mfma_f32_16x16x32_bf16 v[88:91], a[76:79], a[28:31], v[88:91]
    buffer_load_dwordx4 v4, s[4:7], s47 offen offset:0 lds
    v_mov_b32 v142, 0
    v_mfma_f32_16x16x32_bf16 v[92:95], a[76:79], a[32:35], v[92:95]
    ds_read_b128 a[8:11], v12 offset:4096
    v_mov_b32 v143, 0
    v_mfma_f32_16x16x32_bf16 v[96:99], a[80:83], a[20:23], v[96:99]
    ds_read_b128 a[12:15], v12 offset:6144
    v_mfma_f32_16x16x32_bf16 v[100:103], a[80:83], a[24:27], v[100:103]
    buffer_load_dwordx4 v5, s[4:7], s47 offen offset:1024 lds
    v_mfma_f32_16x16x32_bf16 v[104:107], a[80:83], a[28:31], v[104:107]
    s_add_u32 s47, s41, s35
    ds_read_b64_tr_b16 a[40:41], v16 offset:16384
    v_mfma_f32_16x16x32_bf16 v[108:111], a[80:83], a[32:35], v[108:111]
    s_add_u32 m0, s38, 18432
    ds_read_b64_tr_b16 a[42:43], v16 offset:17408
    v_mfma_f32_16x16x32_bf16 v[112:115], a[84:87], a[20:23], v[112:115]
    buffer_load_dwordx4 v4, s[4:7], s47 offen offset:0 lds
    v_mfma_f32_16x16x32_bf16 v[116:119], a[84:87], a[24:27], v[116:119]
    ds_read_b64_tr_b16 a[44:45], v17 offset:16384
    v_mfma_f32_16x16x32_bf16 v[120:123], a[84:87], a[28:31], v[120:123]
    ds_read_b64_tr_b16 a[46:47], v17 offset:17408
    v_mfma_f32_16x16x32_bf16 v[124:127], a[84:87], a[32:35], v[124:127]
    buffer_load_dwordx4 v5, s[4:7], s47 offen offset:1024 lds
    v_mfma_f32_16x16x32_bf16 v[192:195], a[88:91], a[20:23], v[192:195]
    s_add_u32 s47, s34, s35
    ds_read_b64_tr_b16 a[48:49], v18 offset:16384
    v_mfma_f32_16x16x32_bf16 v[196:199], a[88:91], a[24:27], v[196:199]
    s_add_u32 m0, s38, 20480
    ds_read_b64_tr_b16 a[50:51], v18 offset:17408
    v_mfma_f32_16x16x32_bf16 v[200:203], a[88:91], a[28:31], v[200:203]
    buffer_load_dwordx4 v4, s[4:7], s47 offen offset:0 lds
    v_mfma_f32_16x16x32_bf16 v[204:207], a[88:91], a[32:35], v[204:207]
    ds_read_b64_tr_b16 a[52:53], v19 offset:16384
    v_mfma_f32_16x16x32_bf16 v[208:211], a[92:95], a[20:23], v[208:211]
    ds_read_b64_tr_b16 a[54:55], v19 offset:17408
    v_mfma_f32_16x16x32_bf16 v[212:215], a[92:95], a[24:27], v[212:215]
    buffer_load_dwordx4 v5, s[4:7], s47 offen offset:1024 lds
    v_mfma_f32_16x16x32_bf16 v[216:219], a[92:95], a[28:31], v[216:219]
    ds_read_b64_tr_b16 a[56:57], v20 offset:16384
    v_mfma_f32_16x16x32_bf16 v[220:223], a[92:95], a[32:35], v[220:223]
    ds_read_b64_tr_b16 a[58:59], v20 offset:17408
    v_mfma_f32_16x16x32_bf16 v[224:227], a[96:99], a[20:23], v[224:227]
    buffer_load_dwordx4 v6, s[4:7], s47 offen offset:2048 lds
    v_mfma_f32_16x16x32_bf16 v[228:231], a[96:99], a[24:27], v[228:231]
    ds_read_b64_tr_b16 a[60:61], v21 offset:16384
    v_mfma_f32_16x16x32_bf16 v[232:235], a[96:99], a[28:31], v[232:235]
    ds_read_b64_tr_b16 a[62:63], v21 offset:17408
    v_mfma_f32_16x16x32_bf16 v[236:239], a[96:99], a[32:35], v[236:239]
    buffer_load_dwordx4 v7, s[4:7], s47 offen offset:3072 lds
    v_mfma_f32_16x16x32_bf16 v[240:243], a[100:103], a[20:23], v[240:243]
    ds_read_b64_tr_b16 a[64:65], v22 offset:16384
    v_mfma_f32_16x16x32_bf16 v[244:247], a[100:103], a[24:27], v[244:247]
    ds_read_b64_tr_b16 a[66:67], v22 offset:17408
    v_mfma_f32_16x16x32_bf16 v[248:251], a[100:103], a[28:31], v[248:251]
    ds_read_b64_tr_b16 a[68:69], v23 offset:16384
    v_mfma_f32_16x16x32_bf16 v[252:255], a[100:103], a[32:35], v[252:255]
    ds_read_b64_tr_b16 a[70:71], v23 offset:17408
    s_waitcnt lgkmcnt(12)
    v_mfma_f32_16x16x32_bf16 v[64:67], a[40:43], a[0:3], v[64:67]
    ds_read_b128 a[20:23], v13 offset:0
    v_mfma_f32_16x16x32_bf16 v[68:71], a[40:43], a[4:7], v[68:71]
    ds_read_b128 a[24:27], v13 offset:2048
    v_mfma_f32_16x16x32_bf16 v[72:75], a[40:43], a[8:11], v[72:75]
    ds_read_b128 a[28:31], v13 offset:4096
    v_mov_b32 v144, 0
    v_mfma_f32_16x16x32_bf16 v[76:79], a[40:43], a[12:15], v[76:79]
    ds_read_b128 a[32:35], v13 offset:6144
    v_mov_b32 v145, 0
    v_mfma_f32_16x16x32_bf16 v[80:83], a[44:47], a[0:3], v[80:83]
    s_add_u32 s55, s0, 0
    ds_read_b64_tr_b16 a[72:73], v16 offset:24576
    v_mov_b32 v146, 0
    v_mfma_f32_16x16x32_bf16 v[84:87], a[44:47], a[4:7], v[84:87]
    s_add_u32 m0, s0, 0
    ds_read_b64_tr_b16 a[74:75], v16 offset:25600
    v_mov_b32 v147, 0
    v_mfma_f32_16x16x32_bf16 v[88:91], a[44:47], a[8:11], v[88:91]
    buffer_load_dwordx4 v2, s[8:11], s55 offen offset:0 sc1 lds
    v_mov_b32 v148, 0
    v_mfma_f32_16x16x32_bf16 v[92:95], a[44:47], a[12:15], v[92:95]
    s_waitcnt lgkmcnt(6)
    ds_read_b64_tr_b16 a[76:77], v17 offset:24576
    v_mov_b32 v149, 0
    v_mfma_f32_16x16x32_bf16 v[96:99], a[48:51], a[0:3], v[96:99]
    ds_read_b64_tr_b16 a[78:79], v17 offset:25600
    v_mov_b32 v150, 0
    v_mfma_f32_16x16x32_bf16 v[100:103], a[48:51], a[4:7], v[100:103]
    ds_read_b64_tr_b16 a[80:81], v18 offset:24576
    v_mov_b32 v151, 0
    v_mfma_f32_16x16x32_bf16 v[104:107], a[48:51], a[8:11], v[104:107]
    buffer_load_dwordx4 v2, s[8:11], s55 offen offset:1024 sc1 lds
    v_mfma_f32_16x16x32_bf16 v[108:111], a[48:51], a[12:15], v[108:111]
    ds_read_b64_tr_b16 a[82:83], v18 offset:25600
    v_mfma_f32_16x16x32_bf16 v[112:115], a[52:55], a[0:3], v[112:115]
    ds_read_b64_tr_b16 a[84:85], v19 offset:24576
    v_mfma_f32_16x16x32_bf16 v[116:119], a[52:55], a[4:7], v[116:119]
    ds_read_b64_tr_b16 a[86:87], v19 offset:25600
    v_mfma_f32_16x16x32_bf16 v[120:123], a[52:55], a[8:11], v[120:123]
    buffer_load_dwordx4 v2, s[8:11], s55 offen offset:2048 sc1 lds
    v_mfma_f32_16x16x32_bf16 v[124:127], a[52:55], a[12:15], v[124:127]
    ds_read_b64_tr_b16 a[88:89], v20 offset:24576
    v_mfma_f32_16x16x32_bf16 v[192:195], a[56:59], a[0:3], v[192:195]
    ds_read_b64_tr_b16 a[90:91], v20 offset:25600
    v_mfma_f32_16x16x32_bf16 v[196:199], a[56:59], a[4:7], v[196:199]
    ds_read_b64_tr_b16 a[92:93], v21 offset:24576
    v_mfma_f32_16x16x32_bf16 v[200:203], a[56:59], a[8:11], v[200:203]
    buffer_load_dwordx4 v2, s[8:11], s55 offen offset:3072 sc1 lds
    v_mfma_f32_16x16x32_bf16 v[204:207], a[56:59], a[12:15], v[204:207]
    ds_read_b64_tr_b16 a[94:95], v21 offset:25600
    v_mfma_f32_16x16x32_bf16 v[208:211], a[60:63], a[0:3], v[208:211]
    ds_read_b64_tr_b16 a[96:97], v22 offset:24576
    v_mfma_f32_16x16x32_bf16 v[212:215], a[60:63], a[4:7], v[212:215]
    ds_read_b64_tr_b16 a[98:99], v22 offset:25600
    v_mfma_f32_16x16x32_bf16 v[216:219], a[60:63], a[8:11], v[216:219]
    ds_read_b64_tr_b16 a[100:101], v23 offset:24576
    v_mfma_f32_16x16x32_bf16 v[220:223], a[60:63], a[12:15], v[220:223]
    ds_read_b64_tr_b16 a[102:103], v23 offset:25600
    v_mfma_f32_16x16x32_bf16 v[224:227], a[64:67], a[0:3], v[224:227]
    v_mfma_f32_16x16x32_bf16 v[228:231], a[64:67], a[4:7], v[228:231]
    v_mfma_f32_16x16x32_bf16 v[232:235], a[64:67], a[8:11], v[232:235]
    v_mfma_f32_16x16x32_bf16 v[236:239], a[64:67], a[12:15], v[236:239]
    v_mfma_f32_16x16x32_bf16 v[240:243], a[68:71], a[0:3], v[240:243]
    v_mfma_f32_16x16x32_bf16 v[244:247], a[68:71], a[4:7], v[244:247]
    v_mfma_f32_16x16x32_bf16 v[248:251], a[68:71], a[8:11], v[248:251]
    v_mfma_f32_16x16x32_bf16 v[252:255], a[68:71], a[12:15], v[252:255]
    s_waitcnt lgkmcnt(12)
    v_mfma_f32_16x16x32_bf16 v[64:67], a[72:75], a[20:23], v[64:67]
    v_mfma_f32_16x16x32_bf16 v[68:71], a[72:75], a[24:27], v[68:71]
    v_mfma_f32_16x16x32_bf16 v[72:75], a[72:75], a[28:31], v[72:75]
    v_mov_b32 v152, 0
    v_mov_b32 v153, 0
    v_mfma_f32_16x16x32_bf16 v[76:79], a[72:75], a[32:35], v[76:79]
    s_waitcnt vmcnt(17) lgkmcnt(0)
    s_barrier
    v_mov_b32 v154, 0
    v_mov_b32 v155, 0
    v_mfma_f32_16x16x32_bf16 v[80:83], a[76:79], a[20:23], v[80:83]
    s_add_u32 s55, s0, 16384
    ds_read_b128 a[0:3], v12 offset:8192
    v_mov_b32 v156, 0
    v_mfma_f32_16x16x32_bf16 v[84:87], a[76:79], a[24:27], v[84:87]
    s_add_u32 m0, s0, 16384
    ds_read_b128 a[4:7], v12 offset:10240
    v_mov_b32 v157, 0
    v_mfma_f32_16x16x32_bf16 v[88:91], a[76:79], a[28:31], v[88:91]
    buffer_load_dwordx4 v2, s[8:11], s55 offen offset:0 sc1 lds
    v_mov_b32 v158, 0
    v_mfma_f32_16x16x32_bf16 v[92:95], a[76:79], a[32:35], v[92:95]
    ds_read_b128 a[8:11], v12 offset:12288
    v_mov_b32 v159, 0
    v_mfma_f32_16x16x32_bf16 v[96:99], a[80:83], a[20:23], v[96:99]
    ds_read_b128 a[12:15], v12 offset:14336
    v_mfma_f32_16x16x32_bf16 v[100:103], a[80:83], a[24:27], v[100:103]
    ds_read_b64_tr_b16 a[40:41], v16 offset:32768
    v_mfma_f32_16x16x32_bf16 v[104:107], a[80:83], a[28:31], v[104:107]
    buffer_load_dwordx4 v2, s[8:11], s55 offen offset:1024 sc1 lds
    v_mfma_f32_16x16x32_bf16 v[108:111], a[80:83], a[32:35], v[108:111]
    ds_read_b64_tr_b16 a[42:43], v16 offset:33792
    v_mfma_f32_16x16x32_bf16 v[112:115], a[84:87], a[20:23], v[112:115]
    ds_read_b64_tr_b16 a[44:45], v17 offset:32768
    v_mfma_f32_16x16x32_bf16 v[116:119], a[84:87], a[24:27], v[116:119]
    ds_read_b64_tr_b16 a[46:47], v17 offset:33792
    v_mfma_f32_16x16x32_bf16 v[120:123], a[84:87], a[28:31], v[120:123]
    buffer_load_dwordx4 v2, s[8:11], s55 offen offset:2048 sc1 lds
    v_mfma_f32_16x16x32_bf16 v[124:127], a[84:87], a[32:35], v[124:127]
    ds_read_b64_tr_b16 a[48:49], v18 offset:32768
    v_mfma_f32_16x16x32_bf16 v[192:195], a[88:91], a[20:23], v[192:195]
    ds_read_b64_tr_b16 a[50:51], v18 offset:33792
    v_mfma_f32_16x16x32_bf16 v[196:199], a[88:91], a[24:27], v[196:199]
    ds_read_b64_tr_b16 a[52:53], v19 offset:32768
    v_mfma_f32_16x16x32_bf16 v[200:203], a[88:91], a[28:31], v[200:203]
    buffer_load_dwordx4 v2, s[8:11], s55 offen offset:3072 sc1 lds
    v_mfma_f32_16x16x32_bf16 v[204:207], a[88:91], a[32:35], v[204:207]
    ds_read_b64_tr_b16 a[54:55], v19 offset:33792
    v_mfma_f32_16x16x32_bf16 v[208:211], a[92:95], a[20:23], v[208:211]
    ds_read_b64_tr_b16 a[56:57], v20 offset:32768
    v_mfma_f32_16x16x32_bf16 v[212:215], a[92:95], a[24:27], v[212:215]
    ds_read_b64_tr_b16 a[58:59], v20 offset:33792
    v_mfma_f32_16x16x32_bf16 v[216:219], a[92:95], a[28:31], v[216:219]
    ds_read_b64_tr_b16 a[60:61], v21 offset:32768
    v_mfma_f32_16x16x32_bf16 v[220:223], a[92:95], a[32:35], v[220:223]
    ds_read_b64_tr_b16 a[62:63], v21 offset:33792
    v_mfma_f32_16x16x32_bf16 v[224:227], a[96:99], a[20:23], v[224:227]
    ds_read_b64_tr_b16 a[64:65], v22 offset:32768
    v_mfma_f32_16x16x32_bf16 v[228:231], a[96:99], a[24:27], v[228:231]
    ds_read_b64_tr_b16 a[66:67], v22 offset:33792
    v_mfma_f32_16x16x32_bf16 v[232:235], a[96:99], a[28:31], v[232:235]
    ds_read_b64_tr_b16 a[68:69], v23 offset:32768
    v_mfma_f32_16x16x32_bf16 v[236:239], a[96:99], a[32:35], v[236:239]
    ds_read_b64_tr_b16 a[70:71], v23 offset:33792
    v_mfma_f32_16x16x32_bf16 v[240:243], a[100:103], a[20:23], v[240:243]
    v_mfma_f32_16x16x32_bf16 v[244:247], a[100:103], a[24:27], v[244:247]
    v_mfma_f32_16x16x32_bf16 v[248:251], a[100:103], a[28:31], v[248:251]
    v_mfma_f32_16x16x32_bf16 v[252:255], a[100:103], a[32:35], v[252:255]
    s_waitcnt lgkmcnt(12)
    v_mfma_f32_16x16x32_bf16 v[64:67], a[40:43], a[0:3], v[64:67]
    ds_read_b128 a[20:23], v13 offset:8192
    v_mfma_f32_16x16x32_bf16 v[68:71], a[40:43], a[4:7], v[68:71]
    ds_read_b128 a[24:27], v13 offset:10240
    v_mfma_f32_16x16x32_bf16 v[72:75], a[40:43], a[8:11], v[72:75]
    ds_read_b128 a[28:31], v13 offset:12288
    v_mov_b32 v160, 0
    v_mfma_f32_16x16x32_bf16 v[76:79], a[40:43], a[12:15], v[76:79]
    ds_read_b128 a[32:35], v13 offset:14336
    v_mov_b32 v161, 0
    v_mfma_f32_16x16x32_bf16 v[80:83], a[44:47], a[0:3], v[80:83]
    ds_read_b64_tr_b16 a[72:73], v16 offset:40960
    v_mov_b32 v162, 0
    v_mfma_f32_16x16x32_bf16 v[84:87], a[44:47], a[4:7], v[84:87]
    ds_read_b64_tr_b16 a[74:75], v16 offset:41984
    v_mov_b32 v163, 0
    v_mfma_f32_16x16x32_bf16 v[88:91], a[44:47], a[8:11], v[88:91]
    ds_read_b64_tr_b16 a[76:77], v17 offset:40960
    v_mov_b32 v164, 0
    v_mfma_f32_16x16x32_bf16 v[92:95], a[44:47], a[12:15], v[92:95]
    s_waitcnt lgkmcnt(7)
    ds_read_b64_tr_b16 a[78:79], v17 offset:41984
    v_mov_b32 v165, 0
    v_mfma_f32_16x16x32_bf16 v[96:99], a[48:51], a[0:3], v[96:99]
    ds_read_b64_tr_b16 a[80:81], v18 offset:40960
    v_mov_b32 v166, 0
    v_mfma_f32_16x16x32_bf16 v[100:103], a[48:51], a[4:7], v[100:103]
    s_lshl_b32 s62, s30, 2
    ds_read_b64_tr_b16 a[82:83], v18 offset:41984
    v_mov_b32 v167, 0
    v_mfma_f32_16x16x32_bf16 v[104:107], a[48:51], a[8:11], v[104:107]
    ds_read_b64_tr_b16 a[84:85], v19 offset:40960
    v_mfma_f32_16x16x32_bf16 v[108:111], a[48:51], a[12:15], v[108:111]
    s_add_u32 s65, s62, s28
    ds_read_b64_tr_b16 a[86:87], v19 offset:41984
    v_mfma_f32_16x16x32_bf16 v[112:115], a[52:55], a[0:3], v[112:115]
    ds_read_b64_tr_b16 a[88:89], v20 offset:40960
    v_mfma_f32_16x16x32_bf16 v[116:119], a[52:55], a[4:7], v[116:119]
    s_lshr_b32 s66, s28, 1
    ds_read_b64_tr_b16 a[90:91], v20 offset:41984
    v_mfma_f32_16x16x32_bf16 v[120:123], a[52:55], a[8:11], v[120:123]
    ds_read_b64_tr_b16 a[92:93], v21 offset:40960
    v_mfma_f32_16x16x32_bf16 v[124:127], a[52:55], a[12:15], v[124:127]
    s_sub_u32 s66, s66, s62
    ds_read_b64_tr_b16 a[94:95], v21 offset:41984
    v_mfma_f32_16x16x32_bf16 v[192:195], a[56:59], a[0:3], v[192:195]
    ds_read_b64_tr_b16 a[96:97], v22 offset:40960
    v_mfma_f32_16x16x32_bf16 v[196:199], a[56:59], a[4:7], v[196:199]
    s_add_u32 s66, s66, 60
    ds_read_b64_tr_b16 a[98:99], v22 offset:41984
    v_mfma_f32_16x16x32_bf16 v[200:203], a[56:59], a[8:11], v[200:203]
    ds_read_b64_tr_b16 a[100:101], v23 offset:40960
    v_mfma_f32_16x16x32_bf16 v[204:207], a[56:59], a[12:15], v[204:207]
    s_lshl_b32 s70, s30, 3
    ds_read_b64_tr_b16 a[102:103], v23 offset:41984
    v_mfma_f32_16x16x32_bf16 v[208:211], a[60:63], a[0:3], v[208:211]
    v_mfma_f32_16x16x32_bf16 v[212:215], a[60:63], a[4:7], v[212:215]
    s_sub_u32 s70, 120, s70
    v_mfma_f32_16x16x32_bf16 v[216:219], a[60:63], a[8:11], v[216:219]
    v_mfma_f32_16x16x32_bf16 v[220:223], a[60:63], a[12:15], v[220:223]
    s_sub_u32 s63, s70, s28
    v_mfma_f32_16x16x32_bf16 v[224:227], a[64:67], a[0:3], v[224:227]
    v_mfma_f32_16x16x32_bf16 v[228:231], a[64:67], a[4:7], v[228:231]
    s_add_u32 s63, s63, 7
    v_mfma_f32_16x16x32_bf16 v[232:235], a[64:67], a[8:11], v[232:235]
    v_mfma_f32_16x16x32_bf16 v[236:239], a[64:67], a[12:15], v[236:239]
    s_add_u32 s70, s70, s28
    v_mfma_f32_16x16x32_bf16 v[240:243], a[68:71], a[0:3], v[240:243]
    v_mfma_f32_16x16x32_bf16 v[244:247], a[68:71], a[4:7], v[244:247]
    v_mfma_f32_16x16x32_bf16 v[248:251], a[68:71], a[8:11], v[248:251]
    v_mfma_f32_16x16x32_bf16 v[252:255], a[68:71], a[12:15], v[252:255]
    s_waitcnt lgkmcnt(12)
    v_mfma_f32_16x16x32_bf16 v[64:67], a[72:75], a[20:23], v[64:67]
    v_mfma_f32_16x16x32_bf16 v[68:71], a[72:75], a[24:27], v[68:71]
    v_mfma_f32_16x16x32_bf16 v[72:75], a[72:75], a[28:31], v[72:75]
    v_mov_b32 v168, 0
    v_mov_b32 v169, 0
    v_mfma_f32_16x16x32_bf16 v[76:79], a[72:75], a[32:35], v[76:79]
    s_waitcnt vmcnt(8) lgkmcnt(0)
    s_barrier
    v_mov_b32 v170, 0
    v_mov_b32 v171, 0
    v_mfma_f32_16x16x32_bf16 v[80:83], a[76:79], a[20:23], v[80:83]
    s_add_u32 s55, s0, 32768
    ds_read_b128 a[0:3], v12 offset:16384
    v_mov_b32 v172, 0
    v_mfma_f32_16x16x32_bf16 v[84:87], a[76:79], a[24:27], v[84:87]
    s_add_u32 m0, s0, 32768
    ds_read_b128 a[4:7], v12 offset:18432
    v_mov_b32 v173, 0
    v_mfma_f32_16x16x32_bf16 v[88:91], a[76:79], a[28:31], v[88:91]
    buffer_load_dwordx4 v2, s[8:11], s55 offen offset:0 sc1 lds
    v_mov_b32 v174, 0
    v_mfma_f32_16x16x32_bf16 v[92:95], a[76:79], a[32:35], v[92:95]
    ds_read_b128 a[8:11], v12 offset:20480
    v_mov_b32 v175, 0
    v_mfma_f32_16x16x32_bf16 v[96:99], a[80:83], a[20:23], v[96:99]
    ds_read_b128 a[12:15], v12 offset:22528
    v_mfma_f32_16x16x32_bf16 v[100:103], a[80:83], a[24:27], v[100:103]
    s_sub_u32 s62, 61, s62
    ds_read_b64_tr_b16 a[40:41], v16 offset:49152
    v_mfma_f32_16x16x32_bf16 v[104:107], a[80:83], a[28:31], v[104:107]
    buffer_load_dwordx4 v2, s[8:11], s55 offen offset:1024 sc1 lds
    v_mfma_f32_16x16x32_bf16 v[108:111], a[80:83], a[32:35], v[108:111]
    s_bfm_b64 s[56:57], s62, 0
    ds_read_b64_tr_b16 a[42:43], v16 offset:50176
    v_mfma_f32_16x16x32_bf16 v[112:115], a[84:87], a[20:23], v[112:115]
    ds_read_b64_tr_b16 a[44:45], v17 offset:49152
    v_mfma_f32_16x16x32_bf16 v[116:119], a[84:87], a[24:27], v[116:119]
    s_and_b32 s56, s56, 0x55555555
    ds_read_b64_tr_b16 a[46:47], v17 offset:50176
    v_mfma_f32_16x16x32_bf16 v[120:123], a[84:87], a[28:31], v[120:123]
    buffer_load_dwordx4 v2, s[8:11], s55 offen offset:2048 sc1 lds
    v_mfma_f32_16x16x32_bf16 v[124:127], a[84:87], a[32:35], v[124:127]
    s_and_b32 s57, s57, 0x55555555
    ds_read_b64_tr_b16 a[48:49], v18 offset:49152
    v_mfma_f32_16x16x32_bf16 v[192:195], a[88:91], a[20:23], v[192:195]
    ds_read_b64_tr_b16 a[50:51], v18 offset:50176
    v_mfma_f32_16x16x32_bf16 v[196:199], a[88:91], a[24:27], v[196:199]
    s_lshl_b32 s62, s29, 12
    ds_read_b64_tr_b16 a[52:53], v19 offset:49152
    v_mfma_f32_16x16x32_bf16 v[200:203], a[88:91], a[28:31], v[200:203]
    buffer_load_dwordx4 v2, s[8:11], s55 offen offset:3072 sc1 lds
    v_mfma_f32_16x16x32_bf16 v[204:207], a[88:91], a[32:35], v[204:207]
    s_add_u32 s62, s62, 39845888
    ds_read_b64_tr_b16 a[54:55], v19 offset:50176
    v_mfma_f32_16x16x32_bf16 v[208:211], a[92:95], a[20:23], v[208:211]
    ds_read_b64_tr_b16 a[56:57], v20 offset:49152
    v_mfma_f32_16x16x32_bf16 v[212:215], a[92:95], a[24:27], v[212:215]
    s_mul_i32 s70, s70, 131072
    ds_read_b64_tr_b16 a[58:59], v20 offset:50176
    v_mfma_f32_16x16x32_bf16 v[216:219], a[92:95], a[28:31], v[216:219]
    ds_read_b64_tr_b16 a[60:61], v21 offset:49152
    v_mfma_f32_16x16x32_bf16 v[220:223], a[92:95], a[32:35], v[220:223]
    s_add_u32 s70, s70, s62
    ds_read_b64_tr_b16 a[62:63], v21 offset:50176
    v_mfma_f32_16x16x32_bf16 v[224:227], a[96:99], a[20:23], v[224:227]
    ds_read_b64_tr_b16 a[64:65], v22 offset:49152
    v_mfma_f32_16x16x32_bf16 v[228:231], a[96:99], a[24:27], v[228:231]
    s_mul_i32 s63, s63, 131072
    ds_read_b64_tr_b16 a[66:67], v22 offset:50176
    v_mfma_f32_16x16x32_bf16 v[232:235], a[96:99], a[28:31], v[232:235]
    ds_read_b64_tr_b16 a[68:69], v23 offset:49152
    v_mfma_f32_16x16x32_bf16 v[236:239], a[96:99], a[32:35], v[236:239]
    s_add_u32 s63, s63, s62
    ds_read_b64_tr_b16 a[70:71], v23 offset:50176
    v_mfma_f32_16x16x32_bf16 v[240:243], a[100:103], a[20:23], v[240:243]
    v_mfma_f32_16x16x32_bf16 v[244:247], a[100:103], a[24:27], v[244:247]
    v_mfma_f32_16x16x32_bf16 v[248:251], a[100:103], a[28:31], v[248:251]
    v_mfma_f32_16x16x32_bf16 v[252:255], a[100:103], a[32:35], v[252:255]
    s_waitcnt lgkmcnt(12)
    v_mfma_f32_16x16x32_bf16 v[64:67], a[40:43], a[0:3], v[64:67]
    ds_read_b128 a[20:23], v13 offset:16384
    v_mfma_f32_16x16x32_bf16 v[68:71], a[40:43], a[4:7], v[68:71]
    ds_read_b128 a[24:27], v13 offset:18432
    v_mfma_f32_16x16x32_bf16 v[72:75], a[40:43], a[8:11], v[72:75]
    ds_read_b128 a[28:31], v13 offset:20480
    v_mov_b32 v176, 0
    v_mfma_f32_16x16x32_bf16 v[76:79], a[40:43], a[12:15], v[76:79]
    ds_read_b128 a[32:35], v13 offset:22528
    v_mov_b32 v177, 0
    v_mfma_f32_16x16x32_bf16 v[80:83], a[44:47], a[0:3], v[80:83]
    ds_read_b64_tr_b16 a[72:73], v16 offset:57344
    v_mov_b32 v178, 0
    v_mfma_f32_16x16x32_bf16 v[84:87], a[44:47], a[4:7], v[84:87]
    ds_read_b64_tr_b16 a[74:75], v16 offset:58368
    v_mov_b32 v179, 0
    v_mfma_f32_16x16x32_bf16 v[88:91], a[44:47], a[8:11], v[88:91]
    ds_read_b64_tr_b16 a[76:77], v17 offset:57344
    v_mov_b32 v180, 0
    v_mfma_f32_16x16x32_bf16 v[92:95], a[44:47], a[12:15], v[92:95]
    s_waitcnt lgkmcnt(7)
    ds_read_b64_tr_b16 a[78:79], v17 offset:58368
    v_mov_b32 v181, 0
    v_mfma_f32_16x16x32_bf16 v[96:99], a[48:51], a[0:3], v[96:99]
    ds_read_b64_tr_b16 a[80:81], v18 offset:57344
    v_mov_b32 v182, 0
    v_mfma_f32_16x16x32_bf16 v[100:103], a[48:51], a[4:7], v[100:103]
    s_mul_i32 s71, s65, 262144
    ds_read_b64_tr_b16 a[82:83], v18 offset:58368
    v_mov_b32 v183, 0
    v_mfma_f32_16x16x32_bf16 v[104:107], a[48:51], a[8:11], v[104:107]
    ds_read_b64_tr_b16 a[84:85], v19 offset:57344
    v_mfma_f32_16x16x32_bf16 v[108:111], a[48:51], a[12:15], v[108:111]
    s_add_u32 s71, s71, s62
    ds_read_b64_tr_b16 a[86:87], v19 offset:58368
    v_mfma_f32_16x16x32_bf16 v[112:115], a[52:55], a[0:3], v[112:115]
    ds_read_b64_tr_b16 a[88:89], v20 offset:57344
    v_mfma_f32_16x16x32_bf16 v[116:119], a[52:55], a[4:7], v[116:119]
    s_mov_b64 s[58:59], 0
    ds_read_b64_tr_b16 a[90:91], v20 offset:58368
    v_mfma_f32_16x16x32_bf16 v[120:123], a[52:55], a[8:11], v[120:123]
    ds_read_b64_tr_b16 a[92:93], v21 offset:57344
    v_mfma_f32_16x16x32_bf16 v[124:127], a[52:55], a[12:15], v[124:127]
    s_mov_b64 s[60:61], 0
    ds_read_b64_tr_b16 a[94:95], v21 offset:58368
    v_mfma_f32_16x16x32_bf16 v[192:195], a[56:59], a[0:3], v[192:195]
    ds_read_b64_tr_b16 a[96:97], v22 offset:57344
    v_mfma_f32_16x16x32_bf16 v[196:199], a[56:59], a[4:7], v[196:199]
    s_add_u32 s72, s0, 98304
    ds_read_b64_tr_b16 a[98:99], v22 offset:58368
    v_mfma_f32_16x16x32_bf16 v[200:203], a[56:59], a[8:11], v[200:203]
    ds_read_b64_tr_b16 a[100:101], v23 offset:57344
    v_mfma_f32_16x16x32_bf16 v[204:207], a[56:59], a[12:15], v[204:207]
    s_lshl_b32 s65, s65, 14
    ds_read_b64_tr_b16 a[102:103], v23 offset:58368
    v_mfma_f32_16x16x32_bf16 v[208:211], a[60:63], a[0:3], v[208:211]
    v_mfma_f32_16x16x32_bf16 v[212:215], a[60:63], a[4:7], v[212:215]
    s_add_u32 s65, s65, s72
    v_mfma_f32_16x16x32_bf16 v[216:219], a[60:63], a[8:11], v[216:219]
    v_mfma_f32_16x16x32_bf16 v[220:223], a[60:63], a[12:15], v[220:223]
    s_lshl_b32 s66, s66, 14
    v_mfma_f32_16x16x32_bf16 v[224:227], a[64:67], a[0:3], v[224:227]
    v_mfma_f32_16x16x32_bf16 v[228:231], a[64:67], a[4:7], v[228:231]
    s_add_u32 s66, s66, s72
    v_mfma_f32_16x16x32_bf16 v[232:235], a[64:67], a[8:11], v[232:235]
    v_mfma_f32_16x16x32_bf16 v[236:239], a[64:67], a[12:15], v[236:239]
    s_sub_u32 s67, s65, 16384
    v_mfma_f32_16x16x32_bf16 v[240:243], a[68:71], a[0:3], v[240:243]
    v_mfma_f32_16x16x32_bf16 v[244:247], a[68:71], a[4:7], v[244:247]
    v_mfma_f32_16x16x32_bf16 v[248:251], a[68:71], a[8:11], v[248:251]
    v_mfma_f32_16x16x32_bf16 v[252:255], a[68:71], a[12:15], v[252:255]
    s_waitcnt lgkmcnt(12)
    v_mfma_f32_16x16x32_bf16 v[64:67], a[72:75], a[20:23], v[64:67]
    v_mfma_f32_16x16x32_bf16 v[68:71], a[72:75], a[24:27], v[68:71]
    v_mfma_f32_16x16x32_bf16 v[72:75], a[72:75], a[28:31], v[72:75]
    v_mov_b32 v184, 0
    v_mov_b32 v185, 0
    v_mfma_f32_16x16x32_bf16 v[76:79], a[72:75], a[32:35], v[76:79]
    s_waitcnt lgkmcnt(0)
    v_mov_b32 v186, 0
    v_mov_b32 v187, 0
    v_mfma_f32_16x16x32_bf16 v[80:83], a[76:79], a[20:23], v[80:83]
    v_mov_b32 v188, 0
    v_mov_b32 v189, 0
    v_mfma_f32_16x16x32_bf16 v[84:87], a[76:79], a[24:27], v[84:87]
    v_mov_b32 v190, 0
    v_mov_b32 v191, 0
    v_mfma_f32_16x16x32_bf16 v[88:91], a[76:79], a[28:31], v[88:91]
    v_mfma_f32_16x16x32_bf16 v[92:95], a[76:79], a[32:35], v[92:95]
    v_mfma_f32_16x16x32_bf16 v[96:99], a[80:83], a[20:23], v[96:99]
    v_mfma_f32_16x16x32_bf16 v[100:103], a[80:83], a[24:27], v[100:103]
    s_sub_u32 s68, s66, 16384
    v_mfma_f32_16x16x32_bf16 v[104:107], a[80:83], a[28:31], v[104:107]
    v_mfma_f32_16x16x32_bf16 v[108:111], a[80:83], a[32:35], v[108:111]
    s_lshl_b32 s76, s30, 16
    v_mfma_f32_16x16x32_bf16 v[112:115], a[84:87], a[20:23], v[112:115]
    v_mfma_f32_16x16x32_bf16 v[116:119], a[84:87], a[24:27], v[116:119]
    s_add_u32 s76, s76, s72
    v_mfma_f32_16x16x32_bf16 v[120:123], a[84:87], a[28:31], v[120:123]
    v_mfma_f32_16x16x32_bf16 v[124:127], a[84:87], a[32:35], v[124:127]
    s_add_u32 s76, s76, 65536
    v_mfma_f32_16x16x32_bf16 v[192:195], a[88:91], a[20:23], v[192:195]
    v_mfma_f32_16x16x32_bf16 v[196:199], a[88:91], a[24:27], v[196:199]
    s_min_u32 s69, s76, s68
    v_mfma_f32_16x16x32_bf16 v[200:203], a[88:91], a[28:31], v[200:203]
    v_mfma_f32_16x16x32_bf16 v[204:207], a[88:91], a[32:35], v[204:207]
    s_add_u32 s73, s0, 147456
    v_mfma_f32_16x16x32_bf16 v[208:211], a[92:95], a[20:23], v[208:211]
    v_mfma_f32_16x16x32_bf16 v[212:215], a[92:95], a[24:27], v[212:215]
    v_mfma_f32_16x16x32_bf16 v[216:219], a[92:95], a[28:31], v[216:219]
    v_mfma_f32_16x16x32_bf16 v[220:223], a[92:95], a[32:35], v[220:223]
    v_mfma_f32_16x16x32_bf16 v[224:227], a[96:99], a[20:23], v[224:227]
    v_mfma_f32_16x16x32_bf16 v[228:231], a[96:99], a[24:27], v[228:231]
    v_mfma_f32_16x16x32_bf16 v[232:235], a[96:99], a[28:31], v[232:235]
    v_mfma_f32_16x16x32_bf16 v[236:239], a[96:99], a[32:35], v[236:239]
    v_mfma_f32_16x16x32_bf16 v[240:243], a[100:103], a[20:23], v[240:243]
    v_mfma_f32_16x16x32_bf16 v[244:247], a[100:103], a[24:27], v[244:247]
    v_mfma_f32_16x16x32_bf16 v[248:251], a[100:103], a[28:31], v[248:251]
    v_add_u32 v13, s0, v2
    v_mfma_f32_16x16x32_bf16 v[252:255], a[100:103], a[32:35], v[252:255]
    s_waitcnt vmcnt(4)
    s_barrier
    ds_read_b128 a[0:3], v2 offset:0
    ds_read_b128 a[4:7], v2 offset:1024
    ds_read_b128 a[8:11], v2 offset:2048
    ds_read_b128 a[12:15], v2 offset:3072
    ds_read_b128 a[16:19], v2 offset:4096
    ds_read_b128 a[20:23], v2 offset:5120
    ds_read_b128 a[24:27], v2 offset:6144
    ds_read_b128 a[28:31], v2 offset:7168
    v_add_u32 v14, 16384, v2
    v_cvt_pk_bf16_f32 v48, v72, v73
    s_add_u32 s55, s0, 49152
    s_add_u32 m0, s0, 49152
    v_cvt_pk_bf16_f32 v49, v74, v75
    buffer_load_dwordx4 v2, s[8:11], s55 offen offset:0 sc1 lds
    v_cvt_pk_bf16_f32 v50, v88, v89
    v_cvt_pk_bf16_f32 v51, v90, v91
    v_accvgpr_write_b32 a96, v48
    v_accvgpr_write_b32 a97, v49
    v_accvgpr_write_b32 a98, v50
    v_accvgpr_write_b32 a99, v51
    v_cvt_pk_bf16_f32 v52, v104, v105
    v_cvt_pk_bf16_f32 v53, v106, v107
    buffer_load_dwordx4 v2, s[8:11], s55 offen offset:1024 sc1 lds
    v_cvt_pk_bf16_f32 v54, v120, v121
    v_cvt_pk_bf16_f32 v55, v122, v123
    v_accvgpr_write_b32 a100, v52
    v_accvgpr_write_b32 a101, v53
    v_accvgpr_write_b32 a102, v54
    v_accvgpr_write_b32 a103, v55
    v_cvt_pk_bf16_f32 v48, v200, v201
    v_cvt_pk_bf16_f32 v49, v202, v203
    buffer_load_dwordx4 v2, s[8:11], s55 offen offset:2048 sc1 lds
    v_cvt_pk_bf16_f32 v50, v216, v217
    v_cvt_pk_bf16_f32 v51, v218, v219
    v_accvgpr_write_b32 a104, v48
    v_accvgpr_write_b32 a105, v49
    v_accvgpr_write_b32 a106, v50
    v_accvgpr_write_b32 a107, v51
    v_cvt_pk_bf16_f32 v52, v232, v233
    v_cvt_pk_bf16_f32 v53, v234, v235
    buffer_load_dwordx4 v2, s[8:11], s55 offen offset:3072 sc1 lds
    v_cvt_pk_bf16_f32 v54, v248, v249
    v_cvt_pk_bf16_f32 v55, v250, v251
    v_accvgpr_write_b32 a108, v52
    v_accvgpr_write_b32 a109, v53
    v_accvgpr_write_b32 a110, v54
    v_accvgpr_write_b32 a111, v55
    s_waitcnt lgkmcnt(0)
    v_cvt_pk_bf16_f32 v48, v76, v77
    s_add_u32 s55, s0, 65536
    s_add_u32 m0, s0, 65536
    v_cvt_pk_bf16_f32 v49, v78, v79
    buffer_load_dwordx4 v2, s[8:11], s55 offen offset:0 sc1 lds
    v_cvt_pk_bf16_f32 v50, v92, v93
    v_cvt_pk_bf16_f32 v51, v94, v95
    v_mfma_f32_16x16x32_bf16 v[32:35], a[0:3], a[96:99], 0
    v_accvgpr_write_b32 a112, v48
    v_accvgpr_write_b32 a113, v49
    v_accvgpr_write_b32 a114, v50
    v_accvgpr_write_b32 a115, v51
    v_mfma_f32_16x16x32_bf16 v[32:35], a[4:7], a[100:103], v[32:35]
    v_cvt_pk_bf16_f32 v52, v108, v109
    v_cvt_pk_bf16_f32 v53, v110, v111
    buffer_load_dwordx4 v2, s[8:11], s55 offen offset:1024 sc1 lds
    v_cvt_pk_bf16_f32 v54, v124, v125
    v_cvt_pk_bf16_f32 v55, v126, v127
    v_mfma_f32_16x16x32_bf16 v[32:35], a[8:11], a[104:107], v[32:35]
    v_accvgpr_write_b32 a116, v52
    v_accvgpr_write_b32 a117, v53
    v_accvgpr_write_b32 a118, v54
    v_accvgpr_write_b32 a119, v55
    v_mfma_f32_16x16x32_bf16 v[32:35], a[12:15], a[108:111], v[32:35]
    v_cvt_pk_bf16_f32 v48, v204, v205
    v_cvt_pk_bf16_f32 v49, v206, v207
    buffer_load_dwordx4 v2, s[8:11], s55 offen offset:2048 sc1 lds
    v_cvt_pk_bf16_f32 v50, v220, v221
    v_cvt_pk_bf16_f32 v51, v222, v223
    v_mfma_f32_16x16x32_bf16 v[36:39], a[16:19], a[96:99], 0
    v_accvgpr_write_b32 a120, v48
    v_accvgpr_write_b32 a121, v49
    v_accvgpr_write_b32 a122, v50
    v_accvgpr_write_b32 a123, v51
    v_mfma_f32_16x16x32_bf16 v[36:39], a[20:23], a[100:103], v[36:39]
    v_cvt_pk_bf16_f32 v52, v236, v237
    v_cvt_pk_bf16_f32 v53, v238, v239
    buffer_load_dwordx4 v2, s[8:11], s55 offen offset:3072 sc1 lds
    v_cvt_pk_bf16_f32 v54, v252, v253
    v_cvt_pk_bf16_f32 v55, v254, v255
    v_mfma_f32_16x16x32_bf16 v[36:39], a[24:27], a[104:107], v[36:39]
    v_accvgpr_write_b32 a124, v52
    v_accvgpr_write_b32 a125, v53
    v_accvgpr_write_b32 a126, v54
    v_accvgpr_write_b32 a127, v55
    v_mfma_f32_16x16x32_bf16 v[36:39], a[28:31], a[108:111], v[36:39]
    v_cvt_pk_bf16_f32 v48, v64, v65
    s_add_u32 s55, s0, 81920
    s_add_u32 m0, s0, 81920
    v_cvt_pk_bf16_f32 v49, v66, v67
    buffer_load_dwordx4 v2, s[8:11], s55 offen offset:0 sc1 lds
    v_cvt_pk_bf16_f32 v50, v80, v81
    v_cvt_pk_bf16_f32 v51, v82, v83
    v_mfma_f32_16x16x32_bf16 v[40:43], a[0:3], a[112:115], 0
    v_accvgpr_write_b32 a64, v48
    v_accvgpr_write_b32 a65, v49
    v_accvgpr_write_b32 a66, v50
    v_accvgpr_write_b32 a67, v51
    v_mfma_f32_16x16x32_bf16 v[40:43], a[4:7], a[116:119], v[40:43]
    v_cvt_pk_bf16_f32 v52, v96, v97
    v_cvt_pk_bf16_f32 v53, v98, v99
    buffer_load_dwordx4 v2, s[8:11], s55 offen offset:1024 sc1 lds
    v_cvt_pk_bf16_f32 v54, v112, v113
    v_cvt_pk_bf16_f32 v55, v114, v115
    v_mfma_f32_16x16x32_bf16 v[40:43], a[8:11], a[120:123], v[40:43]
    v_accvgpr_write_b32 a68, v52
    v_accvgpr_write_b32 a69, v53
    v_accvgpr_write_b32 a70, v54
    v_accvgpr_write_b32 a71, v55
    v_mfma_f32_16x16x32_bf16 v[40:43], a[12:15], a[124:127], v[40:43]
    v_cvt_pk_bf16_f32 v48, v192, v193
    v_cvt_pk_bf16_f32 v49, v194, v195
    buffer_load_dwordx4 v2, s[8:11], s55 offen offset:2048 sc1 lds
    v_cvt_pk_bf16_f32 v50, v208, v209
    v_cvt_pk_bf16_f32 v51, v210, v211
    v_mfma_f32_16x16x32_bf16 v[44:47], a[16:19], a[112:115], 0
    v_accvgpr_write_b32 a72, v48
    v_accvgpr_write_b32 a73, v49
    v_accvgpr_write_b32 a74, v50
    v_accvgpr_write_b32 a75, v51
    v_mfma_f32_16x16x32_bf16 v[44:47], a[20:23], a[116:119], v[44:47]
    v_cvt_pk_bf16_f32 v52, v224, v225
    v_cvt_pk_bf16_f32 v53, v226, v227
    buffer_load_dwordx4 v2, s[8:11], s55 offen offset:3072 sc1 lds
    v_cvt_pk_bf16_f32 v54, v240, v241
    v_cvt_pk_bf16_f32 v55, v242, v243
    v_mfma_f32_16x16x32_bf16 v[44:47], a[24:27], a[120:123], v[44:47]
    v_accvgpr_write_b32 a76, v52
    v_accvgpr_write_b32 a77, v53
    v_accvgpr_write_b32 a78, v54
    v_accvgpr_write_b32 a79, v55
    v_mfma_f32_16x16x32_bf16 v[44:47], a[28:31], a[124:127], v[44:47]
    v_cvt_pk_bf16_f32 v48, v68, v69
    s_add_u32 s55, s0, 98304
    s_add_u32 m0, s0, 98304
    v_cvt_pk_bf16_f32 v49, v70, v71
    buffer_load_dwordx4 v2, s[8:11], s55 offen offset:0 sc1 lds
    v_cvt_pk_bf16_f32 v50, v84, v85
    v_cvt_pk_bf16_f32 v51, v86, v87
    v_mfma_f32_16x16x32_bf16 v[16:19], a[0:3], a[64:67], 0
    v_accvgpr_write_b32 a80, v48
    v_accvgpr_write_b32 a81, v49
    v_accvgpr_write_b32 a82, v50
    v_accvgpr_write_b32 a83, v51
    v_mfma_f32_16x16x32_bf16 v[16:19], a[4:7], a[68:71], v[16:19]
    v_cvt_pk_bf16_f32 v52, v100, v101
    v_cvt_pk_bf16_f32 v53, v102, v103
    buffer_load_dwordx4 v2, s[8:11], s55 offen offset:1024 sc1 lds
    v_cvt_pk_bf16_f32 v54, v116, v117
    v_cvt_pk_bf16_f32 v55, v118, v119
    v_mfma_f32_16x16x32_bf16 v[16:19], a[8:11], a[72:75], v[16:19]
    v_accvgpr_write_b32 a84, v52
    v_accvgpr_write_b32 a85, v53
    v_accvgpr_write_b32 a86, v54
    v_accvgpr_write_b32 a87, v55
    v_mfma_f32_16x16x32_bf16 v[16:19], a[12:15], a[76:79], v[16:19]
    v_cvt_pk_bf16_f32 v48, v196, v197
    v_cvt_pk_bf16_f32 v49, v198, v199
    buffer_load_dwordx4 v2, s[8:11], s55 offen offset:2048 sc1 lds
    v_cvt_pk_bf16_f32 v50, v212, v213
    v_cvt_pk_bf16_f32 v51, v214, v215
    v_mfma_f32_16x16x32_bf16 v[20:23], a[16:19], a[64:67], 0
    v_accvgpr_write_b32 a88, v48
    v_accvgpr_write_b32 a89, v49
    v_accvgpr_write_b32 a90, v50
    v_accvgpr_write_b32 a91, v51
    v_mfma_f32_16x16x32_bf16 v[20:23], a[20:23], a[68:71], v[20:23]
    v_cvt_pk_bf16_f32 v52, v228, v229
    v_cvt_pk_bf16_f32 v53, v230, v231
    buffer_load_dwordx4 v2, s[8:11], s55 offen offset:3072 sc1 lds
    v_cvt_pk_bf16_f32 v54, v244, v245
    v_cvt_pk_bf16_f32 v55, v246, v247
    v_mfma_f32_16x16x32_bf16 v[20:23], a[24:27], a[72:75], v[20:23]
    v_accvgpr_write_b32 a92, v52
    v_accvgpr_write_b32 a93, v53
    v_accvgpr_write_b32 a94, v54
    v_accvgpr_write_b32 a95, v55
    v_mfma_f32_16x16x32_bf16 v[20:23], a[28:31], a[76:79], v[20:23]
    v_mov_b32 v15, 0x4f800000
    v_xor_b32 v12, 0x10000, v13
    v_and_b32 v7, 15, v1
    v_mfma_f32_16x16x32_bf16 v[24:27], a[0:3], a[80:83], 0
    ds_read_b128 a[0:3], v14 offset:0
    v_lshrrev_b32 v8, 4, v1
    v_lshlrev_b32 v8, 2, v8
    v_mov_b32 v9, 0x7f7fffff
    v_mfma_f32_16x16x32_bf16 v[24:27], a[4:7], a[84:87], v[24:27]
    ds_read_b128 a[4:7], v14 offset:1024
    v_mov_b32 v10, 0xf149f2ca
    v_mov_b32 v6, 0x3f803f80
    v_add_u32 v11, 0, v8
    v_mfma_f32_16x16x32_bf16 v[24:27], a[8:11], a[88:91], v[24:27]
    ds_read_b128 a[8:11], v14 offset:2048
    v_cmp_gt_u32 vcc, v11, v7
    v_mov_b32 v124, 0
    v_accvgpr_write_b32 a128, v6
    v_mfma_f32_16x16x32_bf16 v[24:27], a[12:15], a[92:95], v[24:27]
    ds_read_b128 a[12:15], v14 offset:3072
    v_cndmask_b32 v112, v9, v10, vcc
    v_add_u32 v11, 1, v8
    v_cmp_gt_u32 vcc, v11, v7
    v_mfma_f32_16x16x32_bf16 v[28:31], a[16:19], a[80:83], 0
    ds_read_b128 a[16:19], v14 offset:4096
    v_mov_b32 v125, 0
    v_accvgpr_write_b32 a129, v6
    v_cndmask_b32 v113, v9, v10, vcc
    v_mfma_f32_16x16x32_bf16 v[28:31], a[20:23], a[84:87], v[28:31]
    ds_read_b128 a[20:23], v14 offset:5120
    v_add_u32 v11, 2, v8
    v_cmp_gt_u32 vcc, v11, v7
    v_mov_b32 v126, 0
    v_mfma_f32_16x16x32_bf16 v[28:31], a[24:27], a[88:91], v[28:31]
    ds_read_b128 a[24:27], v14 offset:6144
    v_accvgpr_write_b32 a130, v6
    v_cndmask_b32 v114, v9, v10, vcc
    v_add_u32 v11, 3, v8
    v_mfma_f32_16x16x32_bf16 v[28:31], a[28:31], a[92:95], v[28:31]
    ds_read_b128 a[28:31], v14 offset:7168
    v_cmp_gt_u32 vcc, v11, v7
    v_mov_b32 v127, 0
    v_accvgpr_write_b32 a131, v6
    v_cndmask_b32 v115, v9, v10, vcc
    ds_read_b128 a[32:35], v14 offset:8192
    ds_read_b128 a[36:39], v14 offset:9216
    ds_read_b128 a[40:43], v14 offset:10240
    ds_read_b128 a[44:47], v14 offset:11264
    s_cmp_lg_u32 s65, s55
    s_cbranch_scc1 AT_nm0
    v_min_f32 v32, v32, v112
    v_mov_b32 v36, 0xf149f2ca
    v_min_f32 v44, v44, v112
    v_min_f32 v33, v33, v113
    v_mov_b32 v37, 0xf149f2ca
    v_min_f32 v45, v45, v113
    v_min_f32 v34, v34, v114
    v_mov_b32 v38, 0xf149f2ca
    v_min_f32 v46, v46, v114
    v_min_f32 v35, v35, v115
    v_mov_b32 v39, 0xf149f2ca
    v_min_f32 v47, v47, v115
AT_nm0:
    v_max3_f32 v118, v32, v33, v34
    v_max3_f32 v118, v118, v35, v36
    v_max3_f32 v118, v118, v37, v38
    v_max_f32 v118, v118, v39
    v_mov_b32 v50, v118
    v_max3_f32 v119, v40, v41, v42
    v_max3_f32 v119, v119, v43, v44
    v_max3_f32 v119, v119, v45, v46
    v_max_f32 v119, v119, v47
    v_mov_b32 v51, v119
    v_max3_f32 v116, v16, v17, v18
    v_max3_f32 v116, v116, v19, v20
    v_max3_f32 v116, v116, v21, v22
    v_max_f32 v116, v116, v23
    v_mov_b32 v48, v116
    v_max3_f32 v117, v24, v25, v26
    v_max3_f32 v117, v117, v27, v28
    v_max3_f32 v117, v117, v29, v30
    v_max_f32 v117, v117, v31
    v_mov_b32 v49, v117
    v_accvgpr_write_b32 a132, 0
    v_accvgpr_write_b32 a133, 0
    v_permlane32_swap_b32 v116, v48
    v_permlane32_swap_b32 v117, v49
    v_permlane32_swap_b32 v118, v50
    v_permlane32_swap_b32 v119, v51
    v_max_f32 v116, v116, v48
    v_mov_b32 v48, v116
    v_max_f32 v117, v117, v49
    v_mov_b32 v49, v117
    v_max_f32 v118, v118, v50
    v_mov_b32 v50, v118
    v_max_f32 v119, v119, v51
    v_mov_b32 v51, v119
    v_accvgpr_write_b32 a134, 0
    v_accvgpr_write_b32 a135, 0
    v_accvgpr_write_b32 a136, 0
    v_accvgpr_write_b32 a137, 0
    v_accvgpr_write_b32 a138, 0
    v_accvgpr_write_b32 a139, 0
    v_accvgpr_write_b32 a140, 0
    v_accvgpr_write_b32 a141, 0
    v_accvgpr_write_b32 a142, 0
    v_accvgpr_write_b32 a143, 0
    v_permlane16_swap_b32 v116, v48
    v_permlane16_swap_b32 v117, v49
    v_permlane16_swap_b32 v118, v50
    v_permlane16_swap_b32 v119, v51
    v_max_f32 v116, v116, v48
    v_max_f32 v117, v117, v49
    v_max_f32 v118, v118, v50
    v_max_f32 v119, v119, v51
    v_pk_add_f32 v[16:17], v[16:17], v[116:117] op_sel:[0,0] op_sel_hi:[1,0] neg_lo:[0,1] neg_hi:[0,1]
    v_pk_add_f32 v[18:19], v[18:19], v[116:117] op_sel:[0,0] op_sel_hi:[1,0] neg_lo:[0,1] neg_hi:[0,1]
    v_pk_add_f32 v[20:21], v[20:21], v[116:117] op_sel:[0,0] op_sel_hi:[1,0] neg_lo:[0,1] neg_hi:[0,1]
    v_pk_add_f32 v[22:23], v[22:23], v[116:117] op_sel:[0,0] op_sel_hi:[1,0] neg_lo:[0,1] neg_hi:[0,1]
    v_pk_add_f32 v[32:33], v[32:33], v[118:119] op_sel:[0,0] op_sel_hi:[1,0] neg_lo:[0,1] neg_hi:[0,1]
    v_pk_add_f32 v[34:35], v[34:35], v[118:119] op_sel:[0,0] op_sel_hi:[1,0] neg_lo:[0,1] neg_hi:[0,1]
    v_pk_add_f32 v[36:37], v[36:37], v[118:119] op_sel:[0,0] op_sel_hi:[1,0] neg_lo:[0,1] neg_hi:[0,1]
    v_pk_add_f32 v[38:39], v[38:39], v[118:119] op_sel:[0,0] op_sel_hi:[1,0] neg_lo:[0,1] neg_hi:[0,1]
    v_pk_add_f32 v[24:25], v[24:25], v[116:117] op_sel:[0,1] op_sel_hi:[1,1] neg_lo:[0,1] neg_hi:[0,1]
    v_pk_add_f32 v[26:27], v[26:27], v[116:117] op_sel:[0,1] op_sel_hi:[1,1] neg_lo:[0,1] neg_hi:[0,1]
    v_pk_add_f32 v[28:29], v[28:29], v[116:117] op_sel:[0,1] op_sel_hi:[1,1] neg_lo:[0,1] neg_hi:[0,1]
    v_pk_add_f32 v[30:31], v[30:31], v[116:117] op_sel:[0,1] op_sel_hi:[1,1] neg_lo:[0,1] neg_hi:[0,1]
    v_pk_add_f32 v[40:41], v[40:41], v[118:119] op_sel:[0,1] op_sel_hi:[1,1] neg_lo:[0,1] neg_hi:[0,1]
    v_pk_add_f32 v[42:43], v[42:43], v[118:119] op_sel:[0,1] op_sel_hi:[1,1] neg_lo:[0,1] neg_hi:[0,1]
    v_pk_add_f32 v[44:45], v[44:45], v[118:119] op_sel:[0,1] op_sel_hi:[1,1] neg_lo:[0,1] neg_hi:[0,1]
    v_pk_add_f32 v[46:47], v[46:47], v[118:119] op_sel:[0,1] op_sel_hi:[1,1] neg_lo:[0,1] neg_hi:[0,1]
    v_exp_f32 v48, v16
    v_exp_f32 v49, v17
    v_exp_f32 v50, v18
    v_exp_f32 v51, v19
    v_exp_f32 v52, v20
    v_exp_f32 v53, v21
    v_exp_f32 v54, v22
    v_exp_f32 v55, v23
    v_exp_f32 v56, v32
    v_exp_f32 v57, v33
    v_exp_f32 v58, v34
    v_exp_f32 v59, v35
    v_exp_f32 v60, v36
    v_exp_f32 v61, v37
    v_exp_f32 v62, v38
    v_exp_f32 v63, v39
    v_exp_f32 v8, v24
    v_exp_f32 v9, v25
    v_exp_f32 v10, v26
    v_exp_f32 v11, v27
    v_pk_add_f32 v[80:81], v[128:129], v[116:117] op_sel:[0,0] op_sel_hi:[1,0] neg_lo:[0,1] neg_hi:[0,1]
    v_pk_add_f32 v[82:83], v[128:129], v[116:117] op_sel:[0,0] op_sel_hi:[1,0] neg_lo:[0,1] neg_hi:[0,1]
    v_pk_add_f32 v[84:85], v[128:129], v[116:117] op_sel:[0,0] op_sel_hi:[1,0] neg_lo:[0,1] neg_hi:[0,1]
    v_pk_add_f32 v[86:87], v[128:129], v[116:117] op_sel:[0,0] op_sel_hi:[1,0] neg_lo:[0,1] neg_hi:[0,1]
    v_pk_add_f32 v[88:89], v[128:129], v[116:117] op_sel:[0,1] op_sel_hi:[1,1] neg_lo:[0,1] neg_hi:[0,1]
    v_pk_add_f32 v[90:91], v[128:129], v[116:117] op_sel:[0,1] op_sel_hi:[1,1] neg_lo:[0,1] neg_hi:[0,1]
    v_pk_add_f32 v[92:93], v[128:129], v[116:117] op_sel:[0,1] op_sel_hi:[1,1] neg_lo:[0,1] neg_hi:[0,1]
    v_pk_add_f32 v[94:95], v[128:129], v[116:117] op_sel:[0,1] op_sel_hi:[1,1] neg_lo:[0,1] neg_hi:[0,1]
    v_pk_add_f32 v[96:97], v[128:129], v[118:119] op_sel:[0,0] op_sel_hi:[1,0] neg_lo:[0,1] neg_hi:[0,1]
    v_pk_add_f32 v[98:99], v[128:129], v[118:119] op_sel:[0,0] op_sel_hi:[1,0] neg_lo:[0,1] neg_hi:[0,1]
    v_pk_add_f32 v[100:101], v[128:129], v[118:119] op_sel:[0,0] op_sel_hi:[1,0] neg_lo:[0,1] neg_hi:[0,1]
    v_pk_add_f32 v[102:103], v[128:129], v[118:119] op_sel:[0,0] op_sel_hi:[1,0] neg_lo:[0,1] neg_hi:[0,1]
    v_pk_add_f32 v[104:105], v[128:129], v[118:119] op_sel:[0,1] op_sel_hi:[1,1] neg_lo:[0,1] neg_hi:[0,1]
    v_pk_add_f32 v[106:107], v[128:129], v[118:119] op_sel:[0,1] op_sel_hi:[1,1] neg_lo:[0,1] neg_hi:[0,1]
    v_pk_add_f32 v[108:109], v[128:129], v[118:119] op_sel:[0,1] op_sel_hi:[1,1] neg_lo:[0,1] neg_hi:[0,1]
    v_pk_add_f32 v[110:111], v[128:129], v[118:119] op_sel:[0,1] op_sel_hi:[1,1] neg_lo:[0,1] neg_hi:[0,1]
    v_pk_mul_f32 v[192:193], v[128:129], v[128:129]
    v_pk_mul_f32 v[194:195], v[128:129], v[128:129]
    v_pk_mul_f32 v[196:197], v[128:129], v[128:129]
    v_pk_mul_f32 v[198:199], v[128:129], v[128:129]
    v_pk_mul_f32 v[200:201], v[128:129], v[128:129]
    v_pk_mul_f32 v[202:203], v[128:129], v[128:129]
    v_pk_mul_f32 v[204:205], v[128:129], v[128:129]
    v_pk_mul_f32 v[206:207], v[128:129], v[128:129]
    v_pk_mul_f32 v[208:209], v[128:129], v[128:129]
    v_pk_mul_f32 v[210:211], v[128:129], v[128:129]
    v_pk_mul_f32 v[212:213], v[128:129], v[128:129]
    v_pk_mul_f32 v[214:215], v[128:129], v[128:129]
    v_pk_mul_f32 v[216:217], v[128:129], v[128:129]
    v_pk_mul_f32 v[218:219], v[128:129], v[128:129]
    v_pk_mul_f32 v[220:221], v[128:129], v[128:129]
    v_pk_mul_f32 v[222:223], v[128:129], v[128:129]
    v_pk_mul_f32 v[224:225], v[128:129], v[128:129]
    v_pk_mul_f32 v[226:227], v[128:129], v[128:129]
    v_pk_mul_f32 v[228:229], v[128:129], v[128:129]
    v_pk_mul_f32 v[230:231], v[128:129], v[128:129]
    v_pk_mul_f32 v[232:233], v[128:129], v[128:129]
    v_pk_mul_f32 v[234:235], v[128:129], v[128:129]
    v_pk_mul_f32 v[236:237], v[128:129], v[128:129]
    v_pk_mul_f32 v[238:239], v[128:129], v[128:129]
    v_pk_mul_f32 v[240:241], v[128:129], v[128:129]
    v_pk_mul_f32 v[242:243], v[128:129], v[128:129]
    v_pk_mul_f32 v[244:245], v[128:129], v[128:129]
    v_pk_mul_f32 v[246:247], v[128:129], v[128:129]
    v_pk_mul_f32 v[248:249], v[128:129], v[128:129]
    v_pk_mul_f32 v[250:251], v[128:129], v[128:129]
    v_pk_mul_f32 v[252:253], v[128:129], v[128:129]
    v_pk_mul_f32 v[254:255], v[128:129], v[128:129]
    v_cvt_pk_bf16_f32 v64, v48, v49
    v_cvt_pk_bf16_f32 v65, v50, v51
    v_cvt_pk_bf16_f32 v66, v52, v53
    v_cvt_pk_bf16_f32 v67, v54, v55
    v_cvt_pk_bf16_f32 v72, v56, v57
    v_cvt_pk_bf16_f32 v73, v58, v59
    v_cvt_pk_bf16_f32 v74, v60, v61
    v_cvt_pk_bf16_f32 v75, v62, v63
    v_add_f32 v126, v126, v56
    v_add_f32 v126, v126, v57
    v_add_f32 v126, v126, v58
    v_add_f32 v126, v126, v59
    v_add_f32 v126, v126, v60
    v_add_f32 v126, v126, v61
    v_add_f32 v126, v126, v62
    v_add_f32 v126, v126, v63
    s_waitcnt lgkmcnt(4)
    s_cmp_lt_u32 s55, s67
    s_cbranch_scc1 AT_De
    s_cmp_eq_u32 s55, s65
    s_cbranch_scc1 AT_T
AT_mc:
    v_min_f32 v96, v96, v112
    v_mov_b32 v100, 0xf149f2ca
    v_min_f32 v108, v108, v112
    v_min_f32 v97, v97, v113
    v_mov_b32 v101, 0xf149f2ca
    v_min_f32 v109, v109, v113
    v_min_f32 v98, v98, v114
    v_mov_b32 v102, 0xf149f2ca
    v_min_f32 v110, v110, v114
    v_min_f32 v99, v99, v115
    v_mov_b32 v103, 0xf149f2ca
    v_min_f32 v111, v111, v115
    s_lshr_b32 s64, s55, 14
    s_sub_u32 s64, s64, 6
    s_bitcmp1_b64 s[56:57], s64
    s_cbranch_scc0 AT_Do
.p2align 3
AT_De:
    v_mfma_f32_16x16x32_bf16 v[16:19], a[0:3], a[64:67], v[80:83]
    v_exp_f32 v52, v28
    v_mfma_f32_16x16x32_bf16 v[16:19], a[4:7], a[68:71], v[16:19]
    ds_read_b128 a[48:51], v14 offset:12288
    v_cvt_pk_bf16_f32 v68, v8, v9
    v_mfma_f32_16x16x32_bf16 v[16:19], a[8:11], a[72:75], v[16:19]
    v_exp_f32 v53, v29
    v_mfma_f32_16x16x32_bf16 v[16:19], a[12:15], a[76:79], v[16:19]
    ds_read_b128 a[52:55], v14 offset:13312
    v_cvt_pk_bf16_f32 v69, v10, v11
    v_mfma_f32_16x16x32_bf16 v[20:23], a[16:19], a[64:67], v[84:87]
    v_exp_f32 v54, v30
    v_mfma_f32_16x16x32_bf16 v[20:23], a[20:23], a[68:71], v[20:23]
    ds_read_b128 a[56:59], v14 offset:14336
    v_mfma_f32_16x16x32_bf16 v[20:23], a[24:27], a[72:75], v[20:23]
    v_exp_f32 v55, v31
    v_mfma_f32_16x16x32_bf16 v[20:23], a[28:31], a[76:79], v[20:23]
    ds_read_b128 a[60:63], v14 offset:15360
    v_xor_b32 v14, s72, v12
    v_mfma_f32_16x16x32_bf16 v[32:35], a[0:3], a[96:99], v[96:99]
    v_exp_f32 v56, v40
    v_mfma_f32_16x16x32_bf16 v[32:35], a[4:7], a[100:103], v[32:35]
    v_cvt_pk_bf16_f32 v70, v52, v53
    v_cvt_pk_bf16_f32 v71, v54, v55
    v_mfma_f32_16x16x32_bf16 v[32:35], a[8:11], a[104:107], v[32:35]
    v_exp_f32 v57, v41
    v_mfma_f32_16x16x32_bf16 v[32:35], a[12:15], a[108:111], v[32:35]
    v_mfma_f32_16x16x32_bf16 v[36:39], a[16:19], a[96:99], v[100:103]
    v_exp_f32 v58, v42
    v_mfma_f32_16x16x32_bf16 v[36:39], a[20:23], a[100:103], v[36:39]
    v_mfma_f32_16x16x32_bf16 v[36:39], a[24:27], a[104:107], v[36:39]
    v_exp_f32 v59, v43
    v_mfma_f32_16x16x32_bf16 v[36:39], a[28:31], a[108:111], v[36:39]
    v_add_f32 v127, v127, v56
    v_add_f32 v127, v127, v57
    v_mfma_f32_16x16x32_bf16 v[24:27], a[0:3], a[80:83], v[88:91]
    v_exp_f32 v60, v44
    v_mfma_f32_16x16x32_bf16 v[24:27], a[4:7], a[84:87], v[24:27]
    v_add_f32 v127, v127, v58
    v_add_f32 v127, v127, v59
    v_mfma_f32_16x16x32_bf16 v[24:27], a[8:11], a[88:91], v[24:27]
    v_exp_f32 v61, v45
    v_mfma_f32_16x16x32_bf16 v[24:27], a[12:15], a[92:95], v[24:27]
    v_cvt_pk_bf16_f32 v76, v56, v57
    v_cvt_pk_bf16_f32 v77, v58, v59
    v_mfma_f32_16x16x32_bf16 v[28:31], a[16:19], a[80:83], v[92:95]
    v_exp_f32 v62, v46
    v_mfma_f32_16x16x32_bf16 v[28:31], a[20:23], a[84:87], v[28:31]
    v_mfma_f32_16x16x32_bf16 v[28:31], a[24:27], a[88:91], v[28:31]
    v_exp_f32 v63, v47
    v_mfma_f32_16x16x32_bf16 v[28:31], a[28:31], a[92:95], v[28:31]
    v_cvt_pk_bf16_f32 v78, v60, v61
    v_cvt_pk_bf16_f32 v79, v62, v63
    v_mfma_f32_16x16x32_bf16 v[40:43], a[0:3], a[112:115], v[104:107]
    s_waitcnt vmcnt(8) lgkmcnt(0)
    s_barrier
    v_exp_f32 v48, v16
    v_mfma_f32_16x16x32_bf16 v[40:43], a[4:7], a[116:119], v[40:43]
    s_add_u32 s55, s55, 16384
    ds_read_b128 a[0:3], v14 offset:0
    v_add_f32 v127, v127, v60
    v_mfma_f32_16x16x32_bf16 v[40:43], a[8:11], a[120:123], v[40:43]
    s_and_b32 s72, s55, 0x1ffff
    v_exp_f32 v49, v17
    v_mfma_f32_16x16x32_bf16 v[40:43], a[12:15], a[124:127], v[40:43]
    s_cmp_lt_u32 s55, s10
    ds_read_b128 a[4:7], v14 offset:1024
    v_add_f32 v127, v127, v61
    v_mfma_f32_16x16x32_bf16 v[44:47], a[16:19], a[112:115], v[108:111]
    s_cselect_b32 m0, s72, s73
    v_exp_f32 v50, v18
    v_mfma_f32_16x16x32_bf16 v[44:47], a[20:23], a[116:119], v[44:47]
    ds_read_b128 a[8:11], v14 offset:2048
    v_add_f32 v127, v127, v62
    v_mfma_f32_16x16x32_bf16 v[44:47], a[24:27], a[120:123], v[44:47]
    s_cmp_lt_u32 s55, s67
    v_exp_f32 v51, v19
    v_mfma_f32_16x16x32_bf16 v[44:47], a[28:31], a[124:127], v[44:47]
    ds_read_b128 a[12:15], v14 offset:3072
    v_add_f32 v127, v127, v63
    v_mfma_f32_16x16x32_bf16 v[128:131], a[32:35], v[64:67], v[128:131]
    v_exp_f32 v52, v20
    v_mfma_f32_16x16x32_bf16 v[132:135], a[36:39], v[64:67], v[132:135]
    ds_read_b128 a[16:19], v14 offset:4096
    v_mfma_f32_16x16x32_bf16 v[136:139], a[40:43], v[64:67], v[136:139]
    v_exp_f32 v53, v21
    v_mfma_f32_16x16x32_bf16 v[140:143], a[44:47], v[64:67], v[140:143]
    ds_read_b128 a[20:23], v14 offset:5120
    v_mfma_f32_16x16x32_bf16 v[144:147], a[48:51], v[64:67], v[144:147]
    v_exp_f32 v54, v22
    v_mfma_f32_16x16x32_bf16 v[148:151], a[52:55], v[64:67], v[148:151]
    ds_read_b128 a[24:27], v14 offset:6144
    v_mfma_f32_16x16x32_bf16 v[152:155], a[56:59], v[64:67], v[152:155]
    v_exp_f32 v55, v23
    v_mfma_f32_16x16x32_bf16 v[156:159], a[60:63], v[64:67], v[156:159]
    ds_read_b128 a[28:31], v14 offset:7168
    v_mfma_f32_16x16x32_bf16 a[132:135], a[128:131], v[64:67], a[132:135]
    buffer_load_dwordx4 v2, s[8:11], s55 offen offset:0 sc1 lds
    v_mfma_f32_16x16x32_bf16 v[192:195], a[32:35], v[72:75], v[192:195]
    v_exp_f32 v56, v32
    v_mfma_f32_16x16x32_bf16 v[196:199], a[36:39], v[72:75], v[196:199]
    v_cvt_pk_bf16_f32 v64, v48, v49
    v_cvt_pk_bf16_f32 v65, v50, v51
    v_mfma_f32_16x16x32_bf16 v[200:203], a[40:43], v[72:75], v[200:203]
    v_exp_f32 v57, v33
    v_mfma_f32_16x16x32_bf16 v[204:207], a[44:47], v[72:75], v[204:207]
    buffer_load_dwordx4 v2, s[8:11], s55 offen offset:1024 sc1 lds
    v_cvt_pk_bf16_f32 v66, v52, v53
    v_mfma_f32_16x16x32_bf16 v[208:211], a[48:51], v[72:75], v[208:211]
    v_exp_f32 v58, v34
    v_mfma_f32_16x16x32_bf16 v[212:215], a[52:55], v[72:75], v[212:215]
    v_cvt_pk_bf16_f32 v67, v54, v55
    v_mfma_f32_16x16x32_bf16 v[216:219], a[56:59], v[72:75], v[216:219]
    v_exp_f32 v59, v35
    v_mfma_f32_16x16x32_bf16 v[220:223], a[60:63], v[72:75], v[220:223]
    v_add_f32 v126, v126, v56
    v_add_f32 v126, v126, v57
    v_mfma_f32_16x16x32_bf16 v[160:163], a[32:35], v[68:71], v[160:163]
    v_exp_f32 v60, v36
    v_mfma_f32_16x16x32_bf16 v[164:167], a[36:39], v[68:71], v[164:167]
    v_add_f32 v126, v126, v58
    v_add_f32 v126, v126, v59
    v_mfma_f32_16x16x32_bf16 v[168:171], a[40:43], v[68:71], v[168:171]
    v_exp_f32 v61, v37
    v_mfma_f32_16x16x32_bf16 v[172:175], a[44:47], v[68:71], v[172:175]
    buffer_load_dwordx4 v2, s[8:11], s55 offen offset:2048 sc1 lds
    v_cvt_pk_bf16_f32 v72, v56, v57
    v_mfma_f32_16x16x32_bf16 v[176:179], a[48:51], v[68:71], v[176:179]
    v_exp_f32 v62, v38
    v_mfma_f32_16x16x32_bf16 v[180:183], a[52:55], v[68:71], v[180:183]
    v_cvt_pk_bf16_f32 v73, v58, v59
    v_mfma_f32_16x16x32_bf16 v[184:187], a[56:59], v[68:71], v[184:187]
    v_exp_f32 v63, v39
    v_mfma_f32_16x16x32_bf16 v[188:191], a[60:63], v[68:71], v[188:191]
    v_cvt_pk_bf16_f32 v74, v60, v61
    v_cvt_pk_bf16_f32 v75, v62, v63
    v_add_f32 v126, v126, v63
    v_mfma_f32_16x16x32_bf16 a[136:139], a[128:131], v[68:71], a[136:139]
    buffer_load_dwordx4 v2, s[8:11], s55 offen offset:3072 sc1 lds
    v_mfma_f32_16x16x32_bf16 v[224:227], a[32:35], v[76:79], v[224:227]
    s_waitcnt lgkmcnt(0)
    v_exp_f32 v8, v24
    v_mfma_f32_16x16x32_bf16 v[228:231], a[36:39], v[76:79], v[228:231]
    ds_read_b128 a[32:35], v14 offset:8192
    v_add_f32 v126, v126, v60
    v_mfma_f32_16x16x32_bf16 v[232:235], a[40:43], v[76:79], v[232:235]
    v_exp_f32 v9, v25
    v_mfma_f32_16x16x32_bf16 v[236:239], a[44:47], v[76:79], v[236:239]
    ds_read_b128 a[36:39], v14 offset:9216
    v_add_f32 v126, v126, v61
    v_mfma_f32_16x16x32_bf16 v[240:243], a[48:51], v[76:79], v[240:243]
    v_exp_f32 v10, v26
    v_mfma_f32_16x16x32_bf16 v[244:247], a[52:55], v[76:79], v[244:247]
    ds_read_b128 a[40:43], v14 offset:10240
    v_add_f32 v126, v126, v62
    v_mfma_f32_16x16x32_bf16 v[248:251], a[56:59], v[76:79], v[248:251]
    v_exp_f32 v11, v27
    v_mfma_f32_16x16x32_bf16 v[252:255], a[60:63], v[76:79], v[252:255]
    ds_read_b128 a[44:47], v14 offset:11264
    s_cbranch_scc0 AT_Dx
AT_Do:
    v_mfma_f32_16x16x32_bf16 v[16:19], a[0:3], a[64:67], v[80:83]
    v_exp_f32 v52, v28
    v_mfma_f32_16x16x32_bf16 v[16:19], a[4:7], a[68:71], v[16:19]
    ds_read_b128 a[48:51], v14 offset:12288
    v_cvt_pk_bf16_f32 v68, v8, v9
    v_mfma_f32_16x16x32_bf16 v[16:19], a[8:11], a[72:75], v[16:19]
    v_exp_f32 v53, v29
    v_mfma_f32_16x16x32_bf16 v[16:19], a[12:15], a[76:79], v[16:19]
    ds_read_b128 a[52:55], v14 offset:13312
    v_cvt_pk_bf16_f32 v69, v10, v11
    v_mfma_f32_16x16x32_bf16 v[20:23], a[16:19], a[64:67], v[84:87]
    v_exp_f32 v54, v30
    v_mfma_f32_16x16x32_bf16 v[20:23], a[20:23], a[68:71], v[20:23]
    ds_read_b128 a[56:59], v14 offset:14336
    v_mfma_f32_16x16x32_bf16 v[20:23], a[24:27], a[72:75], v[20:23]
    v_exp_f32 v55, v31
    v_mfma_f32_16x16x32_bf16 v[20:23], a[28:31], a[76:79], v[20:23]
    ds_read_b128 a[60:63], v14 offset:15360
    v_xor_b32 v14, s72, v12
    v_mfma_f32_16x16x32_bf16 v[32:35], a[0:3], a[96:99], v[96:99]
    v_exp_f32 v56, v40
    v_mfma_f32_16x16x32_bf16 v[32:35], a[4:7], a[100:103], v[32:35]
    v_cvt_pk_bf16_f32 v70, v52, v53
    v_cvt_pk_bf16_f32 v71, v54, v55
    v_mfma_f32_16x16x32_bf16 v[32:35], a[8:11], a[104:107], v[32:35]
    v_exp_f32 v57, v41
    v_mfma_f32_16x16x32_bf16 v[32:35], a[12:15], a[108:111], v[32:35]
    v_mfma_f32_16x16x32_bf16 v[36:39], a[16:19], a[96:99], v[100:103]
    v_exp_f32 v58, v42
    v_mfma_f32_16x16x32_bf16 v[36:39], a[20:23], a[100:103], v[36:39]
    v_mfma_f32_16x16x32_bf16 v[36:39], a[24:27], a[104:107], v[36:39]
    v_exp_f32 v59, v43
    v_mfma_f32_16x16x32_bf16 v[36:39], a[28:31], a[108:111], v[36:39]
    v_add_f32 v127, v127, v56
    v_add_f32 v127, v127, v57
    v_mfma_f32_16x16x32_bf16 v[24:27], a[0:3], a[80:83], v[88:91]
    v_exp_f32 v60, v44
    v_mfma_f32_16x16x32_bf16 v[24:27], a[4:7], a[84:87], v[24:27]
    v_add_f32 v127, v127, v58
    v_add_f32 v127, v127, v59
    v_mfma_f32_16x16x32_bf16 v[24:27], a[8:11], a[88:91], v[24:27]
    v_exp_f32 v61, v45
    v_mfma_f32_16x16x32_bf16 v[24:27], a[12:15], a[92:95], v[24:27]
    v_cvt_pk_bf16_f32 v76, v56, v57
    v_cvt_pk_bf16_f32 v77, v58, v59
    v_mfma_f32_16x16x32_bf16 v[28:31], a[16:19], a[80:83], v[92:95]
    v_exp_f32 v62, v46
    v_mfma_f32_16x16x32_bf16 v[28:31], a[20:23], a[84:87], v[28:31]
    v_mfma_f32_16x16x32_bf16 v[28:31], a[24:27], a[88:91], v[28:31]
    v_exp_f32 v63, v47
    v_mfma_f32_16x16x32_bf16 v[28:31], a[28:31], a[92:95], v[28:31]
    v_cvt_pk_bf16_f32 v78, v60, v61
    v_cvt_pk_bf16_f32 v79, v62, v63
    v_mfma_f32_16x16x32_bf16 v[40:43], a[0:3], a[112:115], v[104:107]
    s_waitcnt lgkmcnt(0)
    v_exp_f32 v48, v16
    v_mfma_f32_16x16x32_bf16 v[40:43], a[4:7], a[116:119], v[40:43]
    s_add_u32 s55, s55, 16384
    ds_read_b128 a[0:3], v14 offset:0
    v_add_f32 v127, v127, v60
    v_mfma_f32_16x16x32_bf16 v[40:43], a[8:11], a[120:123], v[40:43]
    s_and_b32 s72, s55, 0x1ffff
    v_exp_f32 v49, v17
    v_mfma_f32_16x16x32_bf16 v[40:43], a[12:15], a[124:127], v[40:43]
    s_cmp_lt_u32 s55, s10
    ds_read_b128 a[4:7], v14 offset:1024
    v_add_f32 v127, v127, v61
    v_mfma_f32_16x16x32_bf16 v[44:47], a[16:19], a[112:115], v[108:111]
    s_cselect_b32 m0, s72, s73
    v_exp_f32 v50, v18
    v_mfma_f32_16x16x32_bf16 v[44:47], a[20:23], a[116:119], v[44:47]
    ds_read_b128 a[8:11], v14 offset:2048
    v_add_f32 v127, v127, v62
    v_mfma_f32_16x16x32_bf16 v[44:47], a[24:27], a[120:123], v[44:47]
    s_cmp_lt_u32 s55, s67
    v_exp_f32 v51, v19
    v_mfma_f32_16x16x32_bf16 v[44:47], a[28:31], a[124:127], v[44:47]
    ds_read_b128 a[12:15], v14 offset:3072
    v_add_f32 v127, v127, v63
    v_mfma_f32_16x16x32_bf16 v[128:131], a[32:35], v[64:67], v[128:131]
    v_exp_f32 v52, v20
    v_mfma_f32_16x16x32_bf16 v[132:135], a[36:39], v[64:67], v[132:135]
    ds_read_b128 a[16:19], v14 offset:4096
    v_mfma_f32_16x16x32_bf16 v[136:139], a[40:43], v[64:67], v[136:139]
    v_exp_f32 v53, v21
    v_mfma_f32_16x16x32_bf16 v[140:143], a[44:47], v[64:67], v[140:143]
    ds_read_b128 a[20:23], v14 offset:5120
    v_mfma_f32_16x16x32_bf16 v[144:147], a[48:51], v[64:67], v[144:147]
    v_exp_f32 v54, v22
    v_mfma_f32_16x16x32_bf16 v[148:151], a[52:55], v[64:67], v[148:151]
    ds_read_b128 a[24:27], v14 offset:6144
    v_mfma_f32_16x16x32_bf16 v[152:155], a[56:59], v[64:67], v[152:155]
    v_exp_f32 v55, v23
    v_mfma_f32_16x16x32_bf16 v[156:159], a[60:63], v[64:67], v[156:159]
    ds_read_b128 a[28:31], v14 offset:7168
    v_mfma_f32_16x16x32_bf16 a[132:135], a[128:131], v[64:67], a[132:135]
    buffer_load_dwordx4 v2, s[8:11], s55 offen offset:0 sc1 lds
    v_mfma_f32_16x16x32_bf16 v[192:195], a[32:35], v[72:75], v[192:195]
    v_exp_f32 v56, v32
    v_mfma_f32_16x16x32_bf16 v[196:199], a[36:39], v[72:75], v[196:199]
    v_cvt_pk_bf16_f32 v64, v48, v49
    v_cvt_pk_bf16_f32 v65, v50, v51
    v_mfma_f32_16x16x32_bf16 v[200:203], a[40:43], v[72:75], v[200:203]
    v_exp_f32 v57, v33
    v_mfma_f32_16x16x32_bf16 v[204:207], a[44:47], v[72:75], v[204:207]
    buffer_load_dwordx4 v2, s[8:11], s55 offen offset:1024 sc1 lds
    v_cvt_pk_bf16_f32 v66, v52, v53
    v_mfma_f32_16x16x32_bf16 v[208:211], a[48:51], v[72:75], v[208:211]
    v_exp_f32 v58, v34
    v_mfma_f32_16x16x32_bf16 v[212:215], a[52:55], v[72:75], v[212:215]
    v_cvt_pk_bf16_f32 v67, v54, v55
    v_mfma_f32_16x16x32_bf16 v[216:219], a[56:59], v[72:75], v[216:219]
    v_exp_f32 v59, v35
    v_mfma_f32_16x16x32_bf16 v[220:223], a[60:63], v[72:75], v[220:223]
    v_add_f32 v126, v126, v56
    v_add_f32 v126, v126, v57
    v_mfma_f32_16x16x32_bf16 v[160:163], a[32:35], v[68:71], v[160:163]
    v_exp_f32 v60, v36
    v_mfma_f32_16x16x32_bf16 v[164:167], a[36:39], v[68:71], v[164:167]
    v_add_f32 v126, v126, v58
    v_add_f32 v126, v126, v59
    v_mfma_f32_16x16x32_bf16 v[168:171], a[40:43], v[68:71], v[168:171]
    v_exp_f32 v61, v37
    v_mfma_f32_16x16x32_bf16 v[172:175], a[44:47], v[68:71], v[172:175]
    buffer_load_dwordx4 v2, s[8:11], s55 offen offset:2048 sc1 lds
    v_cvt_pk_bf16_f32 v72, v56, v57
    v_mfma_f32_16x16x32_bf16 v[176:179], a[48:51], v[68:71], v[176:179]
    v_exp_f32 v62, v38
    v_mfma_f32_16x16x32_bf16 v[180:183], a[52:55], v[68:71], v[180:183]
    v_cvt_pk_bf16_f32 v73, v58, v59
    v_mfma_f32_16x16x32_bf16 v[184:187], a[56:59], v[68:71], v[184:187]
    v_exp_f32 v63, v39
    v_mfma_f32_16x16x32_bf16 v[188:191], a[60:63], v[68:71], v[188:191]
    v_cvt_pk_bf16_f32 v74, v60, v61
    v_cvt_pk_bf16_f32 v75, v62, v63
    v_add_f32 v126, v126, v63
    v_mfma_f32_16x16x32_bf16 a[136:139], a[128:131], v[68:71], a[136:139]
    buffer_load_dwordx4 v2, s[8:11], s55 offen offset:3072 sc1 lds
    v_mfma_f32_16x16x32_bf16 v[224:227], a[32:35], v[76:79], v[224:227]
    s_waitcnt lgkmcnt(0)
    v_exp_f32 v8, v24
    v_mfma_f32_16x16x32_bf16 v[228:231], a[36:39], v[76:79], v[228:231]
    ds_read_b128 a[32:35], v14 offset:8192
    v_add_f32 v126, v126, v60
    v_mfma_f32_16x16x32_bf16 v[232:235], a[40:43], v[76:79], v[232:235]
    v_exp_f32 v9, v25
    v_mfma_f32_16x16x32_bf16 v[236:239], a[44:47], v[76:79], v[236:239]
    ds_read_b128 a[36:39], v14 offset:9216
    v_add_f32 v126, v126, v61
    v_mfma_f32_16x16x32_bf16 v[240:243], a[48:51], v[76:79], v[240:243]
    v_exp_f32 v10, v26
    v_mfma_f32_16x16x32_bf16 v[244:247], a[52:55], v[76:79], v[244:247]
    ds_read_b128 a[40:43], v14 offset:10240
    v_add_f32 v126, v126, v62
    v_mfma_f32_16x16x32_bf16 v[248:251], a[56:59], v[76:79], v[248:251]
    v_exp_f32 v11, v27
    v_mfma_f32_16x16x32_bf16 v[252:255], a[60:63], v[76:79], v[252:255]
    ds_read_b128 a[44:47], v14 offset:11264
    s_cbranch_scc1 AT_De
AT_Dx:
    s_cmp_lg_u32 s55, s65
    s_cbranch_scc1 AT_mc
AT_T:
    s_waitcnt lgkmcnt(4)
    v_mfma_f32_16x16x32_bf16 v[16:19], a[0:3], a[64:67], v[80:83]
    v_exp_f32 v52, v28
    v_mfma_f32_16x16x32_bf16 v[16:19], a[4:7], a[68:71], v[16:19]
    ds_read_b128 a[48:51], v14 offset:12288
    v_cvt_pk_bf16_f32 v68, v8, v9
    v_mfma_f32_16x16x32_bf16 v[16:19], a[8:11], a[72:75], v[16:19]
    v_exp_f32 v53, v29
    v_mfma_f32_16x16x32_bf16 v[16:19], a[12:15], a[76:79], v[16:19]
    ds_read_b128 a[52:55], v14 offset:13312
    v_cvt_pk_bf16_f32 v69, v10, v11
    v_mfma_f32_16x16x32_bf16 v[20:23], a[16:19], a[64:67], v[84:87]
    v_exp_f32 v54, v30
    v_mfma_f32_16x16x32_bf16 v[20:23], a[20:23], a[68:71], v[20:23]
    ds_read_b128 a[56:59], v14 offset:14336
    v_mfma_f32_16x16x32_bf16 v[20:23], a[24:27], a[72:75], v[20:23]
    v_exp_f32 v55, v31
    v_mfma_f32_16x16x32_bf16 v[20:23], a[28:31], a[76:79], v[20:23]
    ds_read_b128 a[60:63], v14 offset:15360
    v_xor_b32 v14, s72, v12
    v_mfma_f32_16x16x32_bf16 v[24:27], a[0:3], a[80:83], v[88:91]
    s_waitcnt lgkmcnt(4)
    s_lshr_b32 s64, s55, 14
    s_sub_u32 s64, s64, 6
    s_bitcmp1_b64 s[56:57], s64
    s_cbranch_scc0 AT_nb1
    s_waitcnt vmcnt(8)
    s_barrier
AT_nb1:
    v_exp_f32 v56, v40
    v_mfma_f32_16x16x32_bf16 v[24:27], a[4:7], a[84:87], v[24:27]
    s_add_u32 s55, s55, 16384
    ds_read_b128 a[0:3], v14 offset:0
    v_cvt_pk_bf16_f32 v70, v52, v53
    v_mfma_f32_16x16x32_bf16 v[24:27], a[8:11], a[88:91], v[24:27]
    s_and_b32 s72, s55, 0x1ffff
    v_exp_f32 v57, v41
    v_mfma_f32_16x16x32_bf16 v[24:27], a[12:15], a[92:95], v[24:27]
    s_cmp_lt_u32 s55, s10
    ds_read_b128 a[4:7], v14 offset:1024
    v_cvt_pk_bf16_f32 v71, v54, v55
    v_mfma_f32_16x16x32_bf16 v[28:31], a[16:19], a[80:83], v[92:95]
    s_cselect_b32 m0, s72, s73
    v_exp_f32 v58, v42
    v_mfma_f32_16x16x32_bf16 v[28:31], a[20:23], a[84:87], v[28:31]
    ds_read_b128 a[8:11], v14 offset:2048
    v_mfma_f32_16x16x32_bf16 v[28:31], a[24:27], a[88:91], v[28:31]
    v_exp_f32 v59, v43
    v_mfma_f32_16x16x32_bf16 v[28:31], a[28:31], a[92:95], v[28:31]
    s_waitcnt lgkmcnt(3)
    ds_read_b128 a[12:15], v14 offset:3072
    v_cvt_pk_bf16_f32 v76, v56, v57
    v_mfma_f32_16x16x32_bf16 v[128:131], a[32:35], v[64:67], v[128:131]
    s_lshr_b32 s32, s31, 1
    s_sub_u32 s33, 15, s30
    s_bitcmp1_b32 s31, 0
    v_exp_f32 v60, v44
    v_mfma_f32_16x16x32_bf16 v[132:135], a[36:39], v[64:67], v[132:135]
    s_cselect_b32 s33, s33, s30
    s_bitcmp1_b32 s30, 0
    s_cselect_b32 s44, 5, 1
    ds_read_b128 a[16:19], v14 offset:4096
    v_cvt_pk_bf16_f32 v77, v58, v59
    v_mfma_f32_16x16x32_bf16 v[136:139], a[40:43], v[64:67], v[136:139]
    s_cselect_b32 s40, 1, 5
    s_lshl_b32 s44, s44, 14
    s_lshl_b32 s40, s40, 14
    v_exp_f32 v61, v45
    v_mfma_f32_16x16x32_bf16 v[140:143], a[44:47], v[64:67], v[140:143]
    s_add_u32 s36, s44, s0
    s_add_u32 s43, s40, s0
    s_lshr_b32 s37, s28, 1
    ds_read_b128 a[20:23], v14 offset:5120
    v_mfma_f32_16x16x32_bf16 v[144:147], a[48:51], v[64:67], v[144:147]
    s_lshl_b32 s42, s37, 17
    s_lshl_b32 s37, s37, 13
    s_add_u32 s40, s40, s37
    v_exp_f32 v62, v46
    v_mfma_f32_16x16x32_bf16 v[148:151], a[52:55], v[64:67], v[148:151]
    s_and_b32 s41, s28, 1
    s_lshl_b32 s37, s41, 7
    s_add_u32 s42, s42, s37
    ds_read_b128 a[24:27], v14 offset:6144
    v_mfma_f32_16x16x32_bf16 v[152:155], a[56:59], v[64:67], v[152:155]
    s_lshl_b32 s37, s41, 12
    s_add_u32 s44, s44, s37
    s_add_u32 s37, s32, 0
    v_exp_f32 v63, v47
    v_mfma_f32_16x16x32_bf16 v[156:159], a[60:63], v[64:67], v[156:159]
    s_and_b32 s37, s37, 3
    s_lshl_b32 s37, s37, 11
    s_add_u32 s48, s37, s40
    ds_read_b128 a[28:31], v14 offset:7168
    v_cvt_pk_bf16_f32 v78, v60, v61
    v_mfma_f32_16x16x32_bf16 a[132:135], a[128:131], v[64:67], a[132:135]
    buffer_load_dwordx4 v2, s[8:11], s55 offen offset:0 sc1 lds
    v_mfma_f32_16x16x32_bf16 v[192:195], a[32:35], v[72:75], v[192:195]
    s_add_u32 s37, s32, 1
    s_and_b32 s37, s37, 3
    s_lshl_b32 s37, s37, 11
    v_exp_f32 v48, v16
    v_mfma_f32_16x16x32_bf16 v[196:199], a[36:39], v[72:75], v[196:199]
    s_add_u32 s49, s37, s40
    s_add_u32 s37, s32, 2
    s_and_b32 s37, s37, 3
    v_cvt_pk_bf16_f32 v79, v62, v63
    v_add_f32 v127, v127, v56
    v_mfma_f32_16x16x32_bf16 v[200:203], a[40:43], v[72:75], v[200:203]
    s_lshl_b32 s37, s37, 11
    s_add_u32 s50, s37, s40
    s_add_u32 s37, s32, 3
    v_exp_f32 v49, v17
    v_mfma_f32_16x16x32_bf16 v[204:207], a[44:47], v[72:75], v[204:207]
    s_and_b32 s37, s37, 3
    s_lshl_b32 s37, s37, 11
    s_add_u32 s54, s37, s40
    buffer_load_dwordx4 v2, s[8:11], s55 offen offset:1024 sc1 lds
    v_add_f32 v127, v127, v57
    v_mfma_f32_16x16x32_bf16 v[208:211], a[48:51], v[72:75], v[208:211]
    s_and_b32 s37, s29, 3
    s_lshl2_add_u32 s35, s32, s37
    s_lshl_b32 s35, s35, 18
    v_exp_f32 v50, v18
    v_mfma_f32_16x16x32_bf16 v[212:215], a[52:55], v[72:75], v[212:215]
    s_add_u32 s35, s35, 58720256
    s_lshl2_add_u32 s38, s33, s37
    s_mul_i32 s38, s38, 262144
    v_add_f32 v127, v127, v58
    v_add_f32 v127, v127, v59
    v_mfma_f32_16x16x32_bf16 v[216:219], a[56:59], v[72:75], v[216:219]
    s_add_u32 s38, s38, s0
    s_add_u32 s38, s38, 67108864
    s_lshl_b32 s37, s37, 8
    v_exp_f32 v51, v19
    v_mfma_f32_16x16x32_bf16 v[220:223], a[60:63], v[72:75], v[220:223]
    s_add_u32 s42, s42, s37
    s_lshl_b32 s37, s32, 16
    s_add_u32 s39, s38, s37
    v_add_f32 v127, v127, v60
    v_add_f32 v127, v127, v61
    v_mfma_f32_16x16x32_bf16 v[160:163], a[32:35], v[68:71], v[160:163]
    s_lshl_b32 s37, s32, 15
    s_add_u32 s42, s42, s37
    s_mul_i32 s34, s33, 1048576
    v_exp_f32 v52, v20
    v_mfma_f32_16x16x32_bf16 v[164:167], a[36:39], v[68:71], v[164:167]
    s_add_u32 s34, s34, s37
    s_add_u32 s34, s34, 39845888
    s_lshl_b32 s37, s33, 18
    v_add_f32 v127, v127, v62
    v_add_f32 v127, v127, v63
    v_mfma_f32_16x16x32_bf16 v[168:171], a[40:43], v[68:71], v[168:171]
    s_add_u32 s42, s42, s37
    s_add_u32 s42, s42, 1024
    s_lshl_b32 s53, s28, 1
    v_exp_f32 v53, v21
    v_mfma_f32_16x16x32_bf16 v[172:175], a[44:47], v[68:71], v[172:175]
    s_add_u32 s77, s53, 1
    s_sub_u32 s37, 7, s28
    s_bitcmp1_b32 s31, 0
    buffer_load_dwordx4 v2, s[8:11], s55 offen offset:2048 sc1 lds
    v_cvt_pk_bf16_f32 v64, v48, v49
    v_mfma_f32_16x16x32_bf16 v[176:179], a[48:51], v[68:71], v[176:179]
    s_cselect_b32 s53, s28, s53
    s_cselect_b32 s77, s37, s77
    s_sub_u32 s37, s43, s0
    v_exp_f32 v54, v22
    v_mfma_f32_16x16x32_bf16 v[180:183], a[52:55], v[68:71], v[180:183]
    s_lshl_b32 s53, s53, 11
    s_lshl_b32 s77, s77, 11
    s_add_u32 s53, s53, s37
    v_cvt_pk_bf16_f32 v65, v50, v51
    v_mfma_f32_16x16x32_bf16 v[184:187], a[56:59], v[68:71], v[184:187]
    s_add_u32 s77, s77, s37
    s_and_b32 s51, s29, 7
    s_lshl_b32 s52, s51, 15
    v_exp_f32 v55, v23
    v_mfma_f32_16x16x32_bf16 v[188:191], a[60:63], v[68:71], v[188:191]
    s_lshl_b32 s51, s51, 12
    s_mul_i32 s1, s28, 262144
    s_lshl_b32 s37, s28, 14
    v_cvt_pk_bf16_f32 v66, v52, v53
    v_cvt_pk_bf16_f32 v67, v54, v55
    v_mfma_f32_16x16x32_bf16 a[136:139], a[128:131], v[68:71], a[136:139]
    buffer_load_dwordx4 v2, s[8:11], s55 offen offset:3072 sc1 lds
    v_mfma_f32_16x16x32_bf16 v[224:227], a[32:35], v[76:79], v[224:227]
    s_lshl_b32 s46, s30, 16
    s_add_u32 s46, s46, s37
    s_add_u32 s46, s46, 62914560
    v_exp_f32 v8, v24
    v_mfma_f32_16x16x32_bf16 v[228:231], a[36:39], v[76:79], v[228:231]
    s_lshl_b32 s45, s29, 16
    s_add_u32 s45, s45, s0
    s_add_u32 s45, s45, 63963136
    ds_read_b128 a[32:35], v14 offset:8192
    v_mfma_f32_16x16x32_bf16 v[232:235], a[40:43], v[76:79], v[232:235]
    s_lshl_b32 s47, s29, 17
    s_lshl_b32 s37, s28, 15
    s_add_u32 s47, s47, s37
    v_exp_f32 v9, v25
    v_mfma_f32_16x16x32_bf16 v[236:239], a[44:47], v[76:79], v[236:239]
    s_lshl_b32 s37, s30, 7
    s_add_u32 s47, s47, s37
    s_mov_b32 s4, s74
    ds_read_b128 a[36:39], v14 offset:9216
    v_mfma_f32_16x16x32_bf16 v[240:243], a[48:51], v[76:79], v[240:243]
    s_mov_b32 s5, s75
    s_mov_b32 s6, 4194304
    s_mov_b32 s7, 0x20000
    v_exp_f32 v10, v26
    v_mfma_f32_16x16x32_bf16 v[244:247], a[52:55], v[76:79], v[244:247]
    ds_read_b128 a[40:43], v14 offset:10240
    v_mfma_f32_16x16x32_bf16 v[248:251], a[56:59], v[76:79], v[248:251]
    v_exp_f32 v11, v27
    v_mfma_f32_16x16x32_bf16 v[252:255], a[60:63], v[76:79], v[252:255]
    ds_read_b128 a[44:47], v14 offset:11264
AT_Sx:
    s_cmp_lg_u32 s55, s76
    s_cbranch_scc1 AT_Sy
    v_mov_b32 v118, v126
    v_mov_b32 v119, v127
    s_nop 1
    v_permlane32_swap_b32 v126, v118
    v_permlane32_swap_b32 v127, v119
    v_add_f32 v126, v126, v118
    v_add_f32 v127, v127, v119
    v_mov_b32 v118, v126
    v_mov_b32 v119, v127
    s_nop 1
    v_permlane16_swap_b32 v126, v118
    v_permlane16_swap_b32 v127, v119
    v_add_f32 v126, v126, v118
    v_add_f32 v127, v127, v119
    v_cmp_nle_f32 vcc, v126, v15
    v_rcp_f32 v116, v126
    s_or_b64 s[60:61], s[60:61], vcc
    v_cmp_nle_f32 vcc, v127, v15
    v_rcp_f32 v118, v127
    s_or_b64 s[60:61], s[60:61], vcc
    v_pk_mul_f32 v[192:193], v[192:193], v[116:117] op_sel_hi:[1,0]
    v_pk_mul_f32 v[194:195], v[194:195], v[116:117] op_sel_hi:[1,0]
    v_pk_mul_f32 v[196:197], v[196:197], v[116:117] op_sel_hi:[1,0]
    v_pk_mul_f32 v[198:199], v[198:199], v[116:117] op_sel_hi:[1,0]
    v_cvt_pk_bf16_f32 v192, v192, v193
    v_cvt_pk_bf16_f32 v193, v194, v195
    v_cvt_pk_bf16_f32 v194, v196, v197
    v_cvt_pk_bf16_f32 v195, v198, v199
    buffer_store_dwordx4 v[192:195], v2, s[20:23], s71 offen offset:0 sc1
    v_pk_mul_f32 v[200:201], v[200:201], v[116:117] op_sel_hi:[1,0]
    v_pk_mul_f32 v[202:203], v[202:203], v[116:117] op_sel_hi:[1,0]
    v_pk_mul_f32 v[204:205], v[204:205], v[116:117] op_sel_hi:[1,0]
    v_pk_mul_f32 v[206:207], v[206:207], v[116:117] op_sel_hi:[1,0]
    v_cvt_pk_bf16_f32 v200, v200, v201
    v_cvt_pk_bf16_f32 v201, v202, v203
    v_cvt_pk_bf16_f32 v202, v204, v205
    v_cvt_pk_bf16_f32 v203, v206, v207
    buffer_store_dwordx4 v[200:203], v2, s[20:23], s71 offen offset:1024 sc1
    v_pk_mul_f32 v[208:209], v[208:209], v[116:117] op_sel_hi:[1,0]
    v_pk_mul_f32 v[210:211], v[210:211], v[116:117] op_sel_hi:[1,0]
    v_pk_mul_f32 v[212:213], v[212:213], v[116:117] op_sel_hi:[1,0]
    v_pk_mul_f32 v[214:215], v[214:215], v[116:117] op_sel_hi:[1,0]
    v_cvt_pk_bf16_f32 v208, v208, v209
    v_cvt_pk_bf16_f32 v209, v210, v211
    v_cvt_pk_bf16_f32 v210, v212, v213
    v_cvt_pk_bf16_f32 v211, v214, v215
    buffer_store_dwordx4 v[208:211], v2, s[20:23], s71 offen offset:2048 sc1
    v_pk_mul_f32 v[216:217], v[216:217], v[116:117] op_sel_hi:[1,0]
    v_pk_mul_f32 v[218:219], v[218:219], v[116:117] op_sel_hi:[1,0]
    v_pk_mul_f32 v[220:221], v[220:221], v[116:117] op_sel_hi:[1,0]
    v_pk_mul_f32 v[222:223], v[222:223], v[116:117] op_sel_hi:[1,0]
    v_cvt_pk_bf16_f32 v216, v216, v217
    v_cvt_pk_bf16_f32 v217, v218, v219
    v_cvt_pk_bf16_f32 v218, v220, v221
    v_cvt_pk_bf16_f32 v219, v222, v223
    buffer_store_dwordx4 v[216:219], v2, s[20:23], s71 offen offset:3072 sc1
    s_add_u32 s62, s71, 131072
    v_pk_mul_f32 v[224:225], v[224:225], v[118:119] op_sel_hi:[1,0]
    v_pk_mul_f32 v[226:227], v[226:227], v[118:119] op_sel_hi:[1,0]
    v_pk_mul_f32 v[228:229], v[228:229], v[118:119] op_sel_hi:[1,0]
    v_pk_mul_f32 v[230:231], v[230:231], v[118:119] op_sel_hi:[1,0]
    v_cvt_pk_bf16_f32 v224, v224, v225
    v_cvt_pk_bf16_f32 v225, v226, v227
    v_cvt_pk_bf16_f32 v226, v228, v229
    v_cvt_pk_bf16_f32 v227, v230, v231
    buffer_store_dwordx4 v[224:227], v2, s[20:23], s62 offen offset:0 sc1
    v_pk_mul_f32 v[232:233], v[232:233], v[118:119] op_sel_hi:[1,0]
    v_pk_mul_f32 v[234:235], v[234:235], v[118:119] op_sel_hi:[1,0]
    v_pk_mul_f32 v[236:237], v[236:237], v[118:119] op_sel_hi:[1,0]
    v_pk_mul_f32 v[238:239], v[238:239], v[118:119] op_sel_hi:[1,0]
    v_cvt_pk_bf16_f32 v232, v232, v233
    v_cvt_pk_bf16_f32 v233, v234, v235
    v_cvt_pk_bf16_f32 v234, v236, v237
    v_cvt_pk_bf16_f32 v235, v238, v239
    buffer_store_dwordx4 v[232:235], v2, s[20:23], s62 offen offset:1024 sc1
    v_pk_mul_f32 v[240:241], v[240:241], v[118:119] op_sel_hi:[1,0]
    v_pk_mul_f32 v[242:243], v[242:243], v[118:119] op_sel_hi:[1,0]
    v_pk_mul_f32 v[244:245], v[244:245], v[118:119] op_sel_hi:[1,0]
    v_pk_mul_f32 v[246:247], v[246:247], v[118:119] op_sel_hi:[1,0]
    v_cvt_pk_bf16_f32 v240, v240, v241
    v_cvt_pk_bf16_f32 v241, v242, v243
    v_cvt_pk_bf16_f32 v242, v244, v245
    v_cvt_pk_bf16_f32 v243, v246, v247
    buffer_store_dwordx4 v[240:243], v2, s[20:23], s62 offen offset:2048 sc1
    v_pk_mul_f32 v[248:249], v[248:249], v[118:119] op_sel_hi:[1,0]
    v_pk_mul_f32 v[250:251], v[250:251], v[118:119] op_sel_hi:[1,0]
    v_pk_mul_f32 v[252:253], v[252:253], v[118:119] op_sel_hi:[1,0]
    v_pk_mul_f32 v[254:255], v[254:255], v[118:119] op_sel_hi:[1,0]
    v_cvt_pk_bf16_f32 v248, v248, v249
    v_cvt_pk_bf16_f32 v249, v250, v251
    v_cvt_pk_bf16_f32 v250, v252, v253
    v_cvt_pk_bf16_f32 v251, v254, v255
    buffer_store_dwordx4 v[248:251], v2, s[20:23], s62 offen offset:3072 sc1
    s_mov_b32 s69, s68
AT_Sy:
    s_cmp_eq_u32 s55, s66
    s_cbranch_scc1 AT_F
    s_cmp_lg_u32 s55, s68
    s_cbranch_scc1 AT_mp
    s_bitcmp1_b32 s28, 0
    s_cbranch_scc1 AT_kao
    v_min_f32 v80, v80, v112
    v_min_f32 v81, v81, v113
    v_min_f32 v82, v82, v114
    v_min_f32 v83, v83, v115
    v_mov_b32 v84, 0xf149f2ca
    v_mov_b32 v85, 0xf149f2ca
    v_mov_b32 v86, 0xf149f2ca
    v_mov_b32 v87, 0xf149f2ca
AT_kao:
    v_min_f32 v84, v84, v112
    v_min_f32 v85, v85, v113
    v_min_f32 v86, v86, v114
    v_min_f32 v87, v87, v115
    s_lshl_b32 s100, s2, 9
    s_add_u32 s100, s100, 57671744
    v_and_b32 v97, 7, v1
    v_lshl_add_u32 v97, v97, 2, s100
    buffer_load_dword v96, v97, s[20:23], 0 offen sc1
    s_lshl_b32 s100, s2, 9
    s_add_u32 s100, s100, 57671808
    v_and_b32 v99, 15, v1
    v_lshl_add_u32 v99, v99, 2, s100
    buffer_load_dword v98, v99, s[20:23], 0 offen sc1
    s_lshl_b32 s100, s2, 9
    s_add_u32 s100, s100, 57671792
    v_and_b32 v101, 3, v1
    v_lshl_add_u32 v101, v101, 2, s100
    buffer_load_dword v100, v101, s[20:23], 0 offen sc1
AT_mp:
    s_lshr_b32 s64, s55, 14
    s_sub_u32 s64, s64, 6
    s_bitcmp1_b64 s[56:57], s64
    s_cbranch_scc0 AT_So
.p2align 3
AT_Se:
    s_waitcnt lgkmcnt(4)
    v_mfma_f32_16x16x32_bf16 v[16:19], a[0:3], a[64:67], v[80:83]
    v_exp_f32 v52, v28
    v_mfma_f32_16x16x32_bf16 v[16:19], a[4:7], a[68:71], v[16:19]
    ds_read_b128 a[48:51], v14 offset:12288
    v_cvt_pk_bf16_f32 v68, v8, v9
    v_mfma_f32_16x16x32_bf16 v[16:19], a[8:11], a[72:75], v[16:19]
    v_exp_f32 v53, v29
    v_mfma_f32_16x16x32_bf16 v[16:19], a[12:15], a[76:79], v[16:19]
    ds_read_b128 a[52:55], v14 offset:13312
    v_cvt_pk_bf16_f32 v69, v10, v11
    v_mfma_f32_16x16x32_bf16 v[20:23], a[16:19], a[64:67], v[84:87]
    v_exp_f32 v54, v30
    v_mfma_f32_16x16x32_bf16 v[20:23], a[20:23], a[68:71], v[20:23]
    ds_read_b128 a[56:59], v14 offset:14336
    v_cvt_pk_bf16_f32 v70, v52, v53
    v_mfma_f32_16x16x32_bf16 v[20:23], a[24:27], a[72:75], v[20:23]
    v_exp_f32 v55, v31
    v_mfma_f32_16x16x32_bf16 v[20:23], a[28:31], a[76:79], v[20:23]
    ds_read_b128 a[60:63], v14 offset:15360
    v_xor_b32 v14, s72, v12
    v_mfma_f32_16x16x32_bf16 v[24:27], a[0:3], a[80:83], v[88:91]
    s_waitcnt vmcnt(8) lgkmcnt(4)
    s_barrier
    v_exp_f32 v56, v16
    v_mfma_f32_16x16x32_bf16 v[24:27], a[4:7], a[84:87], v[24:27]
    s_add_u32 s55, s55, 16384
    ds_read_b128 a[0:3], v14 offset:0
    v_cvt_pk_bf16_f32 v71, v54, v55
    v_mfma_f32_16x16x32_bf16 v[24:27], a[8:11], a[88:91], v[24:27]
    s_and_b32 s72, s55, 0x1ffff
    v_exp_f32 v57, v17
    v_mfma_f32_16x16x32_bf16 v[24:27], a[12:15], a[92:95], v[24:27]
    s_cmp_lt_u32 s55, s10
    ds_read_b128 a[4:7], v14 offset:1024
    v_mfma_f32_16x16x32_bf16 v[28:31], a[16:19], a[80:83], v[92:95]
    s_cselect_b32 m0, s72, s73
    v_exp_f32 v58, v18
    v_mfma_f32_16x16x32_bf16 v[28:31], a[20:23], a[84:87], v[28:31]
    ds_read_b128 a[8:11], v14 offset:2048
    v_mfma_f32_16x16x32_bf16 v[28:31], a[24:27], a[88:91], v[28:31]
    s_cmp_lt_u32 s55, s69
    v_exp_f32 v59, v19
    v_mfma_f32_16x16x32_bf16 v[28:31], a[28:31], a[92:95], v[28:31]
    s_waitcnt lgkmcnt(3)
    ds_read_b128 a[12:15], v14 offset:3072
    buffer_load_dwordx4 v2, s[8:11], s55 offen offset:0 sc1 lds
    v_mfma_f32_16x16x32_bf16 v[128:131], a[32:35], v[64:67], v[128:131]
    v_exp_f32 v60, v20
    v_mfma_f32_16x16x32_bf16 v[132:135], a[36:39], v[64:67], v[132:135]
    ds_read_b128 a[16:19], v14 offset:4096
    v_mfma_f32_16x16x32_bf16 v[136:139], a[40:43], v[64:67], v[136:139]
    v_exp_f32 v61, v21
    v_mfma_f32_16x16x32_bf16 v[140:143], a[44:47], v[64:67], v[140:143]
    ds_read_b128 a[20:23], v14 offset:5120
    buffer_load_dwordx4 v2, s[8:11], s55 offen offset:1024 sc1 lds
    v_mfma_f32_16x16x32_bf16 v[144:147], a[48:51], v[64:67], v[144:147]
    v_exp_f32 v62, v22
    v_mfma_f32_16x16x32_bf16 v[148:151], a[52:55], v[64:67], v[148:151]
    ds_read_b128 a[24:27], v14 offset:6144
    v_mfma_f32_16x16x32_bf16 v[152:155], a[56:59], v[64:67], v[152:155]
    v_exp_f32 v63, v23
    v_mfma_f32_16x16x32_bf16 v[156:159], a[60:63], v[64:67], v[156:159]
    ds_read_b128 a[28:31], v14 offset:7168
    v_mfma_f32_16x16x32_bf16 a[132:135], a[128:131], v[64:67], a[132:135]
    buffer_load_dwordx4 v2, s[8:11], s55 offen offset:2048 sc1 lds
    v_mfma_f32_16x16x32_bf16 v[160:163], a[32:35], v[68:71], v[160:163]
    v_exp_f32 v8, v24
    v_mfma_f32_16x16x32_bf16 v[164:167], a[36:39], v[68:71], v[164:167]
    ds_read_b128 a[32:35], v14 offset:8192
    v_cvt_pk_bf16_f32 v64, v56, v57
    v_cvt_pk_bf16_f32 v67, v62, v63
    v_mfma_f32_16x16x32_bf16 v[168:171], a[40:43], v[68:71], v[168:171]
    v_exp_f32 v9, v25
    v_mfma_f32_16x16x32_bf16 v[172:175], a[44:47], v[68:71], v[172:175]
    ds_read_b128 a[36:39], v14 offset:9216
    buffer_load_dwordx4 v2, s[8:11], s55 offen offset:3072 sc1 lds
    v_mfma_f32_16x16x32_bf16 v[176:179], a[48:51], v[68:71], v[176:179]
    v_exp_f32 v10, v26
    v_mfma_f32_16x16x32_bf16 v[180:183], a[52:55], v[68:71], v[180:183]
    ds_read_b128 a[40:43], v14 offset:10240
    v_cvt_pk_bf16_f32 v65, v58, v59
    v_mfma_f32_16x16x32_bf16 v[184:187], a[56:59], v[68:71], v[184:187]
    v_exp_f32 v11, v27
    v_mfma_f32_16x16x32_bf16 v[188:191], a[60:63], v[68:71], v[188:191]
    ds_read_b128 a[44:47], v14 offset:11264
    v_cvt_pk_bf16_f32 v66, v60, v61
    v_mfma_f32_16x16x32_bf16 a[136:139], a[128:131], v[68:71], a[136:139]
    s_cbranch_scc0 AT_Sx
AT_So:
    s_waitcnt lgkmcnt(4)
    v_mfma_f32_16x16x32_bf16 v[16:19], a[0:3], a[64:67], v[80:83]
    v_exp_f32 v52, v28
    v_mfma_f32_16x16x32_bf16 v[16:19], a[4:7], a[68:71], v[16:19]
    ds_read_b128 a[48:51], v14 offset:12288
    v_cvt_pk_bf16_f32 v68, v8, v9
    v_mfma_f32_16x16x32_bf16 v[16:19], a[8:11], a[72:75], v[16:19]
    v_exp_f32 v53, v29
    v_mfma_f32_16x16x32_bf16 v[16:19], a[12:15], a[76:79], v[16:19]
    ds_read_b128 a[52:55], v14 offset:13312
    v_cvt_pk_bf16_f32 v69, v10, v11
    v_mfma_f32_16x16x32_bf16 v[20:23], a[16:19], a[64:67], v[84:87]
    v_exp_f32 v54, v30
    v_mfma_f32_16x16x32_bf16 v[20:23], a[20:23], a[68:71], v[20:23]
    ds_read_b128 a[56:59], v14 offset:14336
    v_cvt_pk_bf16_f32 v70, v52, v53
    v_mfma_f32_16x16x32_bf16 v[20:23], a[24:27], a[72:75], v[20:23]
    v_exp_f32 v55, v31
    v_mfma_f32_16x16x32_bf16 v[20:23], a[28:31], a[76:79], v[20:23]
    ds_read_b128 a[60:63], v14 offset:15360
    v_xor_b32 v14, s72, v12
    v_mfma_f32_16x16x32_bf16 v[24:27], a[0:3], a[80:83], v[88:91]
    v_exp_f32 v56, v16
    v_mfma_f32_16x16x32_bf16 v[24:27], a[4:7], a[84:87], v[24:27]
    s_add_u32 s55, s55, 16384
    ds_read_b128 a[0:3], v14 offset:0
    v_cvt_pk_bf16_f32 v71, v54, v55
    v_mfma_f32_16x16x32_bf16 v[24:27], a[8:11], a[88:91], v[24:27]
    s_and_b32 s72, s55, 0x1ffff
    v_exp_f32 v57, v17
    v_mfma_f32_16x16x32_bf16 v[24:27], a[12:15], a[92:95], v[24:27]
    s_cmp_lt_u32 s55, s10
    ds_read_b128 a[4:7], v14 offset:1024
    v_mfma_f32_16x16x32_bf16 v[28:31], a[16:19], a[80:83], v[92:95]
    s_cselect_b32 m0, s72, s73
    v_exp_f32 v58, v18
    v_mfma_f32_16x16x32_bf16 v[28:31], a[20:23], a[84:87], v[28:31]
    ds_read_b128 a[8:11], v14 offset:2048
    v_mfma_f32_16x16x32_bf16 v[28:31], a[24:27], a[88:91], v[28:31]
    s_cmp_lt_u32 s55, s69
    v_exp_f32 v59, v19
    v_mfma_f32_16x16x32_bf16 v[28:31], a[28:31], a[92:95], v[28:31]
    s_waitcnt lgkmcnt(3)
    ds_read_b128 a[12:15], v14 offset:3072
    buffer_load_dwordx4 v2, s[8:11], s55 offen offset:0 sc1 lds
    v_mfma_f32_16x16x32_bf16 v[128:131], a[32:35], v[64:67], v[128:131]
    v_exp_f32 v60, v20
    v_mfma_f32_16x16x32_bf16 v[132:135], a[36:39], v[64:67], v[132:135]
    ds_read_b128 a[16:19], v14 offset:4096
    v_mfma_f32_16x16x32_bf16 v[136:139], a[40:43], v[64:67], v[136:139]
    v_exp_f32 v61, v21
    v_mfma_f32_16x16x32_bf16 v[140:143], a[44:47], v[64:67], v[140:143]
    ds_read_b128 a[20:23], v14 offset:5120
    buffer_load_dwordx4 v2, s[8:11], s55 offen offset:1024 sc1 lds
    v_mfma_f32_16x16x32_bf16 v[144:147], a[48:51], v[64:67], v[144:147]
    v_exp_f32 v62, v22
    v_mfma_f32_16x16x32_bf16 v[148:151], a[52:55], v[64:67], v[148:151]
    ds_read_b128 a[24:27], v14 offset:6144
    v_mfma_f32_16x16x32_bf16 v[152:155], a[56:59], v[64:67], v[152:155]
    v_exp_f32 v63, v23
    v_mfma_f32_16x16x32_bf16 v[156:159], a[60:63], v[64:67], v[156:159]
    ds_read_b128 a[28:31], v14 offset:7168
    v_mfma_f32_16x16x32_bf16 a[132:135], a[128:131], v[64:67], a[132:135]
    buffer_load_dwordx4 v2, s[8:11], s55 offen offset:2048 sc1 lds
    v_mfma_f32_16x16x32_bf16 v[160:163], a[32:35], v[68:71], v[160:163]
    v_exp_f32 v8, v24
    v_mfma_f32_16x16x32_bf16 v[164:167], a[36:39], v[68:71], v[164:167]
    ds_read_b128 a[32:35], v14 offset:8192
    v_cvt_pk_bf16_f32 v64, v56, v57
    v_cvt_pk_bf16_f32 v67, v62, v63
    v_mfma_f32_16x16x32_bf16 v[168:171], a[40:43], v[68:71], v[168:171]
    v_exp_f32 v9, v25
    v_mfma_f32_16x16x32_bf16 v[172:175], a[44:47], v[68:71], v[172:175]
    ds_read_b128 a[36:39], v14 offset:9216
    buffer_load_dwordx4 v2, s[8:11], s55 offen offset:3072 sc1 lds
    v_mfma_f32_16x16x32_bf16 v[176:179], a[48:51], v[68:71], v[176:179]
    v_exp_f32 v10, v26
    v_mfma_f32_16x16x32_bf16 v[180:183], a[52:55], v[68:71], v[180:183]
    ds_read_b128 a[40:43], v14 offset:10240
    v_cvt_pk_bf16_f32 v65, v58, v59
    v_mfma_f32_16x16x32_bf16 v[184:187], a[56:59], v[68:71], v[184:187]
    v_exp_f32 v11, v27
    v_mfma_f32_16x16x32_bf16 v[188:191], a[60:63], v[68:71], v[188:191]
    ds_read_b128 a[44:47], v14 offset:11264
    v_cvt_pk_bf16_f32 v66, v60, v61
    v_mfma_f32_16x16x32_bf16 a[136:139], a[128:131], v[68:71], a[136:139]
    s_cbranch_scc1 AT_Se
    s_branch AT_Sx
AT_F:
    s_waitcnt vmcnt(4)
    s_mov_b32 s37, 0x20000
PL7:
    v_cmp_ne_u32 vcc, s3, v96
    s_cbranch_vccz PL7x
    s_sub_u32 s37, s37, 1
    s_cbranch_scc1 PL7x
    s_sleep 4
    buffer_load_dword v96, v97, s[20:23], 0 offen sc1
    s_waitcnt vmcnt(0)
    s_branch PL7
PL7x:
    s_mov_b32 s37, 0x20000
PL8:
    v_cmp_ne_u32 vcc, s3, v98
    s_cbranch_vccz PL8x
    s_sub_u32 s37, s37, 1
    s_cbranch_scc1 PL8x
    s_sleep 4
    buffer_load_dword v98, v99, s[20:23], 0 offen sc1
    s_waitcnt vmcnt(0)
    s_branch PL8
PL8x:
    s_mov_b32 s37, 0x20000
PL9:
    v_cmp_ne_u32 vcc, s3, v100
    s_cbranch_vccz PL9x
    s_sub_u32 s37, s37, 1
    s_cbranch_scc1 PL9x
    s_sleep 4
    buffer_load_dword v100, v101, s[20:23], 0 offen sc1
    s_waitcnt vmcnt(0)
    s_branch PL9
PL9x:
    s_cmp_lt_u32 s28, 2
    s_cbranch_scc1 AT_u
    s_bitcmp1_b32 s28, 0
    s_cbranch_scc0 AT_kbo
    v_min_f32 v88, v88, v112
    v_min_f32 v89, v89, v113
    v_min_f32 v90, v90, v114
    v_min_f32 v91, v91, v115
    v_mov_b32 v92, 0xf149f2ca
    v_mov_b32 v93, 0xf149f2ca
    v_mov_b32 v94, 0xf149f2ca
    v_mov_b32 v95, 0xf149f2ca
AT_kbo:
    v_min_f32 v92, v92, v112
    v_min_f32 v93, v93, v113
    v_min_f32 v94, v94, v114
    v_min_f32 v95, v95, v115
AT_u:
    s_nop 0
    s_waitcnt lgkmcnt(4)
    v_mfma_f32_16x16x32_bf16 v[24:27], a[0:3], a[80:83], v[88:91]
    v_exp_f32 v52, v28
    v_mfma_f32_16x16x32_bf16 v[24:27], a[4:7], a[84:87], v[24:27]
    v_exp_f32 v53, v29
    v_mfma_f32_16x16x32_bf16 v[24:27], a[8:11], a[88:91], v[24:27]
    v_exp_f32 v54, v30
    v_mfma_f32_16x16x32_bf16 v[24:27], a[12:15], a[92:95], v[24:27]
    v_exp_f32 v55, v31
    v_mfma_f32_16x16x32_bf16 v[28:31], a[16:19], a[80:83], v[92:95]
    ds_read_b128 a[48:51], v14 offset:12288
    v_cvt_pk_bf16_f32 v68, v8, v9
    v_cvt_pk_bf16_f32 v69, v10, v11
    v_mfma_f32_16x16x32_bf16 v[28:31], a[20:23], a[84:87], v[28:31]
    ds_read_b128 a[52:55], v14 offset:13312
    v_cvt_pk_bf16_f32 v70, v52, v53
    v_mfma_f32_16x16x32_bf16 v[28:31], a[24:27], a[88:91], v[28:31]
    ds_read_b128 a[56:59], v14 offset:14336
    v_cvt_pk_bf16_f32 v71, v54, v55
    v_mfma_f32_16x16x32_bf16 v[28:31], a[28:31], a[92:95], v[28:31]
    s_waitcnt lgkmcnt(3)
    ds_read_b128 a[60:63], v14 offset:15360
    v_xor_b32 v14, s72, v12
    v_mfma_f32_16x16x32_bf16 v[128:131], a[32:35], v[64:67], v[128:131]
    s_waitcnt lgkmcnt(4)
    s_lshr_b32 s64, s55, 14
    s_sub_u32 s64, s64, 6
    s_bitcmp1_b64 s[56:57], s64
    s_cbranch_scc0 AT_nb2
    s_waitcnt vmcnt(8)
    s_barrier
AT_nb2:
    s_xor_b32 s41, s52, 0
    s_add_u32 s41, s41, s35
    s_add_u32 m0, s36, 0
    v_mfma_f32_16x16x32_bf16 v[132:135], a[36:39], v[64:67], v[132:135]
    s_add_u32 s55, s55, 16384
    ds_read_b128 a[0:3], v14 offset:0
    buffer_load_dwordx4 v13, s[20:23], s41 offen offset:0 sc1 lds
    v_mfma_f32_16x16x32_bf16 v[136:139], a[40:43], v[64:67], v[136:139]
    s_and_b32 s72, s55, 0x1ffff
    buffer_load_dwordx4 v13, s[20:23], s41 offen offset:1024 sc1 lds
    v_exp_f32 v8, v24
    v_mfma_f32_16x16x32_bf16 v[140:143], a[44:47], v[64:67], v[140:143]
    s_waitcnt lgkmcnt(1)
    ds_read_b128 a[4:7], v14 offset:1024
    buffer_load_dwordx4 v13, s[20:23], s41 offen offset:2048 sc1 lds
    v_mfma_f32_16x16x32_bf16 v[144:147], a[48:51], v[64:67], v[144:147]
    buffer_load_dwordx4 v13, s[20:23], s41 offen offset:3072 sc1 lds
    v_exp_f32 v9, v25
    s_xor_b32 s41, s52, 16384
    s_add_u32 s41, s41, s35
    s_add_u32 m0, s36, 16384
    v_mfma_f32_16x16x32_bf16 v[148:151], a[52:55], v[64:67], v[148:151]
    ds_read_b128 a[8:11], v14 offset:2048
    buffer_load_dwordx4 v13, s[20:23], s41 offen offset:0 sc1 lds
    v_mfma_f32_16x16x32_bf16 v[152:155], a[56:59], v[64:67], v[152:155]
    buffer_load_dwordx4 v13, s[20:23], s41 offen offset:1024 sc1 lds
    v_exp_f32 v10, v26
    v_mfma_f32_16x16x32_bf16 v[156:159], a[60:63], v[64:67], v[156:159]
    ds_read_b128 a[12:15], v14 offset:3072
    buffer_load_dwordx4 v13, s[20:23], s41 offen offset:2048 sc1 lds
    v_mfma_f32_16x16x32_bf16 a[132:135], a[128:131], v[64:67], a[132:135]
    ds_read_b128 a[16:19], v14 offset:4096
    buffer_load_dwordx4 v13, s[20:23], s41 offen offset:3072 sc1 lds
    s_xor_b32 s41, s52, 32768
    s_add_u32 s41, s41, s35
    s_add_u32 m0, s36, 32768
    v_mfma_f32_16x16x32_bf16 v[160:163], a[32:35], v[68:71], v[160:163]
    ds_read_b128 a[20:23], v14 offset:5120
    buffer_load_dwordx4 v13, s[20:23], s41 offen offset:0 sc1 lds
    v_mfma_f32_16x16x32_bf16 v[164:167], a[36:39], v[68:71], v[164:167]
    ds_read_b128 a[24:27], v14 offset:6144
    buffer_load_dwordx4 v13, s[20:23], s41 offen offset:1024 sc1 lds
    v_mfma_f32_16x16x32_bf16 v[168:171], a[40:43], v[68:71], v[168:171]
    ds_read_b128 a[28:31], v14 offset:7168
    buffer_load_dwordx4 v13, s[20:23], s41 offen offset:2048 sc1 lds
    v_mfma_f32_16x16x32_bf16 v[172:175], a[44:47], v[68:71], v[172:175]
    buffer_load_dwordx4 v13, s[20:23], s41 offen offset:3072 sc1 lds
    v_exp_f32 v11, v27
    s_xor_b32 s41, s52, 49152
    s_add_u32 s41, s41, s35
    s_add_u32 m0, s36, 49152
    v_mfma_f32_16x16x32_bf16 v[176:179], a[48:51], v[68:71], v[176:179]
    ds_read_b128 a[32:35], v14 offset:8192
    buffer_load_dwordx4 v13, s[20:23], s41 offen offset:0 sc1 lds
    v_mfma_f32_16x16x32_bf16 v[180:183], a[52:55], v[68:71], v[180:183]
    ds_read_b128 a[36:39], v14 offset:9216
    buffer_load_dwordx4 v13, s[20:23], s41 offen offset:1024 sc1 lds
    v_mfma_f32_16x16x32_bf16 v[184:187], a[56:59], v[68:71], v[184:187]
    ds_read_b128 a[40:43], v14 offset:10240
    buffer_load_dwordx4 v13, s[20:23], s41 offen offset:2048 sc1 lds
    v_mfma_f32_16x16x32_bf16 v[188:191], a[60:63], v[68:71], v[188:191]
    ds_read_b128 a[44:47], v14 offset:11264
    buffer_load_dwordx4 v13, s[20:23], s41 offen offset:3072 sc1 lds
    v_mfma_f32_16x16x32_bf16 a[136:139], a[128:131], v[68:71], a[136:139]
    s_cmp_lt_u32 s28, 2
    s_cbranch_scc0 AT_g
    s_waitcnt lgkmcnt(4)
    v_mfma_f32_16x16x32_bf16 v[24:27], a[0:3], a[80:83], v[88:91]
    v_exp_f32 v52, v28
    v_mfma_f32_16x16x32_bf16 v[24:27], a[4:7], a[84:87], v[24:27]
    v_exp_f32 v53, v29
    v_mfma_f32_16x16x32_bf16 v[24:27], a[8:11], a[88:91], v[24:27]
    v_exp_f32 v54, v30
    v_mfma_f32_16x16x32_bf16 v[24:27], a[12:15], a[92:95], v[24:27]
    v_exp_f32 v55, v31
    v_mfma_f32_16x16x32_bf16 v[28:31], a[16:19], a[80:83], v[92:95]
    ds_read_b128 a[48:51], v14 offset:12288
    v_cvt_pk_bf16_f32 v68, v8, v9
    v_cvt_pk_bf16_f32 v69, v10, v11
    v_mfma_f32_16x16x32_bf16 v[28:31], a[20:23], a[84:87], v[28:31]
    ds_read_b128 a[52:55], v14 offset:13312
    v_cvt_pk_bf16_f32 v70, v52, v53
    v_mfma_f32_16x16x32_bf16 v[28:31], a[24:27], a[88:91], v[28:31]
    ds_read_b128 a[56:59], v14 offset:14336
    v_cvt_pk_bf16_f32 v71, v54, v55
    v_mfma_f32_16x16x32_bf16 v[28:31], a[28:31], a[92:95], v[28:31]
    s_waitcnt lgkmcnt(3)
    ds_read_b128 a[60:63], v14 offset:15360
    v_xor_b32 v14, s72, v12
    v_mfma_f32_16x16x32_bf16 v[160:163], a[32:35], v[68:71], v[160:163]
    s_add_u32 s55, s55, 16384
    ds_read_b128 a[0:3], v14 offset:0
    v_mfma_f32_16x16x32_bf16 v[164:167], a[36:39], v[68:71], v[164:167]
    s_and_b32 s72, s55, 0x1ffff
    ds_read_b128 a[4:7], v14 offset:1024
    v_exp_f32 v8, v24
    v_mfma_f32_16x16x32_bf16 v[168:171], a[40:43], v[68:71], v[168:171]
    ds_read_b128 a[8:11], v14 offset:2048
    v_mfma_f32_16x16x32_bf16 v[172:175], a[44:47], v[68:71], v[172:175]
    s_waitcnt lgkmcnt(3)
    v_exp_f32 v9, v25
    v_mfma_f32_16x16x32_bf16 v[176:179], a[48:51], v[68:71], v[176:179]
    ds_read_b128 a[12:15], v14 offset:3072
    v_mfma_f32_16x16x32_bf16 v[180:183], a[52:55], v[68:71], v[180:183]
    ds_read_b128 a[16:19], v14 offset:4096
    v_exp_f32 v10, v26
    v_mfma_f32_16x16x32_bf16 v[184:187], a[56:59], v[68:71], v[184:187]
    ds_read_b128 a[20:23], v14 offset:5120
    v_exp_f32 v11, v27
    v_mfma_f32_16x16x32_bf16 v[188:191], a[60:63], v[68:71], v[188:191]
    ds_read_b128 a[24:27], v14 offset:6144
    ds_read_b128 a[28:31], v14 offset:7168
    v_mfma_f32_16x16x32_bf16 a[136:139], a[128:131], v[68:71], a[136:139]
    ds_read_b128 a[32:35], v14 offset:8192
    ds_read_b128 a[36:39], v14 offset:9216
    ds_read_b128 a[40:43], v14 offset:10240
    ds_read_b128 a[44:47], v14 offset:11264
    s_bitcmp1_b32 s28, 0
    s_cbranch_scc0 AT_kco
    v_min_f32 v88, v88, v112
    v_min_f32 v89, v89, v113
    v_min_f32 v90, v90, v114
    v_min_f32 v91, v91, v115
    v_mov_b32 v92, 0xf149f2ca
    v_mov_b32 v93, 0xf149f2ca
    v_mov_b32 v94, 0xf149f2ca
    v_mov_b32 v95, 0xf149f2ca
AT_kco:
    v_min_f32 v92, v92, v112
    v_min_f32 v93, v93, v113
    v_min_f32 v94, v94, v114
    v_min_f32 v95, v95, v115
    s_nop 0
    s_waitcnt lgkmcnt(4)
    v_mfma_f32_16x16x32_bf16 v[24:27], a[0:3], a[80:83], v[88:91]
    v_exp_f32 v52, v28
    v_mfma_f32_16x16x32_bf16 v[24:27], a[4:7], a[84:87], v[24:27]
    v_exp_f32 v53, v29
    v_mfma_f32_16x16x32_bf16 v[24:27], a[8:11], a[88:91], v[24:27]
    v_exp_f32 v54, v30
    v_mfma_f32_16x16x32_bf16 v[24:27], a[12:15], a[92:95], v[24:27]
    v_exp_f32 v55, v31
    v_mfma_f32_16x16x32_bf16 v[28:31], a[16:19], a[80:83], v[92:95]
    ds_read_b128 a[48:51], v14 offset:12288
    v_cvt_pk_bf16_f32 v68, v8, v9
    v_cvt_pk_bf16_f32 v69, v10, v11
    v_mfma_f32_16x16x32_bf16 v[28:31], a[20:23], a[84:87], v[28:31]
    ds_read_b128 a[52:55], v14 offset:13312
    v_cvt_pk_bf16_f32 v70, v52, v53
    v_mfma_f32_16x16x32_bf16 v[28:31], a[24:27], a[88:91], v[28:31]
    ds_read_b128 a[56:59], v14 offset:14336
    v_cvt_pk_bf16_f32 v71, v54, v55
    v_mfma_f32_16x16x32_bf16 v[28:31], a[28:31], a[92:95], v[28:31]
    s_waitcnt lgkmcnt(3)
    ds_read_b128 a[60:63], v14 offset:15360
    v_xor_b32 v14, s72, v12
    v_mfma_f32_16x16x32_bf16 v[160:163], a[32:35], v[68:71], v[160:163]
    s_add_u32 s55, s55, 16384
    ds_read_b128 a[0:3], v14 offset:0
    v_mfma_f32_16x16x32_bf16 v[164:167], a[36:39], v[68:71], v[164:167]
    s_and_b32 s72, s55, 0x1ffff
    ds_read_b128 a[4:7], v14 offset:1024
    v_exp_f32 v8, v24
    v_mfma_f32_16x16x32_bf16 v[168:171], a[40:43], v[68:71], v[168:171]
    ds_read_b128 a[8:11], v14 offset:2048
    v_mfma_f32_16x16x32_bf16 v[172:175], a[44:47], v[68:71], v[172:175]
    s_waitcnt lgkmcnt(3)
    v_exp_f32 v9, v25
    v_mfma_f32_16x16x32_bf16 v[176:179], a[48:51], v[68:71], v[176:179]
    ds_read_b128 a[12:15], v14 offset:3072
    v_mfma_f32_16x16x32_bf16 v[180:183], a[52:55], v[68:71], v[180:183]
    ds_read_b128 a[16:19], v14 offset:4096
    v_exp_f32 v10, v26
    v_mfma_f32_16x16x32_bf16 v[184:187], a[56:59], v[68:71], v[184:187]
    ds_read_b128 a[20:23], v14 offset:5120
    v_exp_f32 v11, v27
    v_mfma_f32_16x16x32_bf16 v[188:191], a[60:63], v[68:71], v[188:191]
    ds_read_b128 a[24:27], v14 offset:6144
    ds_read_b128 a[28:31], v14 offset:7168
    v_mfma_f32_16x16x32_bf16 a[136:139], a[128:131], v[68:71], a[136:139]
    ds_read_b128 a[32:35], v14 offset:8192
    ds_read_b128 a[36:39], v14 offset:9216
    ds_read_b128 a[40:43], v14 offset:10240
    ds_read_b128 a[44:47], v14 offset:11264
AT_g:
    ds_read_b128 a[48:51], v14 offset:12288
    ds_read_b128 a[52:55], v14 offset:13312
    ds_read_b128 a[56:59], v14 offset:14336
    ds_read_b128 a[60:63], v14 offset:15360
    v_exp_f32 v52, v28
    v_exp_f32 v53, v29
    v_exp_f32 v54, v30
    v_exp_f32 v55, v31
    v_cvt_pk_bf16_f32 v68, v8, v9
    v_cvt_pk_bf16_f32 v69, v10, v11
    v_cvt_pk_bf16_f32 v70, v52, v53
    v_cvt_pk_bf16_f32 v71, v54, v55
    s_nop 0
    s_waitcnt lgkmcnt(4)
    v_mfma_f32_16x16x32_bf16 v[160:163], a[32:35], v[68:71], v[160:163]
    v_mfma_f32_16x16x32_bf16 v[164:167], a[36:39], v[68:71], v[164:167]
    v_mfma_f32_16x16x32_bf16 v[168:171], a[40:43], v[68:71], v[168:171]
    v_mfma_f32_16x16x32_bf16 v[172:175], a[44:47], v[68:71], v[172:175]
    s_waitcnt lgkmcnt(0)
    v_mfma_f32_16x16x32_bf16 v[176:179], a[48:51], v[68:71], v[176:179]
    v_mfma_f32_16x16x32_bf16 v[180:183], a[52:55], v[68:71], v[180:183]
    v_mfma_f32_16x16x32_bf16 v[184:187], a[56:59], v[68:71], v[184:187]
    v_mfma_f32_16x16x32_bf16 v[188:191], a[60:63], v[68:71], v[188:191]
    v_mfma_f32_16x16x32_bf16 a[136:139], a[128:131], v[68:71], a[136:139]
    s_nop 6
    v_accvgpr_read_b32 v124, a132
    v_accvgpr_read_b32 v125, a136
    v_cmp_nle_f32 vcc, v124, v15
    v_rcp_f32 v116, v124
    s_or_b64 s[58:59], s[58:59], vcc
    v_cmp_nle_f32 vcc, v125, v15
    v_rcp_f32 v118, v125
    s_or_b64 s[58:59], s[58:59], vcc
    v_pk_mul_f32 v[128:129], v[128:129], v[116:117] op_sel_hi:[1,0]
    v_pk_mul_f32 v[130:131], v[130:131], v[116:117] op_sel_hi:[1,0]
    v_pk_mul_f32 v[132:133], v[132:133], v[116:117] op_sel_hi:[1,0]
    v_pk_mul_f32 v[134:135], v[134:135], v[116:117] op_sel_hi:[1,0]
    v_cvt_pk_bf16_f32 v128, v128, v129
    v_cvt_pk_bf16_f32 v129, v130, v131
    v_cvt_pk_bf16_f32 v130, v132, v133
    v_cvt_pk_bf16_f32 v131, v134, v135
    buffer_store_dwordx4 v[128:131], v2, s[20:23], s70 offen offset:0 sc1
    v_pk_mul_f32 v[136:137], v[136:137], v[116:117] op_sel_hi:[1,0]
    v_pk_mul_f32 v[138:139], v[138:139], v[116:117] op_sel_hi:[1,0]
    v_pk_mul_f32 v[140:141], v[140:141], v[116:117] op_sel_hi:[1,0]
    v_pk_mul_f32 v[142:143], v[142:143], v[116:117] op_sel_hi:[1,0]
    v_cvt_pk_bf16_f32 v136, v136, v137
    v_cvt_pk_bf16_f32 v137, v138, v139
    v_cvt_pk_bf16_f32 v138, v140, v141
    v_cvt_pk_bf16_f32 v139, v142, v143
    buffer_store_dwordx4 v[136:139], v2, s[20:23], s70 offen offset:1024 sc1
    v_pk_mul_f32 v[144:145], v[144:145], v[116:117] op_sel_hi:[1,0]
    v_pk_mul_f32 v[146:147], v[146:147], v[116:117] op_sel_hi:[1,0]
    v_pk_mul_f32 v[148:149], v[148:149], v[116:117] op_sel_hi:[1,0]
    v_pk_mul_f32 v[150:151], v[150:151], v[116:117] op_sel_hi:[1,0]
    v_cvt_pk_bf16_f32 v144, v144, v145
    v_cvt_pk_bf16_f32 v145, v146, v147
    v_cvt_pk_bf16_f32 v146, v148, v149
    v_cvt_pk_bf16_f32 v147, v150, v151
    buffer_store_dwordx4 v[144:147], v2, s[20:23], s70 offen offset:2048 sc1
    v_pk_mul_f32 v[152:153], v[152:153], v[116:117] op_sel_hi:[1,0]
    v_pk_mul_f32 v[154:155], v[154:155], v[116:117] op_sel_hi:[1,0]
    v_pk_mul_f32 v[156:157], v[156:157], v[116:117] op_sel_hi:[1,0]
    v_pk_mul_f32 v[158:159], v[158:159], v[116:117] op_sel_hi:[1,0]
    v_cvt_pk_bf16_f32 v152, v152, v153
    v_cvt_pk_bf16_f32 v153, v154, v155
    v_cvt_pk_bf16_f32 v154, v156, v157
    v_cvt_pk_bf16_f32 v155, v158, v159
    buffer_store_dwordx4 v[152:155], v2, s[20:23], s70 offen offset:3072 sc1
    v_pk_mul_f32 v[160:161], v[160:161], v[118:119] op_sel_hi:[1,0]
    v_pk_mul_f32 v[162:163], v[162:163], v[118:119] op_sel_hi:[1,0]
    v_pk_mul_f32 v[164:165], v[164:165], v[118:119] op_sel_hi:[1,0]
    v_pk_mul_f32 v[166:167], v[166:167], v[118:119] op_sel_hi:[1,0]
    v_cvt_pk_bf16_f32 v160, v160, v161
    v_cvt_pk_bf16_f32 v161, v162, v163
    v_cvt_pk_bf16_f32 v162, v164, v165
    v_cvt_pk_bf16_f32 v163, v166, v167
    buffer_store_dwordx4 v[160:163], v2, s[20:23], s63 offen offset:0 sc1
    v_pk_mul_f32 v[168:169], v[168:169], v[118:119] op_sel_hi:[1,0]
    v_pk_mul_f32 v[170:171], v[170:171], v[118:119] op_sel_hi:[1,0]
    v_pk_mul_f32 v[172:173], v[172:173], v[118:119] op_sel_hi:[1,0]
    v_pk_mul_f32 v[174:175], v[174:175], v[118:119] op_sel_hi:[1,0]
    v_cvt_pk_bf16_f32 v168, v168, v169
    v_cvt_pk_bf16_f32 v169, v170, v171
    v_cvt_pk_bf16_f32 v170, v172, v173
    v_cvt_pk_bf16_f32 v171, v174, v175
    buffer_store_dwordx4 v[168:171], v2, s[20:23], s63 offen offset:1024 sc1
    v_pk_mul_f32 v[176:177], v[176:177], v[118:119] op_sel_hi:[1,0]
    v_pk_mul_f32 v[178:179], v[178:179], v[118:119] op_sel_hi:[1,0]
    v_pk_mul_f32 v[180:181], v[180:181], v[118:119] op_sel_hi:[1,0]
    v_pk_mul_f32 v[182:183], v[182:183], v[118:119] op_sel_hi:[1,0]
    v_cvt_pk_bf16_f32 v176, v176, v177
    v_cvt_pk_bf16_f32 v177, v178, v179
    v_cvt_pk_bf16_f32 v178, v180, v181
    v_cvt_pk_bf16_f32 v179, v182, v183
    buffer_store_dwordx4 v[176:179], v2, s[20:23], s63 offen offset:2048 sc1
    v_pk_mul_f32 v[184:185], v[184:185], v[118:119] op_sel_hi:[1,0]
    v_pk_mul_f32 v[186:187], v[186:187], v[118:119] op_sel_hi:[1,0]
    v_pk_mul_f32 v[188:189], v[188:189], v[118:119] op_sel_hi:[1,0]
    v_pk_mul_f32 v[190:191], v[190:191], v[118:119] op_sel_hi:[1,0]
    v_cvt_pk_bf16_f32 v184, v184, v185
    v_cvt_pk_bf16_f32 v185, v186, v187
    v_cvt_pk_bf16_f32 v186, v188, v189
    v_cvt_pk_bf16_f32 v187, v190, v191
    buffer_store_dwordx4 v[184:187], v2, s[20:23], s63 offen offset:3072 sc1
    v_mfma_f32_16x16x32_bf16 v[100:103], a[140:143], v[192:195], 0
    v_mfma_f32_16x16x32_bf16 v[100:103], a[140:143], v[200:203], v[100:103]
    v_mfma_f32_16x16x32_bf16 v[100:103], a[140:143], v[208:211], v[100:103]
    v_mfma_f32_16x16x32_bf16 v[100:103], a[140:143], v[216:219], v[100:103]
    v_mfma_f32_16x16x32_bf16 v[100:103], a[140:143], v[224:227], v[100:103]
    v_mfma_f32_16x16x32_bf16 v[100:103], a[140:143], v[232:235], v[100:103]
    v_mfma_f32_16x16x32_bf16 v[100:103], a[140:143], v[240:243], v[100:103]
    v_mfma_f32_16x16x32_bf16 v[100:103], a[140:143], v[248:251], v[100:103]
    v_mfma_f32_16x16x32_bf16 v[84:87], a[140:143], v[128:131], 0
    v_mfma_f32_16x16x32_bf16 v[84:87], a[140:143], v[136:139], v[84:87]
    v_mfma_f32_16x16x32_bf16 v[84:87], a[140:143], v[144:147], v[84:87]
    v_mfma_f32_16x16x32_bf16 v[84:87], a[140:143], v[152:155], v[84:87]
    v_mfma_f32_16x16x32_bf16 v[84:87], a[140:143], v[160:163], v[84:87]
    v_mfma_f32_16x16x32_bf16 v[84:87], a[140:143], v[168:171], v[84:87]
    v_mfma_f32_16x16x32_bf16 v[84:87], a[140:143], v[176:179], v[84:87]
    v_mfma_f32_16x16x32_bf16 v[84:87], a[140:143], v[184:187], v[84:87]
    v_add_u32 v4, s1, v2
    v_add_u32 v5, 129024, v4
    v_add_u32 v12, s44, v2
    v_add_u32 v8, s48, v2
    v_add_u32 v9, s49, v2
    v_add_u32 v10, s50, v2
    v_add_u32 v11, s54, v2
    s_lshl_b32 s37, s28, 14
    v_add_u32 v14, s37, v2
    v_and_b32 v15, 15, v1
    v_lshlrev_b32 v15, 11, v15
    v_lshrrev_b32 v3, 4, v1
    v_lshl_add_u32 v15, v3, 4, v15
    v_cmp_u_f32 vcc, v100, v100
    s_or_b64 s[60:61], s[60:61], vcc
    v_cmp_u_f32 vcc, v84, v84
    s_or_b64 s[58:59], s[58:59], vcc
    s_or_b64 vcc, s[58:59], s[60:61]
    s_cbranch_vccnz AT_fb
AT_fbx:
    v_add_u32 v16, s53, v2
    v_add_u32 v17, s77, v2
    s_barrier
    s_bitcmp1_b32 s31, 0
    s_cbranch_scc1 OP_wl
    ds_write_b128 v16, v[192:195] offset:0
    ds_write_b128 v16, v[200:203] offset:1024
    ds_write_b128 v16, v[208:211] offset:16384
    ds_write_b128 v16, v[216:219] offset:17408
    ds_write_b128 v17, v[224:227] offset:0
    ds_write_b128 v17, v[232:235] offset:1024
    ds_write_b128 v17, v[240:243] offset:16384
    ds_write_b128 v17, v[248:251] offset:17408
    s_branch OP_wd
OP_wl:
    ds_write_b128 v16, v[128:131] offset:0
    ds_write_b128 v16, v[136:139] offset:1024
    ds_write_b128 v16, v[144:147] offset:16384
    ds_write_b128 v16, v[152:155] offset:17408
    ds_write_b128 v17, v[160:163] offset:0
    ds_write_b128 v17, v[168:171] offset:1024
    ds_write_b128 v17, v[176:179] offset:16384
    ds_write_b128 v17, v[184:187] offset:17408
OP_wd:
    s_waitcnt vmcnt(16) lgkmcnt(0)
    s_barrier
    ds_read_b128 v[128:131], v12 offset:0
    ds_read_b128 v[144:147], v12 offset:8192
    ds_read_b128 v[192:195], v8 offset:0
    ds_read_b128 v[208:211], v8 offset:1024
    ds_read_b128 v[132:135], v12 offset:1024
    ds_read_b128 v[148:151], v12 offset:9216
    ds_read_b128 v[196:199], v9 offset:0
    ds_read_b128 v[212:215], v9 offset:1024
    ds_read_b128 v[136:139], v12 offset:2048
    ds_read_b128 v[152:155], v12 offset:10240
    ds_read_b128 v[200:203], v10 offset:0
    ds_read_b128 v[216:219], v10 offset:1024
    ds_read_b128 v[140:143], v12 offset:3072
    ds_read_b128 v[156:159], v12 offset:11264
    ds_read_b128 v[204:207], v11 offset:0
    ds_read_b128 v[220:223], v11 offset:1024
    s_waitcnt lgkmcnt(0)
    v_mfma_f32_16x16x32_bf16 v[64:67], v[128:131], v[192:195], 0
    v_mfma_f32_16x16x32_bf16 v[64:67], v[144:147], v[208:211], v[64:67]
    ds_read_b128 v[160:163], v12 offset:16384
    v_mfma_f32_16x16x32_bf16 v[68:71], v[128:131], v[196:199], 0
    ds_read_b128 v[176:179], v12 offset:24576
    v_mfma_f32_16x16x32_bf16 v[68:71], v[144:147], v[212:215], v[68:71]
    ds_read_b128 v[224:227], v8 offset:16384
    v_mfma_f32_16x16x32_bf16 v[72:75], v[128:131], v[200:203], 0
    v_mfma_f32_16x16x32_bf16 v[72:75], v[144:147], v[216:219], v[72:75]
    ds_read_b128 v[240:243], v8 offset:17408
    v_mfma_f32_16x16x32_bf16 v[76:79], v[128:131], v[204:207], 0
    ds_read_b128 v[164:167], v12 offset:17408
    v_mfma_f32_16x16x32_bf16 v[76:79], v[144:147], v[220:223], v[76:79]
    v_mfma_f32_16x16x32_bf16 v[80:83], v[132:135], v[192:195], 0
    ds_read_b128 v[180:183], v12 offset:25600
    v_mfma_f32_16x16x32_bf16 v[80:83], v[148:151], v[208:211], v[80:83]
    ds_read_b128 v[228:231], v9 offset:16384
    v_mfma_f32_16x16x32_bf16 v[84:87], v[132:135], v[196:199], 0
    v_mfma_f32_16x16x32_bf16 v[84:87], v[148:151], v[212:215], v[84:87]
    ds_read_b128 v[244:247], v9 offset:17408
    v_mfma_f32_16x16x32_bf16 v[88:91], v[132:135], v[200:203], 0
    ds_read_b128 v[168:171], v12 offset:18432
    v_mfma_f32_16x16x32_bf16 v[88:91], v[148:151], v[216:219], v[88:91]
    v_mfma_f32_16x16x32_bf16 v[92:95], v[132:135], v[204:207], 0
    ds_read_b128 v[184:187], v12 offset:26624
    v_mfma_f32_16x16x32_bf16 v[92:95], v[148:151], v[220:223], v[92:95]
    ds_read_b128 v[232:235], v10 offset:16384
    v_mfma_f32_16x16x32_bf16 v[96:99], v[136:139], v[192:195], 0
    v_mfma_f32_16x16x32_bf16 v[96:99], v[152:155], v[208:211], v[96:99]
    ds_read_b128 v[248:251], v10 offset:17408
    v_mfma_f32_16x16x32_bf16 v[100:103], v[136:139], v[196:199], 0
    ds_read_b128 v[172:175], v12 offset:19456
    v_mfma_f32_16x16x32_bf16 v[100:103], v[152:155], v[212:215], v[100:103]
    v_mfma_f32_16x16x32_bf16 v[104:107], v[136:139], v[200:203], 0
    ds_read_b128 v[188:191], v12 offset:27648
    v_mfma_f32_16x16x32_bf16 v[104:107], v[152:155], v[216:219], v[104:107]
    ds_read_b128 v[236:239], v11 offset:16384
    v_mfma_f32_16x16x32_bf16 v[108:111], v[136:139], v[204:207], 0
    v_mfma_f32_16x16x32_bf16 v[108:111], v[152:155], v[220:223], v[108:111]
    ds_read_b128 v[252:255], v11 offset:17408
    v_mfma_f32_16x16x32_bf16 v[112:115], v[140:143], v[192:195], 0
    v_mfma_f32_16x16x32_bf16 v[112:115], v[156:159], v[208:211], v[112:115]
    v_mfma_f32_16x16x32_bf16 v[116:119], v[140:143], v[196:199], 0
    v_mfma_f32_16x16x32_bf16 v[116:119], v[156:159], v[212:215], v[116:119]
    s_waitcnt vmcnt(0) lgkmcnt(0)
    s_barrier
    s_cmp_lg_u32 s28, 0
    s_cbranch_scc1 SG10
    s_and_b32 s100, s31, 6
    v_and_b32 v20, 1, v1
    v_add_u32 v20, s100, v20
    v_lshrrev_b32 v21, 1, v1
    s_lshl_b32 s100, s30, 2
    v_add_u32 v21, s100, v21
    v_lshl_add_u32 v22, v21, 3, v20
    v_lshlrev_b32 v22, 9, v22
    s_and_b32 s100, s29, 7
    s_lshl_b32 s100, s100, 2
    s_add_u32 s100, s100, 57671680
    v_mov_b32 v20, s3
    s_mov_b64 exec, 0xff
    buffer_store_dword v20, v22, s[20:23], s100 offen sc1
    s_mov_b64 exec, -1
SG10:
    v_mfma_f32_16x16x32_bf16 v[120:123], v[140:143], v[200:203], 0
    v_mfma_f32_16x16x32_bf16 v[120:123], v[156:159], v[216:219], v[120:123]
    v_mfma_f32_16x16x32_bf16 v[124:127], v[140:143], v[204:207], 0
    v_mfma_f32_16x16x32_bf16 v[124:127], v[156:159], v[220:223], v[124:127]
    s_waitcnt lgkmcnt(0)
    v_mfma_f32_16x16x32_bf16 v[64:67], v[160:163], v[224:227], v[64:67]
    v_mfma_f32_16x16x32_bf16 v[64:67], v[176:179], v[240:243], v[64:67]
    s_xor_b32 s41, s52, 65536
    v_mfma_f32_16x16x32_bf16 v[68:71], v[160:163], v[228:231], v[68:71]
    s_add_u32 s41, s41, s35
    v_mfma_f32_16x16x32_bf16 v[68:71], v[176:179], v[244:247], v[68:71]
    s_add_u32 m0, s36, 0
    v_mfma_f32_16x16x32_bf16 v[72:75], v[160:163], v[232:235], v[72:75]
    buffer_load_dwordx4 v13, s[20:23], s41 offen offset:0 sc1 lds
    v_mfma_f32_16x16x32_bf16 v[72:75], v[176:179], v[248:251], v[72:75]
    v_mfma_f32_16x16x32_bf16 v[76:79], v[160:163], v[236:239], v[76:79]
    v_mfma_f32_16x16x32_bf16 v[76:79], v[176:179], v[252:255], v[76:79]
    buffer_load_dwordx4 v13, s[20:23], s41 offen offset:1024 sc1 lds
    v_mfma_f32_16x16x32_bf16 v[80:83], v[164:167], v[224:227], v[80:83]
    v_mfma_f32_16x16x32_bf16 v[80:83], v[180:183], v[240:243], v[80:83]
    v_mfma_f32_16x16x32_bf16 v[84:87], v[164:167], v[228:231], v[84:87]
    buffer_load_dwordx4 v13, s[20:23], s41 offen offset:2048 sc1 lds
    v_mfma_f32_16x16x32_bf16 v[84:87], v[180:183], v[244:247], v[84:87]
    v_mfma_f32_16x16x32_bf16 v[88:91], v[164:167], v[232:235], v[88:91]
    v_mfma_f32_16x16x32_bf16 v[88:91], v[180:183], v[248:251], v[88:91]
    buffer_load_dwordx4 v13, s[20:23], s41 offen offset:3072 sc1 lds
    v_mfma_f32_16x16x32_bf16 v[92:95], v[164:167], v[236:239], v[92:95]
    v_mfma_f32_16x16x32_bf16 v[92:95], v[180:183], v[252:255], v[92:95]
    s_and_b32 s101, s29, 4
    s_lshl_b32 s100, s2, 7
    s_add_u32 s100, s100, s101
    s_lshl_b32 s100, s100, 2
    s_add_u32 s100, s100, 57671680
    v_and_b32 v7, 3, v1
    v_lshl_add_u32 v7, v7, 2, s100
    buffer_load_dword v6, v7, s[20:23], 0 offen sc1
    v_mfma_f32_16x16x32_bf16 v[96:99], v[168:171], v[224:227], v[96:99]
    v_mfma_f32_16x16x32_bf16 v[96:99], v[184:187], v[240:243], v[96:99]
    v_mfma_f32_16x16x32_bf16 v[100:103], v[168:171], v[228:231], v[100:103]
    v_mfma_f32_16x16x32_bf16 v[100:103], v[184:187], v[244:247], v[100:103]
    v_mfma_f32_16x16x32_bf16 v[104:107], v[168:171], v[232:235], v[104:107]
    buffer_load_dword v21, v7, s[20:23], 0 offen sc1
    v_mfma_f32_16x16x32_bf16 v[104:107], v[184:187], v[248:251], v[104:107]
    v_mfma_f32_16x16x32_bf16 v[108:111], v[168:171], v[236:239], v[108:111]
    v_mfma_f32_16x16x32_bf16 v[108:111], v[184:187], v[252:255], v[108:111]
    v_mfma_f32_16x16x32_bf16 v[112:115], v[172:175], v[224:227], v[112:115]
    v_mfma_f32_16x16x32_bf16 v[112:115], v[188:191], v[240:243], v[112:115]
    buffer_load_dword v22, v7, s[20:23], 0 offen sc1
    v_mfma_f32_16x16x32_bf16 v[116:119], v[172:175], v[228:231], v[116:119]
    v_mfma_f32_16x16x32_bf16 v[116:119], v[188:191], v[244:247], v[116:119]
    v_mfma_f32_16x16x32_bf16 v[120:123], v[172:175], v[232:235], v[120:123]
    v_mfma_f32_16x16x32_bf16 v[120:123], v[188:191], v[248:251], v[120:123]
    v_mfma_f32_16x16x32_bf16 v[124:127], v[172:175], v[236:239], v[124:127]
    buffer_load_dword v23, v7, s[20:23], 0 offen sc1
    v_mfma_f32_16x16x32_bf16 v[124:127], v[188:191], v[252:255], v[124:127]
    s_waitcnt vmcnt(3)
    v_cmp_ne_u32 vcc, s3, v6
    s_cbranch_vccz OP_c1
    s_waitcnt vmcnt(2)
    v_cmp_ne_u32 vcc, s3, v21
    s_cbranch_vccz OP_c1
    s_waitcnt vmcnt(1)
    v_cmp_ne_u32 vcc, s3, v22
    s_cbranch_vccz OP_c1
    s_waitcnt vmcnt(0)
    v_mov_b32 v6, v23
    s_mov_b32 s37, 0x20000
PL11:
    v_cmp_ne_u32 vcc, s3, v6
    s_cbranch_vccz PL11x
    s_sub_u32 s37, s37, 1
    s_cbranch_scc1 PL11x
    s_sleep 4
    buffer_load_dword v6, v7, s[20:23], 0 offen sc1
    s_waitcnt vmcnt(0)
    s_branch PL11
PL11x:
OP_c1:
    s_xor_b32 s40, s51, 4096
    s_add_u32 s40, s40, s34
    s_add_u32 m0, s43, 32768
    s_nop 0
    buffer_load_dwordx4 v4, s[20:23], s40 offen offset:0 sc1 lds
    buffer_load_dwordx4 v4, s[20:23], s40 offen offset:1024 sc1 lds
    buffer_load_dwordx4 v5, s[20:23], s40 offen offset:2048 sc1 lds
    buffer_load_dwordx4 v5, s[20:23], s40 offen offset:3072 sc1 lds
    s_xor_b32 s40, s51, 6144
    s_add_u32 s40, s40, s34
    s_add_u32 m0, s43, 49152
    s_nop 0
    buffer_load_dwordx4 v4, s[20:23], s40 offen offset:0 sc1 lds
    buffer_load_dwordx4 v4, s[20:23], s40 offen offset:1024 sc1 lds
    buffer_load_dwordx4 v5, s[20:23], s40 offen offset:2048 sc1 lds
    buffer_load_dwordx4 v5, s[20:23], s40 offen offset:3072 sc1 lds
    s_xor_b32 s40, s51, 8192
    s_add_u32 s40, s40, s34
    s_add_u32 m0, s43, 0
    s_nop 0
    buffer_load_dwordx4 v4, s[20:23], s40 offen offset:0 sc1 lds
    buffer_load_dwordx4 v4, s[20:23], s40 offen offset:1024 sc1 lds
    buffer_load_dwordx4 v5, s[20:23], s40 offen offset:2048 sc1 lds
    buffer_load_dwordx4 v5, s[20:23], s40 offen offset:3072 sc1 lds
    s_waitcnt vmcnt(8)
    s_barrier
    ds_read_b128 v[128:131], v12 offset:32768
    ds_read_b128 v[144:147], v12 offset:40960
    ds_read_b128 v[192:195], v8 offset:32768
    ds_read_b128 v[208:211], v8 offset:33792
    ds_read_b128 v[132:135], v12 offset:33792
    ds_read_b128 v[148:151], v12 offset:41984
    ds_read_b128 v[196:199], v9 offset:32768
    ds_read_b128 v[212:215], v9 offset:33792
    ds_read_b128 v[136:139], v12 offset:34816
    ds_read_b128 v[152:155], v12 offset:43008
    ds_read_b128 v[200:203], v10 offset:32768
    ds_read_b128 v[216:219], v10 offset:33792
    ds_read_b128 v[140:143], v12 offset:35840
    ds_read_b128 v[156:159], v12 offset:44032
    ds_read_b128 v[204:207], v11 offset:32768
    ds_read_b128 v[220:223], v11 offset:33792
    s_waitcnt lgkmcnt(0)
    v_mfma_f32_16x16x32_bf16 v[64:67], v[128:131], v[192:195], v[64:67]
    s_waitcnt vmcnt(4)
    s_barrier
    v_mfma_f32_16x16x32_bf16 v[64:67], v[144:147], v[208:211], v[64:67]
    s_xor_b32 s40, s51, 10240
    ds_read_b128 v[160:163], v12 offset:49152
    v_mfma_f32_16x16x32_bf16 v[68:71], v[128:131], v[196:199], v[68:71]
    s_add_u32 s40, s40, s34
    ds_read_b128 v[176:179], v12 offset:57344
    v_mfma_f32_16x16x32_bf16 v[68:71], v[144:147], v[212:215], v[68:71]
    s_add_u32 m0, s43, 16384
    ds_read_b128 v[224:227], v8 offset:49152
    v_mfma_f32_16x16x32_bf16 v[72:75], v[128:131], v[200:203], v[72:75]
    buffer_load_dwordx4 v4, s[20:23], s40 offen offset:0 sc1 lds
    v_mfma_f32_16x16x32_bf16 v[72:75], v[144:147], v[216:219], v[72:75]
    ds_read_b128 v[240:243], v8 offset:50176
    v_mfma_f32_16x16x32_bf16 v[76:79], v[128:131], v[204:207], v[76:79]
    ds_read_b128 v[164:167], v12 offset:50176
    v_mfma_f32_16x16x32_bf16 v[76:79], v[144:147], v[220:223], v[76:79]
    buffer_load_dwordx4 v4, s[20:23], s40 offen offset:1024 sc1 lds
    v_mfma_f32_16x16x32_bf16 v[80:83], v[132:135], v[192:195], v[80:83]
    ds_read_b128 v[180:183], v12 offset:58368
    v_mfma_f32_16x16x32_bf16 v[80:83], v[148:151], v[208:211], v[80:83]
    ds_read_b128 v[228:231], v9 offset:49152
    v_mfma_f32_16x16x32_bf16 v[84:87], v[132:135], v[196:199], v[84:87]
    buffer_load_dwordx4 v5, s[20:23], s40 offen offset:2048 sc1 lds
    v_mfma_f32_16x16x32_bf16 v[84:87], v[148:151], v[212:215], v[84:87]
    ds_read_b128 v[244:247], v9 offset:50176
    v_mfma_f32_16x16x32_bf16 v[88:91], v[132:135], v[200:203], v[88:91]
    ds_read_b128 v[168:171], v12 offset:51200
    v_mfma_f32_16x16x32_bf16 v[88:91], v[148:151], v[216:219], v[88:91]
    s_xor_b32 s41, s52, 81920
    buffer_load_dwordx4 v5, s[20:23], s40 offen offset:3072 sc1 lds
    v_mfma_f32_16x16x32_bf16 v[92:95], v[132:135], v[204:207], v[92:95]
    s_add_u32 s41, s41, s35
    ds_read_b128 v[184:187], v12 offset:59392
    v_mfma_f32_16x16x32_bf16 v[92:95], v[148:151], v[220:223], v[92:95]
    s_add_u32 m0, s36, 16384
    ds_read_b128 v[232:235], v10 offset:49152
    v_mfma_f32_16x16x32_bf16 v[96:99], v[136:139], v[192:195], v[96:99]
    buffer_load_dwordx4 v13, s[20:23], s41 offen offset:0 sc1 lds
    v_mfma_f32_16x16x32_bf16 v[96:99], v[152:155], v[208:211], v[96:99]
    ds_read_b128 v[248:251], v10 offset:50176
    v_mfma_f32_16x16x32_bf16 v[100:103], v[136:139], v[196:199], v[100:103]
    ds_read_b128 v[172:175], v12 offset:52224
    v_mfma_f32_16x16x32_bf16 v[100:103], v[152:155], v[212:215], v[100:103]
    buffer_load_dwordx4 v13, s[20:23], s41 offen offset:1024 sc1 lds
    v_mfma_f32_16x16x32_bf16 v[104:107], v[136:139], v[200:203], v[104:107]
    ds_read_b128 v[188:191], v12 offset:60416
    v_mfma_f32_16x16x32_bf16 v[104:107], v[152:155], v[216:219], v[104:107]
    ds_read_b128 v[236:239], v11 offset:49152
    v_mfma_f32_16x16x32_bf16 v[108:111], v[136:139], v[204:207], v[108:111]
    buffer_load_dwordx4 v13, s[20:23], s41 offen offset:2048 sc1 lds
    v_mfma_f32_16x16x32_bf16 v[108:111], v[152:155], v[220:223], v[108:111]
    ds_read_b128 v[252:255], v11 offset:50176
    v_mfma_f32_16x16x32_bf16 v[112:115], v[140:143], v[192:195], v[112:115]
    v_mfma_f32_16x16x32_bf16 v[112:115], v[156:159], v[208:211], v[112:115]
    buffer_load_dwordx4 v13, s[20:23], s41 offen offset:3072 sc1 lds
    v_mfma_f32_16x16x32_bf16 v[116:119], v[140:143], v[196:199], v[116:119]
    v_mfma_f32_16x16x32_bf16 v[116:119], v[156:159], v[212:215], v[116:119]
    v_mfma_f32_16x16x32_bf16 v[120:123], v[140:143], v[200:203], v[120:123]
    v_mfma_f32_16x16x32_bf16 v[120:123], v[156:159], v[216:219], v[120:123]
    v_mfma_f32_16x16x32_bf16 v[124:127], v[140:143], v[204:207], v[124:127]
    v_mfma_f32_16x16x32_bf16 v[124:127], v[156:159], v[220:223], v[124:127]
    s_waitcnt lgkmcnt(0)
    v_mfma_f32_16x16x32_bf16 v[64:67], v[160:163], v[224:227], v[64:67]
    s_waitcnt vmcnt(8)
    s_barrier
    v_mfma_f32_16x16x32_bf16 v[64:67], v[176:179], v[240:243], v[64:67]
    s_xor_b32 s40, s51, 12288
    ds_read_b128 v[128:131], v12 offset:0
    v_mfma_f32_16x16x32_bf16 v[68:71], v[160:163], v[228:231], v[68:71]
    s_add_u32 s40, s40, s34
    ds_read_b128 v[144:147], v12 offset:8192
    v_mfma_f32_16x16x32_bf16 v[68:71], v[176:179], v[244:247], v[68:71]
    s_add_u32 m0, s43, 32768
    ds_read_b128 v[192:195], v8 offset:0
    v_mfma_f32_16x16x32_bf16 v[72:75], v[160:163], v[232:235], v[72:75]
    buffer_load_dwordx4 v4, s[20:23], s40 offen offset:0 sc1 lds
    v_mfma_f32_16x16x32_bf16 v[72:75], v[176:179], v[248:251], v[72:75]
    ds_read_b128 v[208:211], v8 offset:1024
    v_mfma_f32_16x16x32_bf16 v[76:79], v[160:163], v[236:239], v[76:79]
    ds_read_b128 v[132:135], v12 offset:1024
    v_mfma_f32_16x16x32_bf16 v[76:79], v[176:179], v[252:255], v[76:79]
    buffer_load_dwordx4 v4, s[20:23], s40 offen offset:1024 sc1 lds
    v_mfma_f32_16x16x32_bf16 v[80:83], v[164:167], v[224:227], v[80:83]
    ds_read_b128 v[148:151], v12 offset:9216
    v_mfma_f32_16x16x32_bf16 v[80:83], v[180:183], v[240:243], v[80:83]
    ds_read_b128 v[196:199], v9 offset:0
    v_mfma_f32_16x16x32_bf16 v[84:87], v[164:167], v[228:231], v[84:87]
    buffer_load_dwordx4 v5, s[20:23], s40 offen offset:2048 sc1 lds
    v_mfma_f32_16x16x32_bf16 v[84:87], v[180:183], v[244:247], v[84:87]
    ds_read_b128 v[212:215], v9 offset:1024
    v_mfma_f32_16x16x32_bf16 v[88:91], v[164:167], v[232:235], v[88:91]
    ds_read_b128 v[136:139], v12 offset:2048
    v_mfma_f32_16x16x32_bf16 v[88:91], v[180:183], v[248:251], v[88:91]
    s_xor_b32 s41, s52, 98304
    buffer_load_dwordx4 v5, s[20:23], s40 offen offset:3072 sc1 lds
    v_mfma_f32_16x16x32_bf16 v[92:95], v[164:167], v[236:239], v[92:95]
    s_add_u32 s41, s41, s35
    ds_read_b128 v[152:155], v12 offset:10240
    v_mfma_f32_16x16x32_bf16 v[92:95], v[180:183], v[252:255], v[92:95]
    s_add_u32 m0, s36, 32768
    ds_read_b128 v[200:203], v10 offset:0
    v_mfma_f32_16x16x32_bf16 v[96:99], v[168:171], v[224:227], v[96:99]
    buffer_load_dwordx4 v13, s[20:23], s41 offen offset:0 sc1 lds
    v_mfma_f32_16x16x32_bf16 v[96:99], v[184:187], v[240:243], v[96:99]
    ds_read_b128 v[216:219], v10 offset:1024
    v_mfma_f32_16x16x32_bf16 v[100:103], v[168:171], v[228:231], v[100:103]
    ds_read_b128 v[140:143], v12 offset:3072
    v_mfma_f32_16x16x32_bf16 v[100:103], v[184:187], v[244:247], v[100:103]
    buffer_load_dwordx4 v13, s[20:23], s41 offen offset:1024 sc1 lds
    v_mfma_f32_16x16x32_bf16 v[104:107], v[168:171], v[232:235], v[104:107]
    ds_read_b128 v[156:159], v12 offset:11264
    v_mfma_f32_16x16x32_bf16 v[104:107], v[184:187], v[248:251], v[104:107]
    ds_read_b128 v[204:207], v11 offset:0
    v_mfma_f32_16x16x32_bf16 v[108:111], v[168:171], v[236:239], v[108:111]
    buffer_load_dwordx4 v13, s[20:23], s41 offen offset:2048 sc1 lds
    v_mfma_f32_16x16x32_bf16 v[108:111], v[184:187], v[252:255], v[108:111]
    ds_read_b128 v[220:223], v11 offset:1024
    v_mfma_f32_16x16x32_bf16 v[112:115], v[172:175], v[224:227], v[112:115]
    v_mfma_f32_16x16x32_bf16 v[112:115], v[188:191], v[240:243], v[112:115]
    buffer_load_dwordx4 v13, s[20:23], s41 offen offset:3072 sc1 lds
    v_mfma_f32_16x16x32_bf16 v[116:119], v[172:175], v[228:231], v[116:119]
    v_mfma_f32_16x16x32_bf16 v[116:119], v[188:191], v[244:247], v[116:119]
    v_mfma_f32_16x16x32_bf16 v[120:123], v[172:175], v[232:235], v[120:123]
    s_and_b32 s101, s29, 4
    s_xor_b32 s101, s101, 4
    s_lshl_b32 s100, s2, 7
    s_add_u32 s100, s100, s101
    s_lshl_b32 s100, s100, 2
    s_add_u32 s100, s100, 57671680
    v_and_b32 v7, 3, v1
    v_lshl_add_u32 v7, v7, 2, s100
    buffer_load_dword v6, v7, s[20:23], 0 offen sc1
    v_mfma_f32_16x16x32_bf16 v[120:123], v[188:191], v[248:251], v[120:123]
    v_mfma_f32_16x16x32_bf16 v[124:127], v[172:175], v[236:239], v[124:127]
    v_mfma_f32_16x16x32_bf16 v[124:127], v[188:191], v[252:255], v[124:127]
    s_waitcnt lgkmcnt(0)
    v_mfma_f32_16x16x32_bf16 v[64:67], v[128:131], v[192:195], v[64:67]
    s_waitcnt vmcnt(9)
    s_barrier
    v_mfma_f32_16x16x32_bf16 v[64:67], v[144:147], v[208:211], v[64:67]
    s_xor_b32 s40, s51, 14336
    ds_read_b128 v[160:163], v12 offset:16384
    v_mfma_f32_16x16x32_bf16 v[68:71], v[128:131], v[196:199], v[68:71]
    s_add_u32 s40, s40, s34
    ds_read_b128 v[176:179], v12 offset:24576
    v_mfma_f32_16x16x32_bf16 v[68:71], v[144:147], v[212:215], v[68:71]
    s_add_u32 m0, s43, 49152
    ds_read_b128 v[224:227], v8 offset:16384
    v_mfma_f32_16x16x32_bf16 v[72:75], v[128:131], v[200:203], v[72:75]
    buffer_load_dwordx4 v4, s[20:23], s40 offen offset:0 sc1 lds
    v_mfma_f32_16x16x32_bf16 v[72:75], v[144:147], v[216:219], v[72:75]
    ds_read_b128 v[240:243], v8 offset:17408
    v_mfma_f32_16x16x32_bf16 v[76:79], v[128:131], v[204:207], v[76:79]
    ds_read_b128 v[164:167], v12 offset:17408
    v_mfma_f32_16x16x32_bf16 v[76:79], v[144:147], v[220:223], v[76:79]
    buffer_load_dwordx4 v4, s[20:23], s40 offen offset:1024 sc1 lds
    v_mfma_f32_16x16x32_bf16 v[80:83], v[132:135], v[192:195], v[80:83]
    ds_read_b128 v[180:183], v12 offset:25600
    v_mfma_f32_16x16x32_bf16 v[80:83], v[148:151], v[208:211], v[80:83]
    ds_read_b128 v[228:231], v9 offset:16384
    v_mfma_f32_16x16x32_bf16 v[84:87], v[132:135], v[196:199], v[84:87]
    buffer_load_dwordx4 v5, s[20:23], s40 offen offset:2048 sc1 lds
    v_mfma_f32_16x16x32_bf16 v[84:87], v[148:151], v[212:215], v[84:87]
    ds_read_b128 v[244:247], v9 offset:17408
    v_mfma_f32_16x16x32_bf16 v[88:91], v[132:135], v[200:203], v[88:91]
    ds_read_b128 v[168:171], v12 offset:18432
    v_mfma_f32_16x16x32_bf16 v[88:91], v[148:151], v[216:219], v[88:91]
    s_xor_b32 s41, s52, 114688
    buffer_load_dwordx4 v5, s[20:23], s40 offen offset:3072 sc1 lds
    v_mfma_f32_16x16x32_bf16 v[92:95], v[132:135], v[204:207], v[92:95]
    s_add_u32 s41, s41, s35
    ds_read_b128 v[184:187], v12 offset:26624
    v_mfma_f32_16x16x32_bf16 v[92:95], v[148:151], v[220:223], v[92:95]
    s_add_u32 m0, s36, 49152
    ds_read_b128 v[232:235], v10 offset:16384
    v_mfma_f32_16x16x32_bf16 v[96:99], v[136:139], v[192:195], v[96:99]
    buffer_load_dwordx4 v13, s[20:23], s41 offen offset:0 sc1 lds
    v_mfma_f32_16x16x32_bf16 v[96:99], v[152:155], v[208:211], v[96:99]
    ds_read_b128 v[248:251], v10 offset:17408
    v_mfma_f32_16x16x32_bf16 v[100:103], v[136:139], v[196:199], v[100:103]
    ds_read_b128 v[172:175], v12 offset:19456
    v_mfma_f32_16x16x32_bf16 v[100:103], v[152:155], v[212:215], v[100:103]
    buffer_load_dwordx4 v13, s[20:23], s41 offen offset:1024 sc1 lds
    v_mfma_f32_16x16x32_bf16 v[104:107], v[136:139], v[200:203], v[104:107]
    ds_read_b128 v[188:191], v12 offset:27648
    v_mfma_f32_16x16x32_bf16 v[104:107], v[152:155], v[216:219], v[104:107]
    ds_read_b128 v[236:239], v11 offset:16384
    v_mfma_f32_16x16x32_bf16 v[108:111], v[136:139], v[204:207], v[108:111]
    buffer_load_dwordx4 v13, s[20:23], s41 offen offset:2048 sc1 lds
    v_mfma_f32_16x16x32_bf16 v[108:111], v[152:155], v[220:223], v[108:111]
    ds_read_b128 v[252:255], v11 offset:17408
    v_mfma_f32_16x16x32_bf16 v[112:115], v[140:143], v[192:195], v[112:115]
    v_mfma_f32_16x16x32_bf16 v[112:115], v[156:159], v[208:211], v[112:115]
    buffer_load_dwordx4 v13, s[20:23], s41 offen offset:3072 sc1 lds
    v_mfma_f32_16x16x32_bf16 v[116:119], v[140:143], v[196:199], v[116:119]
    v_mfma_f32_16x16x32_bf16 v[116:119], v[156:159], v[212:215], v[116:119]
    v_mfma_f32_16x16x32_bf16 v[120:123], v[140:143], v[200:203], v[120:123]
    v_mfma_f32_16x16x32_bf16 v[120:123], v[156:159], v[216:219], v[120:123]
    v_mfma_f32_16x16x32_bf16 v[124:127], v[140:143], v[204:207], v[124:127]
    v_mfma_f32_16x16x32_bf16 v[124:127], v[156:159], v[220:223], v[124:127]
    s_waitcnt lgkmcnt(0)
    v_mfma_f32_16x16x32_bf16 v[64:67], v[160:163], v[224:227], v[64:67]
    s_waitcnt vmcnt(9)
    s_barrier
    s_waitcnt vmcnt(8)
    s_mov_b32 s37, 0x20000
PL12:
    v_cmp_ne_u32 vcc, s3, v6
    s_cbranch_vccz PL12x
    s_sub_u32 s37, s37, 1
    s_cbranch_scc1 PL12x
    s_sleep 4
    buffer_load_dword v6, v7, s[20:23], 0 offen sc1
    s_waitcnt vmcnt(0)
    s_branch PL12
PL12x:
    v_mfma_f32_16x16x32_bf16 v[64:67], v[176:179], v[240:243], v[64:67]
    s_xor_b32 s40, s51, 16384
    ds_read_b128 v[128:131], v12 offset:32768
    v_mfma_f32_16x16x32_bf16 v[68:71], v[160:163], v[228:231], v[68:71]
    s_add_u32 s40, s40, s34
    ds_read_b128 v[144:147], v12 offset:40960
    v_mfma_f32_16x16x32_bf16 v[68:71], v[176:179], v[244:247], v[68:71]
    s_add_u32 m0, s43, 0
    ds_read_b128 v[192:195], v8 offset:32768
    v_mfma_f32_16x16x32_bf16 v[72:75], v[160:163], v[232:235], v[72:75]
    buffer_load_dwordx4 v4, s[20:23], s40 offen offset:0 sc1 lds
    v_mfma_f32_16x16x32_bf16 v[72:75], v[176:179], v[248:251], v[72:75]
    ds_read_b128 v[208:211], v8 offset:33792
    v_mfma_f32_16x16x32_bf16 v[76:79], v[160:163], v[236:239], v[76:79]
    ds_read_b128 v[132:135], v12 offset:33792
    v_mfma_f32_16x16x32_bf16 v[76:79], v[176:179], v[252:255], v[76:79]
    buffer_load_dwordx4 v4, s[20:23], s40 offen offset:1024 sc1 lds
    v_mfma_f32_16x16x32_bf16 v[80:83], v[164:167], v[224:227], v[80:83]
    ds_read_b128 v[148:151], v12 offset:41984
    v_mfma_f32_16x16x32_bf16 v[80:83], v[180:183], v[240:243], v[80:83]
    ds_read_b128 v[196:199], v9 offset:32768
    v_mfma_f32_16x16x32_bf16 v[84:87], v[164:167], v[228:231], v[84:87]
    buffer_load_dwordx4 v5, s[20:23], s40 offen offset:2048 sc1 lds
    v_mfma_f32_16x16x32_bf16 v[84:87], v[180:183], v[244:247], v[84:87]
    ds_read_b128 v[212:215], v9 offset:33792
    v_mfma_f32_16x16x32_bf16 v[88:91], v[164:167], v[232:235], v[88:91]
    ds_read_b128 v[136:139], v12 offset:34816
    v_mfma_f32_16x16x32_bf16 v[88:91], v[180:183], v[248:251], v[88:91]
    s_xor_b32 s41, s52, 131072
    buffer_load_dwordx4 v5, s[20:23], s40 offen offset:3072 sc1 lds
    v_mfma_f32_16x16x32_bf16 v[92:95], v[164:167], v[236:239], v[92:95]
    s_add_u32 s41, s41, s35
    ds_read_b128 v[152:155], v12 offset:43008
    v_mfma_f32_16x16x32_bf16 v[92:95], v[180:183], v[252:255], v[92:95]
    s_add_u32 m0, s36, 0
    ds_read_b128 v[200:203], v10 offset:32768
    v_mfma_f32_16x16x32_bf16 v[96:99], v[168:171], v[224:227], v[96:99]
    buffer_load_dwordx4 v13, s[20:23], s41 offen offset:0 sc1 lds
    v_mfma_f32_16x16x32_bf16 v[96:99], v[184:187], v[240:243], v[96:99]
    ds_read_b128 v[216:219], v10 offset:33792
    v_mfma_f32_16x16x32_bf16 v[100:103], v[168:171], v[228:231], v[100:103]
    ds_read_b128 v[140:143], v12 offset:35840
    v_mfma_f32_16x16x32_bf16 v[100:103], v[184:187], v[244:247], v[100:103]
    buffer_load_dwordx4 v13, s[20:23], s41 offen offset:1024 sc1 lds
    v_mfma_f32_16x16x32_bf16 v[104:107], v[168:171], v[232:235], v[104:107]
    ds_read_b128 v[156:159], v12 offset:44032
    v_mfma_f32_16x16x32_bf16 v[104:107], v[184:187], v[248:251], v[104:107]
    ds_read_b128 v[204:207], v11 offset:32768
    v_mfma_f32_16x16x32_bf16 v[108:111], v[168:171], v[236:239], v[108:111]
    buffer_load_dwordx4 v13, s[20:23], s41 offen offset:2048 sc1 lds
    v_mfma_f32_16x16x32_bf16 v[108:111], v[184:187], v[252:255], v[108:111]
    ds_read_b128 v[220:223], v11 offset:33792
    v_mfma_f32_16x16x32_bf16 v[112:115], v[172:175], v[224:227], v[112:115]
    v_mfma_f32_16x16x32_bf16 v[112:115], v[188:191], v[240:243], v[112:115]
    buffer_load_dwordx4 v13, s[20:23], s41 offen offset:3072 sc1 lds
    v_mfma_f32_16x16x32_bf16 v[116:119], v[172:175], v[228:231], v[116:119]
    v_mfma_f32_16x16x32_bf16 v[116:119], v[188:191], v[244:247], v[116:119]
    v_mfma_f32_16x16x32_bf16 v[120:123], v[172:175], v[232:235], v[120:123]
    v_mfma_f32_16x16x32_bf16 v[120:123], v[188:191], v[248:251], v[120:123]
    v_mfma_f32_16x16x32_bf16 v[124:127], v[172:175], v[236:239], v[124:127]
    v_mfma_f32_16x16x32_bf16 v[124:127], v[188:191], v[252:255], v[124:127]
    s_waitcnt lgkmcnt(0)
    v_mfma_f32_16x16x32_bf16 v[64:67], v[128:131], v[192:195], v[64:67]
    s_waitcnt vmcnt(8)
    s_barrier
    v_mfma_f32_16x16x32_bf16 v[64:67], v[144:147], v[208:211], v[64:67]
    s_xor_b32 s40, s51, 18432
    ds_read_b128 v[160:163], v12 offset:49152
    v_mfma_f32_16x16x32_bf16 v[68:71], v[128:131], v[196:199], v[68:71]
    s_add_u32 s40, s40, s34
    ds_read_b128 v[176:179], v12 offset:57344
    v_mfma_f32_16x16x32_bf16 v[68:71], v[144:147], v[212:215], v[68:71]
    s_add_u32 m0, s43, 16384
    ds_read_b128 v[224:227], v8 offset:49152
    v_mfma_f32_16x16x32_bf16 v[72:75], v[128:131], v[200:203], v[72:75]
    buffer_load_dwordx4 v4, s[20:23], s40 offen offset:0 sc1 lds
    v_mfma_f32_16x16x32_bf16 v[72:75], v[144:147], v[216:219], v[72:75]
    ds_read_b128 v[240:243], v8 offset:50176
    v_mfma_f32_16x16x32_bf16 v[76:79], v[128:131], v[204:207], v[76:79]
    ds_read_b128 v[164:167], v12 offset:50176
    v_mfma_f32_16x16x32_bf16 v[76:79], v[144:147], v[220:223], v[76:79]
    buffer_load_dwordx4 v4, s[20:23], s40 offen offset:1024 sc1 lds
    v_mfma_f32_16x16x32_bf16 v[80:83], v[132:135], v[192:195], v[80:83]
    ds_read_b128 v[180:183], v12 offset:58368
    v_mfma_f32_16x16x32_bf16 v[80:83], v[148:151], v[208:211], v[80:83]
    ds_read_b128 v[228:231], v9 offset:49152
    v_mfma_f32_16x16x32_bf16 v[84:87], v[132:135], v[196:199], v[84:87]
    buffer_load_dwordx4 v5, s[20:23], s40 offen offset:2048 sc1 lds
    v_mfma_f32_16x16x32_bf16 v[84:87], v[148:151], v[212:215], v[84:87]
    ds_read_b128 v[244:247], v9 offset:50176
    v_mfma_f32_16x16x32_bf16 v[88:91], v[132:135], v[200:203], v[88:91]
    ds_read_b128 v[168:171], v12 offset:51200
    v_mfma_f32_16x16x32_bf16 v[88:91], v[148:151], v[216:219], v[88:91]
    s_xor_b32 s41, s52, 147456
    buffer_load_dwordx4 v5, s[20:23], s40 offen offset:3072 sc1 lds
    v_mfma_f32_16x16x32_bf16 v[92:95], v[132:135], v[204:207], v[92:95]
    s_add_u32 s41, s41, s35
    ds_read_b128 v[184:187], v12 offset:59392
    v_mfma_f32_16x16x32_bf16 v[92:95], v[148:151], v[220:223], v[92:95]
    s_add_u32 m0, s36, 16384
    ds_read_b128 v[232:235], v10 offset:49152
    v_mfma_f32_16x16x32_bf16 v[96:99], v[136:139], v[192:195], v[96:99]
    buffer_load_dwordx4 v13, s[20:23], s41 offen offset:0 sc1 lds
    v_mfma_f32_16x16x32_bf16 v[96:99], v[152:155], v[208:211], v[96:99]
    ds_read_b128 v[248:251], v10 offset:50176
    v_mfma_f32_16x16x32_bf16 v[100:103], v[136:139], v[196:199], v[100:103]
    ds_read_b128 v[172:175], v12 offset:52224
    v_mfma_f32_16x16x32_bf16 v[100:103], v[152:155], v[212:215], v[100:103]
    buffer_load_dwordx4 v13, s[20:23], s41 offen offset:1024 sc1 lds
    v_mfma_f32_16x16x32_bf16 v[104:107], v[136:139], v[200:203], v[104:107]
    ds_read_b128 v[188:191], v12 offset:60416
    v_mfma_f32_16x16x32_bf16 v[104:107], v[152:155], v[216:219], v[104:107]
    ds_read_b128 v[236:239], v11 offset:49152
    v_mfma_f32_16x16x32_bf16 v[108:111], v[136:139], v[204:207], v[108:111]
    buffer_load_dwordx4 v13, s[20:23], s41 offen offset:2048 sc1 lds
    v_mfma_f32_16x16x32_bf16 v[108:111], v[152:155], v[220:223], v[108:111]
    ds_read_b128 v[252:255], v11 offset:50176
    v_mfma_f32_16x16x32_bf16 v[112:115], v[140:143], v[192:195], v[112:115]
    v_mfma_f32_16x16x32_bf16 v[112:115], v[156:159], v[208:211], v[112:115]
    buffer_load_dwordx4 v13, s[20:23], s41 offen offset:3072 sc1 lds
    v_mfma_f32_16x16x32_bf16 v[116:119], v[140:143], v[196:199], v[116:119]
    v_mfma_f32_16x16x32_bf16 v[116:119], v[156:159], v[212:215], v[116:119]
    v_mfma_f32_16x16x32_bf16 v[120:123], v[140:143], v[200:203], v[120:123]
    v_mfma_f32_16x16x32_bf16 v[120:123], v[156:159], v[216:219], v[120:123]
    v_mfma_f32_16x16x32_bf16 v[124:127], v[140:143], v[204:207], v[124:127]
    v_mfma_f32_16x16x32_bf16 v[124:127], v[156:159], v[220:223], v[124:127]
    s_waitcnt lgkmcnt(0)
    v_mfma_f32_16x16x32_bf16 v[64:67], v[160:163], v[224:227], v[64:67]
    s_waitcnt vmcnt(8)
    s_barrier
    v_mfma_f32_16x16x32_bf16 v[64:67], v[176:179], v[240:243], v[64:67]
    s_xor_b32 s40, s51, 20480
    ds_read_b128 v[128:131], v12 offset:0
    v_mfma_f32_16x16x32_bf16 v[68:71], v[160:163], v[228:231], v[68:71]
    s_add_u32 s40, s40, s34
    ds_read_b128 v[144:147], v12 offset:8192
    v_mfma_f32_16x16x32_bf16 v[68:71], v[176:179], v[244:247], v[68:71]
    s_add_u32 m0, s43, 32768
    ds_read_b128 v[192:195], v8 offset:0
    v_mfma_f32_16x16x32_bf16 v[72:75], v[160:163], v[232:235], v[72:75]
    buffer_load_dwordx4 v4, s[20:23], s40 offen offset:0 sc1 lds
    v_mfma_f32_16x16x32_bf16 v[72:75], v[176:179], v[248:251], v[72:75]
    ds_read_b128 v[208:211], v8 offset:1024
    v_mfma_f32_16x16x32_bf16 v[76:79], v[160:163], v[236:239], v[76:79]
    ds_read_b128 v[132:135], v12 offset:1024
    v_mfma_f32_16x16x32_bf16 v[76:79], v[176:179], v[252:255], v[76:79]
    buffer_load_dwordx4 v4, s[20:23], s40 offen offset:1024 sc1 lds
    v_mfma_f32_16x16x32_bf16 v[80:83], v[164:167], v[224:227], v[80:83]
    ds_read_b128 v[148:151], v12 offset:9216
    v_mfma_f32_16x16x32_bf16 v[80:83], v[180:183], v[240:243], v[80:83]
    ds_read_b128 v[196:199], v9 offset:0
    v_mfma_f32_16x16x32_bf16 v[84:87], v[164:167], v[228:231], v[84:87]
    buffer_load_dwordx4 v5, s[20:23], s40 offen offset:2048 sc1 lds
    v_mfma_f32_16x16x32_bf16 v[84:87], v[180:183], v[244:247], v[84:87]
    ds_read_b128 v[212:215], v9 offset:1024
    v_mfma_f32_16x16x32_bf16 v[88:91], v[164:167], v[232:235], v[88:91]
    ds_read_b128 v[136:139], v12 offset:2048
    v_mfma_f32_16x16x32_bf16 v[88:91], v[180:183], v[248:251], v[88:91]
    s_xor_b32 s41, s52, 163840
    buffer_load_dwordx4 v5, s[20:23], s40 offen offset:3072 sc1 lds
    v_mfma_f32_16x16x32_bf16 v[92:95], v[164:167], v[236:239], v[92:95]
    s_add_u32 s41, s41, s35
    ds_read_b128 v[152:155], v12 offset:10240
    v_mfma_f32_16x16x32_bf16 v[92:95], v[180:183], v[252:255], v[92:95]
    s_add_u32 m0, s36, 32768
    ds_read_b128 v[200:203], v10 offset:0
    v_mfma_f32_16x16x32_bf16 v[96:99], v[168:171], v[224:227], v[96:99]
    buffer_load_dwordx4 v13, s[20:23], s41 offen offset:0 sc1 lds
    v_mfma_f32_16x16x32_bf16 v[96:99], v[184:187], v[240:243], v[96:99]
    ds_read_b128 v[216:219], v10 offset:1024
    v_mfma_f32_16x16x32_bf16 v[100:103], v[168:171], v[228:231], v[100:103]
    ds_read_b128 v[140:143], v12 offset:3072
    v_mfma_f32_16x16x32_bf16 v[100:103], v[184:187], v[244:247], v[100:103]
    buffer_load_dwordx4 v13, s[20:23], s41 offen offset:1024 sc1 lds
    v_mfma_f32_16x16x32_bf16 v[104:107], v[168:171], v[232:235], v[104:107]
    ds_read_b128 v[156:159], v12 offset:11264
    v_mfma_f32_16x16x32_bf16 v[104:107], v[184:187], v[248:251], v[104:107]
    ds_read_b128 v[204:207], v11 offset:0
    v_mfma_f32_16x16x32_bf16 v[108:111], v[168:171], v[236:239], v[108:111]
    buffer_load_dwordx4 v13, s[20:23], s41 offen offset:2048 sc1 lds
    v_mfma_f32_16x16x32_bf16 v[108:111], v[184:187], v[252:255], v[108:111]
    ds_read_b128 v[220:223], v11 offset:1024
    v_mfma_f32_16x16x32_bf16 v[112:115], v[172:175], v[224:227], v[112:115]
    v_mfma_f32_16x16x32_bf16 v[112:115], v[188:191], v[240:243], v[112:115]
    buffer_load_dwordx4 v13, s[20:23], s41 offen offset:3072 sc1 lds
    v_mfma_f32_16x16x32_bf16 v[116:119], v[172:175], v[228:231], v[116:119]
    v_mfma_f32_16x16x32_bf16 v[116:119], v[188:191], v[244:247], v[116:119]
    v_mfma_f32_16x16x32_bf16 v[120:123], v[172:175], v[232:235], v[120:123]
    v_mfma_f32_16x16x32_bf16 v[120:123], v[188:191], v[248:251], v[120:123]
    v_mfma_f32_16x16x32_bf16 v[124:127], v[172:175], v[236:239], v[124:127]
    v_mfma_f32_16x16x32_bf16 v[124:127], v[188:191], v[252:255], v[124:127]
    s_waitcnt lgkmcnt(0)
    v_mfma_f32_16x16x32_bf16 v[64:67], v[128:131], v[192:195], v[64:67]
    s_waitcnt vmcnt(8)
    s_barrier
    v_mfma_f32_16x16x32_bf16 v[64:67], v[144:147], v[208:211], v[64:67]
    s_xor_b32 s40, s51, 22528
    ds_read_b128 v[160:163], v12 offset:16384
    v_mfma_f32_16x16x32_bf16 v[68:71], v[128:131], v[196:199], v[68:71]
    s_add_u32 s40, s40, s34
    ds_read_b128 v[176:179], v12 offset:24576
    v_mfma_f32_16x16x32_bf16 v[68:71], v[144:147], v[212:215], v[68:71]
    s_add_u32 m0, s43, 49152
    ds_read_b128 v[224:227], v8 offset:16384
    v_mfma_f32_16x16x32_bf16 v[72:75], v[128:131], v[200:203], v[72:75]
    buffer_load_dwordx4 v4, s[20:23], s40 offen offset:0 sc1 lds
    v_mfma_f32_16x16x32_bf16 v[72:75], v[144:147], v[216:219], v[72:75]
    ds_read_b128 v[240:243], v8 offset:17408
    v_mfma_f32_16x16x32_bf16 v[76:79], v[128:131], v[204:207], v[76:79]
    ds_read_b128 v[164:167], v12 offset:17408
    v_mfma_f32_16x16x32_bf16 v[76:79], v[144:147], v[220:223], v[76:79]
    buffer_load_dwordx4 v4, s[20:23], s40 offen offset:1024 sc1 lds
    v_mfma_f32_16x16x32_bf16 v[80:83], v[132:135], v[192:195], v[80:83]
    ds_read_b128 v[180:183], v12 offset:25600
    v_mfma_f32_16x16x32_bf16 v[80:83], v[148:151], v[208:211], v[80:83]
    ds_read_b128 v[228:231], v9 offset:16384
    v_mfma_f32_16x16x32_bf16 v[84:87], v[132:135], v[196:199], v[84:87]
    buffer_load_dwordx4 v5, s[20:23], s40 offen offset:2048 sc1 lds
    v_mfma_f32_16x16x32_bf16 v[84:87], v[148:151], v[212:215], v[84:87]
    ds_read_b128 v[244:247], v9 offset:17408
    v_mfma_f32_16x16x32_bf16 v[88:91], v[132:135], v[200:203], v[88:91]
    ds_read_b128 v[168:171], v12 offset:18432
    v_mfma_f32_16x16x32_bf16 v[88:91], v[148:151], v[216:219], v[88:91]
    s_xor_b32 s41, s52, 180224
    buffer_load_dwordx4 v5, s[20:23], s40 offen offset:3072 sc1 lds
    v_mfma_f32_16x16x32_bf16 v[92:95], v[132:135], v[204:207], v[92:95]
    s_add_u32 s41, s41, s35
    ds_read_b128 v[184:187], v12 offset:26624
    v_mfma_f32_16x16x32_bf16 v[92:95], v[148:151], v[220:223], v[92:95]
    s_add_u32 m0, s36, 49152
    ds_read_b128 v[232:235], v10 offset:16384
    v_mfma_f32_16x16x32_bf16 v[96:99], v[136:139], v[192:195], v[96:99]
    buffer_load_dwordx4 v13, s[20:23], s41 offen offset:0 sc1 lds
    v_mfma_f32_16x16x32_bf16 v[96:99], v[152:155], v[208:211], v[96:99]
    ds_read_b128 v[248:251], v10 offset:17408
    v_mfma_f32_16x16x32_bf16 v[100:103], v[136:139], v[196:199], v[100:103]
    ds_read_b128 v[172:175], v12 offset:19456
    v_mfma_f32_16x16x32_bf16 v[100:103], v[152:155], v[212:215], v[100:103]
    buffer_load_dwordx4 v13, s[20:23], s41 offen offset:1024 sc1 lds
    v_mfma_f32_16x16x32_bf16 v[104:107], v[136:139], v[200:203], v[104:107]
    ds_read_b128 v[188:191], v12 offset:27648
    v_mfma_f32_16x16x32_bf16 v[104:107], v[152:155], v[216:219], v[104:107]
    ds_read_b128 v[236:239], v11 offset:16384
    v_mfma_f32_16x16x32_bf16 v[108:111], v[136:139], v[204:207], v[108:111]
    buffer_load_dwordx4 v13, s[20:23], s41 offen offset:2048 sc1 lds
    v_mfma_f32_16x16x32_bf16 v[108:111], v[152:155], v[220:223], v[108:111]
    ds_read_b128 v[252:255], v11 offset:17408
    v_mfma_f32_16x16x32_bf16 v[112:115], v[140:143], v[192:195], v[112:115]
    v_mfma_f32_16x16x32_bf16 v[112:115], v[156:159], v[208:211], v[112:115]
    buffer_load_dwordx4 v13, s[20:23], s41 offen offset:3072 sc1 lds
    v_mfma_f32_16x16x32_bf16 v[116:119], v[140:143], v[196:199], v[116:119]
    v_mfma_f32_16x16x32_bf16 v[116:119], v[156:159], v[212:215], v[116:119]
    v_mfma_f32_16x16x32_bf16 v[120:123], v[140:143], v[200:203], v[120:123]
    v_mfma_f32_16x16x32_bf16 v[120:123], v[156:159], v[216:219], v[120:123]
    v_mfma_f32_16x16x32_bf16 v[124:127], v[140:143], v[204:207], v[124:127]
    v_mfma_f32_16x16x32_bf16 v[124:127], v[156:159], v[220:223], v[124:127]
    s_waitcnt lgkmcnt(0)
    v_mfma_f32_16x16x32_bf16 v[64:67], v[160:163], v[224:227], v[64:67]
    s_waitcnt vmcnt(8)
    s_barrier
    v_mfma_f32_16x16x32_bf16 v[64:67], v[176:179], v[240:243], v[64:67]
    s_xor_b32 s40, s51, 24576
    ds_read_b128 v[128:131], v12 offset:32768
    v_mfma_f32_16x16x32_bf16 v[68:71], v[160:163], v[228:231], v[68:71]
    s_add_u32 s40, s40, s34
    ds_read_b128 v[144:147], v12 offset:40960
    v_mfma_f32_16x16x32_bf16 v[68:71], v[176:179], v[244:247], v[68:71]
    s_add_u32 m0, s43, 0
    ds_read_b128 v[192:195], v8 offset:32768
    v_mfma_f32_16x16x32_bf16 v[72:75], v[160:163], v[232:235], v[72:75]
    buffer_load_dwordx4 v4, s[20:23], s40 offen offset:0 sc1 lds
    v_mfma_f32_16x16x32_bf16 v[72:75], v[176:179], v[248:251], v[72:75]
    ds_read_b128 v[208:211], v8 offset:33792
    v_mfma_f32_16x16x32_bf16 v[76:79], v[160:163], v[236:239], v[76:79]
    ds_read_b128 v[132:135], v12 offset:33792
    v_mfma_f32_16x16x32_bf16 v[76:79], v[176:179], v[252:255], v[76:79]
    buffer_load_dwordx4 v4, s[20:23], s40 offen offset:1024 sc1 lds
    v_mfma_f32_16x16x32_bf16 v[80:83], v[164:167], v[224:227], v[80:83]
    ds_read_b128 v[148:151], v12 offset:41984
    v_mfma_f32_16x16x32_bf16 v[80:83], v[180:183], v[240:243], v[80:83]
    ds_read_b128 v[196:199], v9 offset:32768
    v_mfma_f32_16x16x32_bf16 v[84:87], v[164:167], v[228:231], v[84:87]
    buffer_load_dwordx4 v5, s[20:23], s40 offen offset:2048 sc1 lds
    v_mfma_f32_16x16x32_bf16 v[84:87], v[180:183], v[244:247], v[84:87]
    ds_read_b128 v[212:215], v9 offset:33792
    v_mfma_f32_16x16x32_bf16 v[88:91], v[164:167], v[232:235], v[88:91]
    ds_read_b128 v[136:139], v12 offset:34816
    v_mfma_f32_16x16x32_bf16 v[88:91], v[180:183], v[248:251], v[88:91]
    s_xor_b32 s41, s52, 196608
    buffer_load_dwordx4 v5, s[20:23], s40 offen offset:3072 sc1 lds
    v_mfma_f32_16x16x32_bf16 v[92:95], v[164:167], v[236:239], v[92:95]
    s_add_u32 s41, s41, s35
    ds_read_b128 v[152:155], v12 offset:43008
    v_mfma_f32_16x16x32_bf16 v[92:95], v[180:183], v[252:255], v[92:95]
    s_add_u32 m0, s36, 0
    ds_read_b128 v[200:203], v10 offset:32768
    v_mfma_f32_16x16x32_bf16 v[96:99], v[168:171], v[224:227], v[96:99]
    buffer_load_dwordx4 v13, s[20:23], s41 offen offset:0 sc1 lds
    v_mfma_f32_16x16x32_bf16 v[96:99], v[184:187], v[240:243], v[96:99]
    ds_read_b128 v[216:219], v10 offset:33792
    v_mfma_f32_16x16x32_bf16 v[100:103], v[168:171], v[228:231], v[100:103]
    ds_read_b128 v[140:143], v12 offset:35840
    v_mfma_f32_16x16x32_bf16 v[100:103], v[184:187], v[244:247], v[100:103]
    buffer_load_dwordx4 v13, s[20:23], s41 offen offset:1024 sc1 lds
    v_mfma_f32_16x16x32_bf16 v[104:107], v[168:171], v[232:235], v[104:107]
    ds_read_b128 v[156:159], v12 offset:44032
    v_mfma_f32_16x16x32_bf16 v[104:107], v[184:187], v[248:251], v[104:107]
    ds_read_b128 v[204:207], v11 offset:32768
    v_mfma_f32_16x16x32_bf16 v[108:111], v[168:171], v[236:239], v[108:111]
    buffer_load_dwordx4 v13, s[20:23], s41 offen offset:2048 sc1 lds
    v_mfma_f32_16x16x32_bf16 v[108:111], v[184:187], v[252:255], v[108:111]
    ds_read_b128 v[220:223], v11 offset:33792
    v_mfma_f32_16x16x32_bf16 v[112:115], v[172:175], v[224:227], v[112:115]
    v_mfma_f32_16x16x32_bf16 v[112:115], v[188:191], v[240:243], v[112:115]
    buffer_load_dwordx4 v13, s[20:23], s41 offen offset:3072 sc1 lds
    v_mfma_f32_16x16x32_bf16 v[116:119], v[172:175], v[228:231], v[116:119]
    v_mfma_f32_16x16x32_bf16 v[116:119], v[188:191], v[244:247], v[116:119]
    v_mfma_f32_16x16x32_bf16 v[120:123], v[172:175], v[232:235], v[120:123]
    v_mfma_f32_16x16x32_bf16 v[120:123], v[188:191], v[248:251], v[120:123]
    v_mfma_f32_16x16x32_bf16 v[124:127], v[172:175], v[236:239], v[124:127]
    v_mfma_f32_16x16x32_bf16 v[124:127], v[188:191], v[252:255], v[124:127]
    s_waitcnt lgkmcnt(0)
    v_mfma_f32_16x16x32_bf16 v[64:67], v[128:131], v[192:195], v[64:67]
    s_waitcnt vmcnt(8)
    s_barrier
    v_mfma_f32_16x16x32_bf16 v[64:67], v[144:147], v[208:211], v[64:67]
    s_xor_b32 s40, s51, 26624
    ds_read_b128 v[160:163], v12 offset:49152
    v_mfma_f32_16x16x32_bf16 v[68:71], v[128:131], v[196:199], v[68:71]
    s_add_u32 s40, s40, s34
    ds_read_b128 v[176:179], v12 offset:57344
    v_mfma_f32_16x16x32_bf16 v[68:71], v[144:147], v[212:215], v[68:71]
    s_add_u32 m0, s43, 16384
    ds_read_b128 v[224:227], v8 offset:49152
    v_mfma_f32_16x16x32_bf16 v[72:75], v[128:131], v[200:203], v[72:75]
    buffer_load_dwordx4 v4, s[20:23], s40 offen offset:0 sc1 lds
    v_mfma_f32_16x16x32_bf16 v[72:75], v[144:147], v[216:219], v[72:75]
    ds_read_b128 v[240:243], v8 offset:50176
    v_mfma_f32_16x16x32_bf16 v[76:79], v[128:131], v[204:207], v[76:79]
    ds_read_b128 v[164:167], v12 offset:50176
    v_mfma_f32_16x16x32_bf16 v[76:79], v[144:147], v[220:223], v[76:79]
    buffer_load_dwordx4 v4, s[20:23], s40 offen offset:1024 sc1 lds
    v_mfma_f32_16x16x32_bf16 v[80:83], v[132:135], v[192:195], v[80:83]
    ds_read_b128 v[180:183], v12 offset:58368
    v_mfma_f32_16x16x32_bf16 v[80:83], v[148:151], v[208:211], v[80:83]
    ds_read_b128 v[228:231], v9 offset:49152
    v_mfma_f32_16x16x32_bf16 v[84:87], v[132:135], v[196:199], v[84:87]
    buffer_load_dwordx4 v5, s[20:23], s40 offen offset:2048 sc1 lds
    v_mfma_f32_16x16x32_bf16 v[84:87], v[148:151], v[212:215], v[84:87]
    ds_read_b128 v[244:247], v9 offset:50176
    v_mfma_f32_16x16x32_bf16 v[88:91], v[132:135], v[200:203], v[88:91]
    ds_read_b128 v[168:171], v12 offset:51200
    v_mfma_f32_16x16x32_bf16 v[88:91], v[148:151], v[216:219], v[88:91]
    s_xor_b32 s41, s52, 212992
    buffer_load_dwordx4 v5, s[20:23], s40 offen offset:3072 sc1 lds
    v_mfma_f32_16x16x32_bf16 v[92:95], v[132:135], v[204:207], v[92:95]
    s_add_u32 s41, s41, s35
    ds_read_b128 v[184:187], v12 offset:59392
    v_mfma_f32_16x16x32_bf16 v[92:95], v[148:151], v[220:223], v[92:95]
    s_add_u32 m0, s36, 16384
    ds_read_b128 v[232:235], v10 offset:49152
    v_mfma_f32_16x16x32_bf16 v[96:99], v[136:139], v[192:195], v[96:99]
    buffer_load_dwordx4 v13, s[20:23], s41 offen offset:0 sc1 lds
    v_mfma_f32_16x16x32_bf16 v[96:99], v[152:155], v[208:211], v[96:99]
    ds_read_b128 v[248:251], v10 offset:50176
    v_mfma_f32_16x16x32_bf16 v[100:103], v[136:139], v[196:199], v[100:103]
    ds_read_b128 v[172:175], v12 offset:52224
    v_mfma_f32_16x16x32_bf16 v[100:103], v[152:155], v[212:215], v[100:103]
    buffer_load_dwordx4 v13, s[20:23], s41 offen offset:1024 sc1 lds
    v_mfma_f32_16x16x32_bf16 v[104:107], v[136:139], v[200:203], v[104:107]
    ds_read_b128 v[188:191], v12 offset:60416
    v_mfma_f32_16x16x32_bf16 v[104:107], v[152:155], v[216:219], v[104:107]
    ds_read_b128 v[236:239], v11 offset:49152
    v_mfma_f32_16x16x32_bf16 v[108:111], v[136:139], v[204:207], v[108:111]
    buffer_load_dwordx4 v13, s[20:23], s41 offen offset:2048 sc1 lds
    v_mfma_f32_16x16x32_bf16 v[108:111], v[152:155], v[220:223], v[108:111]
    ds_read_b128 v[252:255], v11 offset:50176
    v_mfma_f32_16x16x32_bf16 v[112:115], v[140:143], v[192:195], v[112:115]
    v_mfma_f32_16x16x32_bf16 v[112:115], v[156:159], v[208:211], v[112:115]
    buffer_load_dwordx4 v13, s[20:23], s41 offen offset:3072 sc1 lds
    v_mfma_f32_16x16x32_bf16 v[116:119], v[140:143], v[196:199], v[116:119]
    v_mfma_f32_16x16x32_bf16 v[116:119], v[156:159], v[212:215], v[116:119]
    v_mfma_f32_16x16x32_bf16 v[120:123], v[140:143], v[200:203], v[120:123]
    v_mfma_f32_16x16x32_bf16 v[120:123], v[156:159], v[216:219], v[120:123]
    v_mfma_f32_16x16x32_bf16 v[124:127], v[140:143], v[204:207], v[124:127]
    v_mfma_f32_16x16x32_bf16 v[124:127], v[156:159], v[220:223], v[124:127]
    s_waitcnt lgkmcnt(0)
    v_mfma_f32_16x16x32_bf16 v[64:67], v[160:163], v[224:227], v[64:67]
    s_waitcnt vmcnt(8)
    s_barrier
    v_mfma_f32_16x16x32_bf16 v[64:67], v[176:179], v[240:243], v[64:67]
    s_xor_b32 s40, s51, 28672
    ds_read_b128 v[128:131], v12 offset:0
    v_mfma_f32_16x16x32_bf16 v[68:71], v[160:163], v[228:231], v[68:71]
    s_add_u32 s40, s40, s34
    ds_read_b128 v[144:147], v12 offset:8192
    v_mfma_f32_16x16x32_bf16 v[68:71], v[176:179], v[244:247], v[68:71]
    s_add_u32 m0, s43, 32768
    ds_read_b128 v[192:195], v8 offset:0
    v_mfma_f32_16x16x32_bf16 v[72:75], v[160:163], v[232:235], v[72:75]
    buffer_load_dwordx4 v4, s[20:23], s40 offen offset:0 sc1 lds
    v_mfma_f32_16x16x32_bf16 v[72:75], v[176:179], v[248:251], v[72:75]
    ds_read_b128 v[208:211], v8 offset:1024
    v_mfma_f32_16x16x32_bf16 v[76:79], v[160:163], v[236:239], v[76:79]
    ds_read_b128 v[132:135], v12 offset:1024
    v_mfma_f32_16x16x32_bf16 v[76:79], v[176:179], v[252:255], v[76:79]
    buffer_load_dwordx4 v4, s[20:23], s40 offen offset:1024 sc1 lds
    v_mfma_f32_16x16x32_bf16 v[80:83], v[164:167], v[224:227], v[80:83]
    ds_read_b128 v[148:151], v12 offset:9216
    v_mfma_f32_16x16x32_bf16 v[80:83], v[180:183], v[240:243], v[80:83]
    ds_read_b128 v[196:199], v9 offset:0
    v_mfma_f32_16x16x32_bf16 v[84:87], v[164:167], v[228:231], v[84:87]
    buffer_load_dwordx4 v5, s[20:23], s40 offen offset:2048 sc1 lds
    v_mfma_f32_16x16x32_bf16 v[84:87], v[180:183], v[244:247], v[84:87]
    ds_read_b128 v[212:215], v9 offset:1024
    v_mfma_f32_16x16x32_bf16 v[88:91], v[164:167], v[232:235], v[88:91]
    ds_read_b128 v[136:139], v12 offset:2048
    v_mfma_f32_16x16x32_bf16 v[88:91], v[180:183], v[248:251], v[88:91]
    s_xor_b32 s41, s52, 229376
    buffer_load_dwordx4 v5, s[20:23], s40 offen offset:3072 sc1 lds
    v_mfma_f32_16x16x32_bf16 v[92:95], v[164:167], v[236:239], v[92:95]
    s_add_u32 s41, s41, s35
    ds_read_b128 v[152:155], v12 offset:10240
    v_mfma_f32_16x16x32_bf16 v[92:95], v[180:183], v[252:255], v[92:95]
    s_add_u32 m0, s36, 32768
    ds_read_b128 v[200:203], v10 offset:0
    v_mfma_f32_16x16x32_bf16 v[96:99], v[168:171], v[224:227], v[96:99]
    buffer_load_dwordx4 v13, s[20:23], s41 offen offset:0 sc1 lds
    v_mfma_f32_16x16x32_bf16 v[96:99], v[184:187], v[240:243], v[96:99]
    ds_read_b128 v[216:219], v10 offset:1024
    v_mfma_f32_16x16x32_bf16 v[100:103], v[168:171], v[228:231], v[100:103]
    ds_read_b128 v[140:143], v12 offset:3072
    v_mfma_f32_16x16x32_bf16 v[100:103], v[184:187], v[244:247], v[100:103]
    buffer_load_dwordx4 v13, s[20:23], s41 offen offset:1024 sc1 lds
    v_mfma_f32_16x16x32_bf16 v[104:107], v[168:171], v[232:235], v[104:107]
    ds_read_b128 v[156:159], v12 offset:11264
    v_mfma_f32_16x16x32_bf16 v[104:107], v[184:187], v[248:251], v[104:107]
    ds_read_b128 v[204:207], v11 offset:0
    v_mfma_f32_16x16x32_bf16 v[108:111], v[168:171], v[236:239], v[108:111]
    buffer_load_dwordx4 v13, s[20:23], s41 offen offset:2048 sc1 lds
    v_mfma_f32_16x16x32_bf16 v[108:111], v[184:187], v[252:255], v[108:111]
    ds_read_b128 v[220:223], v11 offset:1024
    v_mfma_f32_16x16x32_bf16 v[112:115], v[172:175], v[224:227], v[112:115]
    v_mfma_f32_16x16x32_bf16 v[112:115], v[188:191], v[240:243], v[112:115]
    buffer_load_dwordx4 v13, s[20:23], s41 offen offset:3072 sc1 lds
    v_mfma_f32_16x16x32_bf16 v[116:119], v[172:175], v[228:231], v[116:119]
    v_mfma_f32_16x16x32_bf16 v[116:119], v[188:191], v[244:247], v[116:119]
    v_mfma_f32_16x16x32_bf16 v[120:123], v[172:175], v[232:235], v[120:123]
    v_mfma_f32_16x16x32_bf16 v[120:123], v[188:191], v[248:251], v[120:123]
    v_mfma_f32_16x16x32_bf16 v[124:127], v[172:175], v[236:239], v[124:127]
    v_mfma_f32_16x16x32_bf16 v[124:127], v[188:191], v[252:255], v[124:127]
    s_waitcnt lgkmcnt(0)
    v_mfma_f32_16x16x32_bf16 v[64:67], v[128:131], v[192:195], v[64:67]
    s_waitcnt vmcnt(8)
    s_barrier
    v_mfma_f32_16x16x32_bf16 v[64:67], v[144:147], v[208:211], v[64:67]
    s_xor_b32 s40, s51, 30720
    ds_read_b128 v[160:163], v12 offset:16384
    v_mfma_f32_16x16x32_bf16 v[68:71], v[128:131], v[196:199], v[68:71]
    s_add_u32 s40, s40, s34
    ds_read_b128 v[176:179], v12 offset:24576
    v_mfma_f32_16x16x32_bf16 v[68:71], v[144:147], v[212:215], v[68:71]
    s_add_u32 m0, s43, 49152
    ds_read_b128 v[224:227], v8 offset:16384
    v_mfma_f32_16x16x32_bf16 v[72:75], v[128:131], v[200:203], v[72:75]
    buffer_load_dwordx4 v4, s[20:23], s40 offen offset:0 sc1 lds
    v_mfma_f32_16x16x32_bf16 v[72:75], v[144:147], v[216:219], v[72:75]
    ds_read_b128 v[240:243], v8 offset:17408
    v_mfma_f32_16x16x32_bf16 v[76:79], v[128:131], v[204:207], v[76:79]
    ds_read_b128 v[164:167], v12 offset:17408
    v_mfma_f32_16x16x32_bf16 v[76:79], v[144:147], v[220:223], v[76:79]
    buffer_load_dwordx4 v4, s[20:23], s40 offen offset:1024 sc1 lds
    v_mfma_f32_16x16x32_bf16 v[80:83], v[132:135], v[192:195], v[80:83]
    ds_read_b128 v[180:183], v12 offset:25600
    v_mfma_f32_16x16x32_bf16 v[80:83], v[148:151], v[208:211], v[80:83]
    ds_read_b128 v[228:231], v9 offset:16384
    v_mfma_f32_16x16x32_bf16 v[84:87], v[132:135], v[196:199], v[84:87]
    buffer_load_dwordx4 v5, s[20:23], s40 offen offset:2048 sc1 lds
    v_mfma_f32_16x16x32_bf16 v[84:87], v[148:151], v[212:215], v[84:87]
    ds_read_b128 v[244:247], v9 offset:17408
    v_mfma_f32_16x16x32_bf16 v[88:91], v[132:135], v[200:203], v[88:91]
    ds_read_b128 v[168:171], v12 offset:18432
    v_mfma_f32_16x16x32_bf16 v[88:91], v[148:151], v[216:219], v[88:91]
    s_xor_b32 s41, s52, 245760
    buffer_load_dwordx4 v5, s[20:23], s40 offen offset:3072 sc1 lds
    v_mfma_f32_16x16x32_bf16 v[92:95], v[132:135], v[204:207], v[92:95]
    s_add_u32 s41, s41, s35
    ds_read_b128 v[184:187], v12 offset:26624
    v_mfma_f32_16x16x32_bf16 v[92:95], v[148:151], v[220:223], v[92:95]
    s_add_u32 m0, s36, 49152
    ds_read_b128 v[232:235], v10 offset:16384
    v_mfma_f32_16x16x32_bf16 v[96:99], v[136:139], v[192:195], v[96:99]
    buffer_load_dwordx4 v13, s[20:23], s41 offen offset:0 sc1 lds
    v_mfma_f32_16x16x32_bf16 v[96:99], v[152:155], v[208:211], v[96:99]
    ds_read_b128 v[248:251], v10 offset:17408
    v_mfma_f32_16x16x32_bf16 v[100:103], v[136:139], v[196:199], v[100:103]
    ds_read_b128 v[172:175], v12 offset:19456
    v_mfma_f32_16x16x32_bf16 v[100:103], v[152:155], v[212:215], v[100:103]
    buffer_load_dwordx4 v13, s[20:23], s41 offen offset:1024 sc1 lds
    v_mfma_f32_16x16x32_bf16 v[104:107], v[136:139], v[200:203], v[104:107]
    ds_read_b128 v[188:191], v12 offset:27648
    v_mfma_f32_16x16x32_bf16 v[104:107], v[152:155], v[216:219], v[104:107]
    ds_read_b128 v[236:239], v11 offset:16384
    v_mfma_f32_16x16x32_bf16 v[108:111], v[136:139], v[204:207], v[108:111]
    buffer_load_dwordx4 v13, s[20:23], s41 offen offset:2048 sc1 lds
    v_mfma_f32_16x16x32_bf16 v[108:111], v[152:155], v[220:223], v[108:111]
    ds_read_b128 v[252:255], v11 offset:17408
    v_mfma_f32_16x16x32_bf16 v[112:115], v[140:143], v[192:195], v[112:115]
    v_mfma_f32_16x16x32_bf16 v[112:115], v[156:159], v[208:211], v[112:115]
    buffer_load_dwordx4 v13, s[20:23], s41 offen offset:3072 sc1 lds
    v_mfma_f32_16x16x32_bf16 v[116:119], v[140:143], v[196:199], v[116:119]
    v_mfma_f32_16x16x32_bf16 v[116:119], v[156:159], v[212:215], v[116:119]
    s_add_u32 s37, s46, 0
    v_mfma_f32_16x16x32_bf16 v[120:123], v[140:143], v[200:203], v[120:123]
    buffer_load_dwordx4 a[64:67], v2, s[20:23], s37 offen offset:0 sc1
    v_mfma_f32_16x16x32_bf16 v[120:123], v[156:159], v[216:219], v[120:123]
    v_mfma_f32_16x16x32_bf16 v[124:127], v[140:143], v[204:207], v[124:127]
    buffer_load_dwordx4 a[68:71], v2, s[20:23], s37 offen offset:1024 sc1
    v_mfma_f32_16x16x32_bf16 v[124:127], v[156:159], v[220:223], v[124:127]
    s_waitcnt lgkmcnt(0)
    v_mfma_f32_16x16x32_bf16 v[64:67], v[160:163], v[224:227], v[64:67]
    s_waitcnt vmcnt(10)
    s_barrier
    v_mfma_f32_16x16x32_bf16 v[64:67], v[176:179], v[240:243], v[64:67]
    ds_read_b128 v[128:131], v12 offset:32768
    v_mfma_f32_16x16x32_bf16 v[68:71], v[160:163], v[228:231], v[68:71]
    ds_read_b128 v[144:147], v12 offset:40960
    v_mfma_f32_16x16x32_bf16 v[68:71], v[176:179], v[244:247], v[68:71]
    ds_read_b128 v[192:195], v8 offset:32768
    v_mfma_f32_16x16x32_bf16 v[72:75], v[160:163], v[232:235], v[72:75]
    buffer_load_dwordx4 a[72:75], v2, s[20:23], s37 offen offset:2048 sc1
    v_mfma_f32_16x16x32_bf16 v[72:75], v[176:179], v[248:251], v[72:75]
    ds_read_b128 v[208:211], v8 offset:33792
    v_mfma_f32_16x16x32_bf16 v[76:79], v[160:163], v[236:239], v[76:79]
    ds_read_b128 v[132:135], v12 offset:33792
    v_mfma_f32_16x16x32_bf16 v[76:79], v[176:179], v[252:255], v[76:79]
    buffer_load_dwordx4 a[76:79], v2, s[20:23], s37 offen offset:3072 sc1
    v_mfma_f32_16x16x32_bf16 v[80:83], v[164:167], v[224:227], v[80:83]
    ds_read_b128 v[148:151], v12 offset:41984
    v_mfma_f32_16x16x32_bf16 v[80:83], v[180:183], v[240:243], v[80:83]
    s_add_u32 s37, s45, 0
    ds_read_b128 v[196:199], v9 offset:32768
    v_mfma_f32_16x16x32_bf16 v[84:87], v[164:167], v[228:231], v[84:87]
    buffer_load_dwordx4 a[128:131], v2, s[20:23], s37 offen offset:0 sc1
    v_mfma_f32_16x16x32_bf16 v[84:87], v[180:183], v[244:247], v[84:87]
    ds_read_b128 v[212:215], v9 offset:33792
    v_mfma_f32_16x16x32_bf16 v[88:91], v[164:167], v[232:235], v[88:91]
    s_add_u32 s37, s45, 16384
    ds_read_b128 v[136:139], v12 offset:34816
    v_mfma_f32_16x16x32_bf16 v[88:91], v[180:183], v[248:251], v[88:91]
    buffer_load_dwordx4 a[132:135], v2, s[20:23], s37 offen offset:0 sc1
    v_mfma_f32_16x16x32_bf16 v[92:95], v[164:167], v[236:239], v[92:95]
    ds_read_b128 v[152:155], v12 offset:43008
    v_mfma_f32_16x16x32_bf16 v[92:95], v[180:183], v[252:255], v[92:95]
    s_add_u32 s37, s45, 32768
    ds_read_b128 v[200:203], v10 offset:32768
    v_mfma_f32_16x16x32_bf16 v[96:99], v[168:171], v[224:227], v[96:99]
    buffer_load_dwordx4 a[136:139], v2, s[20:23], s37 offen offset:0 sc1
    v_mfma_f32_16x16x32_bf16 v[96:99], v[184:187], v[240:243], v[96:99]
    ds_read_b128 v[216:219], v10 offset:33792
    v_mfma_f32_16x16x32_bf16 v[100:103], v[168:171], v[228:231], v[100:103]
    s_add_u32 s37, s45, 49152
    ds_read_b128 v[140:143], v12 offset:35840
    v_mfma_f32_16x16x32_bf16 v[100:103], v[184:187], v[244:247], v[100:103]
    buffer_load_dwordx4 a[140:143], v2, s[20:23], s37 offen offset:0 sc1
    v_mfma_f32_16x16x32_bf16 v[104:107], v[168:171], v[232:235], v[104:107]
    ds_read_b128 v[156:159], v12 offset:44032
    v_mfma_f32_16x16x32_bf16 v[104:107], v[184:187], v[248:251], v[104:107]
    s_add_u32 s37, s46, 4096
    ds_read_b128 v[204:207], v11 offset:32768
    v_mfma_f32_16x16x32_bf16 v[108:111], v[168:171], v[236:239], v[108:111]
    buffer_load_dwordx4 a[80:83], v2, s[20:23], s37 offen offset:0 sc1
    v_mfma_f32_16x16x32_bf16 v[108:111], v[184:187], v[252:255], v[108:111]
    ds_read_b128 v[220:223], v11 offset:33792
    v_mfma_f32_16x16x32_bf16 v[112:115], v[172:175], v[224:227], v[112:115]
    v_mfma_f32_16x16x32_bf16 v[112:115], v[188:191], v[240:243], v[112:115]
    buffer_load_dwordx4 a[84:87], v2, s[20:23], s37 offen offset:1024 sc1
    v_mfma_f32_16x16x32_bf16 v[116:119], v[172:175], v[228:231], v[116:119]
    v_mfma_f32_16x16x32_bf16 v[116:119], v[188:191], v[244:247], v[116:119]
    v_mfma_f32_16x16x32_bf16 v[120:123], v[172:175], v[232:235], v[120:123]
    buffer_load_dwordx4 a[88:91], v2, s[20:23], s37 offen offset:2048 sc1
    v_mfma_f32_16x16x32_bf16 v[120:123], v[188:191], v[248:251], v[120:123]
    v_mfma_f32_16x16x32_bf16 v[124:127], v[172:175], v[236:239], v[124:127]
    buffer_load_dwordx4 a[92:95], v2, s[20:23], s37 offen offset:3072 sc1
    v_mfma_f32_16x16x32_bf16 v[124:127], v[188:191], v[252:255], v[124:127]
    s_waitcnt lgkmcnt(0)
    v_mfma_f32_16x16x32_bf16 v[64:67], v[128:131], v[192:195], v[64:67]
    s_waitcnt vmcnt(12)
    s_barrier
    v_mfma_f32_16x16x32_bf16 v[64:67], v[144:147], v[208:211], v[64:67]
    ds_read_b128 v[160:163], v12 offset:49152
    v_mfma_f32_16x16x32_bf16 v[68:71], v[128:131], v[196:199], v[68:71]
    ds_read_b128 v[176:179], v12 offset:57344
    v_mfma_f32_16x16x32_bf16 v[68:71], v[144:147], v[212:215], v[68:71]
    s_add_u32 s37, s45, 0
    ds_read_b128 v[224:227], v8 offset:49152
    v_mfma_f32_16x16x32_bf16 v[72:75], v[128:131], v[200:203], v[72:75]
    buffer_load_dwordx4 a[144:147], v2, s[20:23], s37 offen offset:1024 sc1
    v_mfma_f32_16x16x32_bf16 v[72:75], v[144:147], v[216:219], v[72:75]
    ds_read_b128 v[240:243], v8 offset:50176
    v_mfma_f32_16x16x32_bf16 v[76:79], v[128:131], v[204:207], v[76:79]
    s_add_u32 s37, s45, 16384
    ds_read_b128 v[164:167], v12 offset:50176
    v_mfma_f32_16x16x32_bf16 v[76:79], v[144:147], v[220:223], v[76:79]
    buffer_load_dwordx4 a[148:151], v2, s[20:23], s37 offen offset:1024 sc1
    v_mfma_f32_16x16x32_bf16 v[80:83], v[132:135], v[192:195], v[80:83]
    ds_read_b128 v[180:183], v12 offset:58368
    v_mfma_f32_16x16x32_bf16 v[80:83], v[148:151], v[208:211], v[80:83]
    s_add_u32 s37, s45, 32768
    ds_read_b128 v[228:231], v9 offset:49152
    v_mfma_f32_16x16x32_bf16 v[84:87], v[132:135], v[196:199], v[84:87]
    buffer_load_dwordx4 a[152:155], v2, s[20:23], s37 offen offset:1024 sc1
    v_mfma_f32_16x16x32_bf16 v[84:87], v[148:151], v[212:215], v[84:87]
    ds_read_b128 v[244:247], v9 offset:50176
    v_mfma_f32_16x16x32_bf16 v[88:91], v[132:135], v[200:203], v[88:91]
    s_add_u32 s37, s45, 49152
    ds_read_b128 v[168:171], v12 offset:51200
    v_mfma_f32_16x16x32_bf16 v[88:91], v[148:151], v[216:219], v[88:91]
    buffer_load_dwordx4 a[156:159], v2, s[20:23], s37 offen offset:1024 sc1
    v_mfma_f32_16x16x32_bf16 v[92:95], v[132:135], v[204:207], v[92:95]
    ds_read_b128 v[184:187], v12 offset:59392
    v_mfma_f32_16x16x32_bf16 v[92:95], v[148:151], v[220:223], v[92:95]
    s_add_u32 s37, s46, 8192
    ds_read_b128 v[232:235], v10 offset:49152
    v_mfma_f32_16x16x32_bf16 v[96:99], v[136:139], v[192:195], v[96:99]
    buffer_load_dwordx4 a[96:99], v2, s[20:23], s37 offen offset:0 sc1
    v_mfma_f32_16x16x32_bf16 v[96:99], v[152:155], v[208:211], v[96:99]
    ds_read_b128 v[248:251], v10 offset:50176
    v_mfma_f32_16x16x32_bf16 v[100:103], v[136:139], v[196:199], v[100:103]
    ds_read_b128 v[172:175], v12 offset:52224
    v_mfma_f32_16x16x32_bf16 v[100:103], v[152:155], v[212:215], v[100:103]
    buffer_load_dwordx4 a[100:103], v2, s[20:23], s37 offen offset:1024 sc1
    v_mfma_f32_16x16x32_bf16 v[104:107], v[136:139], v[200:203], v[104:107]
    ds_read_b128 v[188:191], v12 offset:60416
    v_mfma_f32_16x16x32_bf16 v[104:107], v[152:155], v[216:219], v[104:107]
    ds_read_b128 v[236:239], v11 offset:49152
    v_mfma_f32_16x16x32_bf16 v[108:111], v[136:139], v[204:207], v[108:111]
    buffer_load_dwordx4 a[104:107], v2, s[20:23], s37 offen offset:2048 sc1
    v_mfma_f32_16x16x32_bf16 v[108:111], v[152:155], v[220:223], v[108:111]
    ds_read_b128 v[252:255], v11 offset:50176
    v_mfma_f32_16x16x32_bf16 v[112:115], v[140:143], v[192:195], v[112:115]
    v_mfma_f32_16x16x32_bf16 v[112:115], v[156:159], v[208:211], v[112:115]
    buffer_load_dwordx4 a[108:111], v2, s[20:23], s37 offen offset:3072 sc1
    v_mfma_f32_16x16x32_bf16 v[116:119], v[140:143], v[196:199], v[116:119]
    v_mfma_f32_16x16x32_bf16 v[116:119], v[156:159], v[212:215], v[116:119]
    s_add_u32 s37, s45, 0
    v_mfma_f32_16x16x32_bf16 v[120:123], v[140:143], v[200:203], v[120:123]
    buffer_load_dwordx4 a[160:163], v2, s[20:23], s37 offen offset:2048 sc1
    v_mfma_f32_16x16x32_bf16 v[120:123], v[156:159], v[216:219], v[120:123]
    s_add_u32 s37, s45, 16384
    v_mfma_f32_16x16x32_bf16 v[124:127], v[140:143], v[204:207], v[124:127]
    buffer_load_dwordx4 a[164:167], v2, s[20:23], s37 offen offset:2048 sc1
    v_mfma_f32_16x16x32_bf16 v[124:127], v[156:159], v[220:223], v[124:127]
    s_waitcnt lgkmcnt(0)
    v_mfma_f32_16x16x32_bf16 v[64:67], v[160:163], v[224:227], v[64:67]
    s_add_u32 s37, s45, 32768
    v_mfma_f32_16x16x32_bf16 v[64:67], v[176:179], v[240:243], v[64:67]
    buffer_load_dwordx4 a[168:171], v2, s[20:23], s37 offen offset:2048 sc1
    v_mfma_f32_16x16x32_bf16 v[68:71], v[160:163], v[228:231], v[68:71]
    s_add_u32 s37, s45, 49152
    v_mfma_f32_16x16x32_bf16 v[68:71], v[176:179], v[244:247], v[68:71]
    buffer_load_dwordx4 a[172:175], v2, s[20:23], s37 offen offset:2048 sc1
    v_mfma_f32_16x16x32_bf16 v[72:75], v[160:163], v[232:235], v[72:75]
    s_add_u32 s37, s46, 12288
    v_mfma_f32_16x16x32_bf16 v[72:75], v[176:179], v[248:251], v[72:75]
    buffer_load_dwordx4 a[112:115], v2, s[20:23], s37 offen offset:0 sc1
    v_mfma_f32_16x16x32_bf16 v[76:79], v[160:163], v[236:239], v[76:79]
    v_mfma_f32_16x16x32_bf16 v[76:79], v[176:179], v[252:255], v[76:79]
    buffer_load_dwordx4 a[116:119], v2, s[20:23], s37 offen offset:1024 sc1
    v_mfma_f32_16x16x32_bf16 v[80:83], v[164:167], v[224:227], v[80:83]
    v_mfma_f32_16x16x32_bf16 v[80:83], v[180:183], v[240:243], v[80:83]
    buffer_load_dwordx4 a[120:123], v2, s[20:23], s37 offen offset:2048 sc1
    v_mfma_f32_16x16x32_bf16 v[84:87], v[164:167], v[228:231], v[84:87]
    v_mfma_f32_16x16x32_bf16 v[84:87], v[180:183], v[244:247], v[84:87]
    buffer_load_dwordx4 a[124:127], v2, s[20:23], s37 offen offset:3072 sc1
    v_mfma_f32_16x16x32_bf16 v[88:91], v[164:167], v[232:235], v[88:91]
    s_add_u32 s37, s45, 0
    v_mfma_f32_16x16x32_bf16 v[88:91], v[180:183], v[248:251], v[88:91]
    buffer_load_dwordx4 a[176:179], v2, s[20:23], s37 offen offset:3072 sc1
    v_mfma_f32_16x16x32_bf16 v[92:95], v[164:167], v[236:239], v[92:95]
    s_add_u32 s37, s45, 16384
    v_mfma_f32_16x16x32_bf16 v[92:95], v[180:183], v[252:255], v[92:95]
    buffer_load_dwordx4 a[180:183], v2, s[20:23], s37 offen offset:3072 sc1
    v_mfma_f32_16x16x32_bf16 v[96:99], v[168:171], v[224:227], v[96:99]
    s_add_u32 s37, s45, 32768
    v_mfma_f32_16x16x32_bf16 v[96:99], v[184:187], v[240:243], v[96:99]
    buffer_load_dwordx4 a[184:187], v2, s[20:23], s37 offen offset:3072 sc1
    v_mfma_f32_16x16x32_bf16 v[100:103], v[168:171], v[228:231], v[100:103]
    s_add_u32 s37, s45, 49152
    v_mfma_f32_16x16x32_bf16 v[100:103], v[184:187], v[244:247], v[100:103]
    buffer_load_dwordx4 a[188:191], v2, s[20:23], s37 offen offset:3072 sc1
    v_mfma_f32_16x16x32_bf16 v[104:107], v[168:171], v[232:235], v[104:107]
    v_mfma_f32_16x16x32_bf16 v[104:107], v[184:187], v[248:251], v[104:107]
    s_lshl_b32 s100, s2, 7
    s_add_u32 s100, s100, s28
    s_lshl_b32 s100, s100, 2
    s_add_u32 s100, s100, 57671872
    v_and_b32 v7, 3, v1
    v_max_u32 v7, 1, v7
    v_lshl_add_u32 v7, v7, 4, s100
    buffer_load_dword v6, v7, s[20:23], 0 offen sc1
    v_mfma_f32_16x16x32_bf16 v[108:111], v[168:171], v[236:239], v[108:111]
    v_mfma_f32_16x16x32_bf16 v[108:111], v[184:187], v[252:255], v[108:111]
    v_mfma_f32_16x16x32_bf16 v[112:115], v[172:175], v[224:227], v[112:115]
    v_mfma_f32_16x16x32_bf16 v[112:115], v[188:191], v[240:243], v[112:115]
    v_mfma_f32_16x16x32_bf16 v[116:119], v[172:175], v[228:231], v[116:119]
    v_mfma_f32_16x16x32_bf16 v[116:119], v[188:191], v[244:247], v[116:119]
    v_mfma_f32_16x16x32_bf16 v[120:123], v[172:175], v[232:235], v[120:123]
    v_mfma_f32_16x16x32_bf16 v[120:123], v[188:191], v[248:251], v[120:123]
    v_mfma_f32_16x16x32_bf16 v[124:127], v[172:175], v[236:239], v[124:127]
    v_mfma_f32_16x16x32_bf16 v[124:127], v[188:191], v[252:255], v[124:127]
    s_nop 4
    s_add_u32 s37, s32, 1
    s_and_b32 s37, s37, 3
    s_lshl_b32 s37, s37, 16
    s_add_u32 s37, s37, s38
    s_add_u32 s37, s37, 16384
    v_cvt_pk_bf16_f32 v216, v68, v69
    v_cvt_pk_bf16_f32 v217, v70, v71
    v_cvt_pk_bf16_f32 v218, v84, v85
    v_cvt_pk_bf16_f32 v219, v86, v87
    buffer_store_dwordx4 v[216:219], v2, s[20:23], s37 offen offset:0 sc1
    v_cvt_pk_bf16_f32 v220, v100, v101
    v_cvt_pk_bf16_f32 v221, v102, v103
    v_cvt_pk_bf16_f32 v222, v116, v117
    v_cvt_pk_bf16_f32 v223, v118, v119
    buffer_store_dwordx4 v[220:223], v2, s[20:23], s37 offen offset:1024 sc1
    s_add_u32 s37, s32, 2
    s_and_b32 s37, s37, 3
    s_lshl_b32 s37, s37, 16
    s_add_u32 s37, s37, s38
    s_add_u32 s37, s37, 32768
    v_cvt_pk_bf16_f32 v224, v72, v73
    v_cvt_pk_bf16_f32 v225, v74, v75
    v_cvt_pk_bf16_f32 v226, v88, v89
    v_cvt_pk_bf16_f32 v227, v90, v91
    buffer_store_dwordx4 v[224:227], v2, s[20:23], s37 offen offset:0 sc1
    v_cvt_pk_bf16_f32 v228, v104, v105
    v_cvt_pk_bf16_f32 v229, v106, v107
    v_cvt_pk_bf16_f32 v230, v120, v121
    v_cvt_pk_bf16_f32 v231, v122, v123
    buffer_store_dwordx4 v[228:231], v2, s[20:23], s37 offen offset:1024 sc1
    s_add_u32 s37, s32, 3
    s_and_b32 s37, s37, 3
    s_lshl_b32 s37, s37, 16
    s_add_u32 s37, s37, s38
    s_add_u32 s37, s37, 49152
    v_cvt_pk_bf16_f32 v232, v76, v77
    v_cvt_pk_bf16_f32 v233, v78, v79
    v_cvt_pk_bf16_f32 v234, v92, v93
    v_cvt_pk_bf16_f32 v235, v94, v95
    buffer_store_dwordx4 v[232:235], v2, s[20:23], s37 offen offset:0 sc1
    v_cvt_pk_bf16_f32 v236, v108, v109
    v_cvt_pk_bf16_f32 v237, v110, v111
    v_cvt_pk_bf16_f32 v238, v124, v125
    v_cvt_pk_bf16_f32 v239, v126, v127
    buffer_store_dwordx4 v[236:239], v2, s[20:23], s37 offen offset:1024 sc1
    s_waitcnt vmcnt(6)
    v_cmp_ne_u32 vcc, s3, v6
    s_mov_b64 s[40:41], vcc
    s_cbranch_vccnz OP_wx
    s_add_u32 s37, s39, 16384
    buffer_load_dwordx4 v[32:35], v2, s[20:23], s37 offen offset:0 sc1
    buffer_load_dwordx4 v[36:39], v2, s[20:23], s37 offen offset:1024 sc1
    s_add_u32 s37, s39, 32768
    buffer_load_dwordx4 v[40:43], v2, s[20:23], s37 offen offset:0 sc1
    buffer_load_dwordx4 v[44:47], v2, s[20:23], s37 offen offset:1024 sc1
    s_add_u32 s37, s39, 49152
    buffer_load_dwordx4 v[48:51], v2, s[20:23], s37 offen offset:0 sc1
    buffer_load_dwordx4 v[52:55], v2, s[20:23], s37 offen offset:1024 sc1
OP_wx:
    v_mfma_f32_16x16x32_bf16 a[192:195], a[64:67], a[128:131], 0
    v_mov_b32 v192, v64
    v_mfma_f32_16x16x32_bf16 a[196:199], a[64:67], a[132:135], 0
    v_mov_b32 v193, v65
    v_mfma_f32_16x16x32_bf16 a[200:203], a[64:67], a[136:139], 0
    v_mov_b32 v194, v66
    v_mfma_f32_16x16x32_bf16 a[204:207], a[64:67], a[140:143], 0
    v_mov_b32 v195, v67
    v_mfma_f32_16x16x32_bf16 a[208:211], a[68:71], a[128:131], 0
    v_mov_b32 v196, v80
    v_mfma_f32_16x16x32_bf16 a[212:215], a[68:71], a[132:135], 0
    v_mov_b32 v197, v81
    v_mfma_f32_16x16x32_bf16 a[216:219], a[68:71], a[136:139], 0
    v_mov_b32 v198, v82
    v_mfma_f32_16x16x32_bf16 a[220:223], a[68:71], a[140:143], 0
    v_mov_b32 v199, v83
    v_mfma_f32_16x16x32_bf16 a[224:227], a[72:75], a[128:131], 0
    v_mov_b32 v200, v96
    v_mfma_f32_16x16x32_bf16 a[228:231], a[72:75], a[132:135], 0
    v_mov_b32 v201, v97
    v_mfma_f32_16x16x32_bf16 a[232:235], a[72:75], a[136:139], 0
    v_mov_b32 v202, v98
    v_mfma_f32_16x16x32_bf16 a[236:239], a[72:75], a[140:143], 0
    v_mov_b32 v203, v99
    v_mfma_f32_16x16x32_bf16 a[240:243], a[76:79], a[128:131], 0
    v_mov_b32 v204, v112
    v_mfma_f32_16x16x32_bf16 a[244:247], a[76:79], a[132:135], 0
    v_mov_b32 v205, v113
    v_mfma_f32_16x16x32_bf16 a[248:251], a[76:79], a[136:139], 0
    v_mov_b32 v206, v114
    v_mfma_f32_16x16x32_bf16 a[252:255], a[76:79], a[140:143], 0
    v_mov_b32 v207, v115
    v_mfma_f32_16x16x32_bf16 a[192:195], a[80:83], a[144:147], a[192:195]
    v_mov_b32 v30, 0x3f80
    v_mov_b32 v31, 0x3f800000
    v_mfma_f32_16x16x32_bf16 a[196:199], a[80:83], a[148:151], a[196:199]
    v_mfma_f32_16x16x32_bf16 a[200:203], a[80:83], a[152:155], a[200:203]
    v_mfma_f32_16x16x32_bf16 a[204:207], a[80:83], a[156:159], a[204:207]
    v_mfma_f32_16x16x32_bf16 a[208:211], a[84:87], a[144:147], a[208:211]
    v_mfma_f32_16x16x32_bf16 a[212:215], a[84:87], a[148:151], a[212:215]
    v_mfma_f32_16x16x32_bf16 a[216:219], a[84:87], a[152:155], a[216:219]
    v_mfma_f32_16x16x32_bf16 a[220:223], a[84:87], a[156:159], a[220:223]
    s_cmp_eq_u64 s[40:41], 0
    s_cbranch_scc1 OP_w12
    s_waitcnt vmcnt(0)
OP_w12:
    s_waitcnt vmcnt(6)
    v_lshl_add_u32 v20, v1, 1, s31
    v_and_b32 v20, 7, v20
    s_lshr_b32 s100, s2, 3
    v_mov_b32 v21, s100
    v_lshl_add_u32 v22, v21, 3, v20
    v_lshlrev_b32 v22, 9, v22
    v_lshl_add_u32 v22, v1, 4, v22
    s_mov_b32 s100, s28
    s_lshl_b32 s100, s100, 2
    s_add_u32 s100, s100, 57671872
    v_mov_b32 v20, s3
    s_mov_b64 exec, 0xe
    buffer_store_dword v20, v22, s[20:23], s100 offen sc1
    s_mov_b64 exec, -1
SG13:
    v_mfma_f32_16x16x32_bf16 a[224:227], a[88:91], a[144:147], a[224:227]
    v_mfma_f32_16x16x32_bf16 a[228:231], a[88:91], a[148:151], a[228:231]
    v_mfma_f32_16x16x32_bf16 a[232:235], a[88:91], a[152:155], a[232:235]
    v_mfma_f32_16x16x32_bf16 a[236:239], a[88:91], a[156:159], a[236:239]
    v_mfma_f32_16x16x32_bf16 a[240:243], a[92:95], a[144:147], a[240:243]
    v_mfma_f32_16x16x32_bf16 a[244:247], a[92:95], a[148:151], a[244:247]
    v_mfma_f32_16x16x32_bf16 a[248:251], a[92:95], a[152:155], a[248:251]
    v_mfma_f32_16x16x32_bf16 a[252:255], a[92:95], a[156:159], a[252:255]
    v_mfma_f32_16x16x32_bf16 a[192:195], a[96:99], a[160:163], a[192:195]
    v_mfma_f32_16x16x32_bf16 a[196:199], a[96:99], a[164:167], a[196:199]
    v_mfma_f32_16x16x32_bf16 a[200:203], a[96:99], a[168:171], a[200:203]
    v_mfma_f32_16x16x32_bf16 a[204:207], a[96:99], a[172:175], a[204:207]
    v_mfma_f32_16x16x32_bf16 a[208:211], a[100:103], a[160:163], a[208:211]
    v_mfma_f32_16x16x32_bf16 a[212:215], a[100:103], a[164:167], a[212:215]
    v_mfma_f32_16x16x32_bf16 a[216:219], a[100:103], a[168:171], a[216:219]
    v_mfma_f32_16x16x32_bf16 a[220:223], a[100:103], a[172:175], a[220:223]
    v_mfma_f32_16x16x32_bf16 a[224:227], a[104:107], a[160:163], a[224:227]
    v_mfma_f32_16x16x32_bf16 a[228:231], a[104:107], a[164:167], a[228:231]
    v_mfma_f32_16x16x32_bf16 a[232:235], a[104:107], a[168:171], a[232:235]
    v_mfma_f32_16x16x32_bf16 a[236:239], a[104:107], a[172:175], a[236:239]
    v_mfma_f32_16x16x32_bf16 a[240:243], a[108:111], a[160:163], a[240:243]
    v_mfma_f32_16x16x32_bf16 a[244:247], a[108:111], a[164:167], a[244:247]
    v_mfma_f32_16x16x32_bf16 a[248:251], a[108:111], a[168:171], a[248:251]
    v_mfma_f32_16x16x32_bf16 a[252:255], a[108:111], a[172:175], a[252:255]
    v_mfma_f32_16x16x32_bf16 a[192:195], a[112:115], a[176:179], a[192:195]
    v_mfma_f32_16x16x32_bf16 a[196:199], a[112:115], a[180:183], a[196:199]
    v_mfma_f32_16x16x32_bf16 a[200:203], a[112:115], a[184:187], a[200:203]
    v_mfma_f32_16x16x32_bf16 a[204:207], a[112:115], a[188:191], a[204:207]
    v_mfma_f32_16x16x32_bf16 a[208:211], a[116:119], a[176:179], a[208:211]
    v_mfma_f32_16x16x32_bf16 a[212:215], a[116:119], a[180:183], a[212:215]
    v_mfma_f32_16x16x32_bf16 a[216:219], a[116:119], a[184:187], a[216:219]
    v_mfma_f32_16x16x32_bf16 a[220:223], a[116:119], a[188:191], a[220:223]
    v_mfma_f32_16x16x32_bf16 a[224:227], a[120:123], a[176:179], a[224:227]
    v_mfma_f32_16x16x32_bf16 a[228:231], a[120:123], a[180:183], a[228:231]
    v_mfma_f32_16x16x32_bf16 a[232:235], a[120:123], a[184:187], a[232:235]
    v_mfma_f32_16x16x32_bf16 a[236:239], a[120:123], a[188:191], a[236:239]
    v_mfma_f32_16x16x32_bf16 a[240:243], a[124:127], a[176:179], a[240:243]
    v_mfma_f32_16x16x32_bf16 a[244:247], a[124:127], a[180:183], a[244:247]
    v_mfma_f32_16x16x32_bf16 a[248:251], a[124:127], a[184:187], a[248:251]
    v_mfma_f32_16x16x32_bf16 a[252:255], a[124:127], a[188:191], a[252:255]
    s_barrier
    s_nop 4
    ds_write_b128 v13, a[192:195] offset:0
    ds_write_b128 v13, a[208:211] offset:1024
    ds_write_b128 v13, a[224:227] offset:2048
    ds_write_b128 v13, a[240:243] offset:3072
    ds_write_b128 v13, a[196:199] offset:16384
    ds_write_b128 v13, a[212:215] offset:17408
    ds_write_b128 v13, a[228:231] offset:18432
    ds_write_b128 v13, a[244:247] offset:19456
    buffer_load_dword v6, v7, s[20:23], 0 offen sc1
    ds_write_b128 v13, a[200:203] offset:32768
    ds_write_b128 v13, a[216:219] offset:33792
    ds_write_b128 v13, a[232:235] offset:34816
    ds_write_b128 v13, a[248:251] offset:35840
    ds_write_b128 v13, a[204:207] offset:49152
    ds_write_b128 v13, a[220:223] offset:50176
    ds_write_b128 v13, a[236:239] offset:51200
    ds_write_b128 v13, a[252:255] offset:52224
    s_waitcnt lgkmcnt(0)
    s_barrier
    ds_read_b128 v[128:131], v14 offset:0
    ds_read_b128 v[132:135], v14 offset:1024
    ds_read_b128 v[136:139], v14 offset:2048
    ds_read_b128 v[140:143], v14 offset:3072
    ds_read_b128 v[144:147], v14 offset:4096
    ds_read_b128 v[148:151], v14 offset:5120
    ds_read_b128 v[152:155], v14 offset:6144
    ds_read_b128 v[156:159], v14 offset:7168
    ds_read_b128 v[160:163], v14 offset:8192
    ds_read_b128 v[164:167], v14 offset:9216
    ds_read_b128 v[168:171], v14 offset:10240
    ds_read_b128 v[172:175], v14 offset:11264
    ds_read_b128 v[176:179], v14 offset:12288
    ds_read_b128 v[180:183], v14 offset:13312
    ds_read_b128 v[184:187], v14 offset:14336
    ds_read_b128 v[188:191], v14 offset:15360
    s_waitcnt vmcnt(0)
    s_cmp_eq_u64 s[40:41], 0
    s_cbranch_scc1 OP_fin
    s_mov_b32 s37, 0x20000
PL14:
    v_cmp_ne_u32 vcc, s3, v6
    s_cbranch_vccz PL14x
    s_sub_u32 s37, s37, 1
    s_cbranch_scc1 PL14x
    s_sleep 4
    buffer_load_dword v6, v7, s[20:23], 0 offen sc1
    s_waitcnt vmcnt(0)
    s_branch PL14
PL14x:
    s_add_u32 s37, s39, 16384
    buffer_load_dwordx4 v[32:35], v2, s[20:23], s37 offen offset:0 sc1
    buffer_load_dwordx4 v[36:39], v2, s[20:23], s37 offen offset:1024 sc1
    s_add_u32 s37, s39, 32768
    buffer_load_dwordx4 v[40:43], v2, s[20:23], s37 offen offset:0 sc1
    buffer_load_dwordx4 v[44:47], v2, s[20:23], s37 offen offset:1024 sc1
    s_add_u32 s37, s39, 49152
    buffer_load_dwordx4 v[48:51], v2, s[20:23], s37 offen offset:0 sc1
    buffer_load_dwordx4 v[52:55], v2, s[20:23], s37 offen offset:1024 sc1
OP_fin:
    s_waitcnt lgkmcnt(0)
    v_add_f32 v128, v128, v144
    v_add_f32 v160, v160, v176
    v_add_f32 v129, v129, v145
    v_add_f32 v161, v161, v177
    v_add_f32 v130, v130, v146
    v_add_f32 v162, v162, v178
    v_add_f32 v131, v131, v147
    v_add_f32 v163, v163, v179
    v_add_f32 v132, v132, v148
    v_add_f32 v164, v164, v180
    v_add_f32 v133, v133, v149
    v_add_f32 v165, v165, v181
    v_add_f32 v134, v134, v150
    v_add_f32 v166, v166, v182
    v_add_f32 v135, v135, v151
    v_add_f32 v167, v167, v183
    v_add_f32 v136, v136, v152
    v_add_f32 v168, v168, v184
    v_add_f32 v137, v137, v153
    v_add_f32 v169, v169, v185
    v_add_f32 v138, v138, v154
    v_add_f32 v170, v170, v186
    v_add_f32 v139, v139, v155
    v_add_f32 v171, v171, v187
    v_add_f32 v140, v140, v156
    v_add_f32 v172, v172, v188
    v_add_f32 v141, v141, v157
    v_add_f32 v173, v173, v189
    v_add_f32 v142, v142, v158
    v_add_f32 v174, v174, v190
    v_add_f32 v143, v143, v159
    v_add_f32 v175, v175, v191
    v_add_f32 v128, v128, v160
    v_add_f32 v129, v129, v161
    v_add_f32 v130, v130, v162
    v_add_f32 v131, v131, v163
    v_add_f32 v132, v132, v164
    v_add_f32 v133, v133, v165
    v_add_f32 v134, v134, v166
    v_add_f32 v135, v135, v167
    v_add_f32 v136, v136, v168
    v_add_f32 v137, v137, v169
    v_add_f32 v138, v138, v170
    v_add_f32 v139, v139, v171
    v_add_f32 v140, v140, v172
    v_add_f32 v141, v141, v173
    v_add_f32 v142, v142, v174
    v_add_f32 v143, v143, v175
    v_cvt_pk_bf16_f32 v128, v128, v129
    v_cvt_pk_bf16_f32 v129, v130, v131
    v_cvt_pk_bf16_f32 v130, v132, v133
    v_cvt_pk_bf16_f32 v131, v134, v135
    v_cvt_pk_bf16_f32 v132, v136, v137
    v_cvt_pk_bf16_f32 v133, v138, v139
    v_cvt_pk_bf16_f32 v134, v140, v141
    v_cvt_pk_bf16_f32 v135, v142, v143
    buffer_store_dwordx4 v[128:131], v15, s[4:7], s47 offen offset:0
    buffer_store_dwordx4 v[132:135], v15, s[4:7], s47 offen offset:64
    s_waitcnt vmcnt(2)
    v_dot2c_f32_bf16 v192, v32, v30
    v_dot2c_f32_bf16 v193, v32, v31
    v_dot2c_f32_bf16 v194, v33, v30
    v_dot2c_f32_bf16 v195, v33, v31
    v_dot2c_f32_bf16 v196, v34, v30
    v_dot2c_f32_bf16 v197, v34, v31
    v_dot2c_f32_bf16 v198, v35, v30
    v_dot2c_f32_bf16 v199, v35, v31
    v_dot2c_f32_bf16 v200, v36, v30
    v_dot2c_f32_bf16 v201, v36, v31
    v_dot2c_f32_bf16 v202, v37, v30
    v_dot2c_f32_bf16 v203, v37, v31
    v_dot2c_f32_bf16 v204, v38, v30
    v_dot2c_f32_bf16 v205, v38, v31
    v_dot2c_f32_bf16 v206, v39, v30
    v_dot2c_f32_bf16 v207, v39, v31
    v_dot2c_f32_bf16 v192, v40, v30
    v_dot2c_f32_bf16 v193, v40, v31
    v_dot2c_f32_bf16 v194, v41, v30
    v_dot2c_f32_bf16 v195, v41, v31
    v_dot2c_f32_bf16 v196, v42, v30
    v_dot2c_f32_bf16 v197, v42, v31
    v_dot2c_f32_bf16 v198, v43, v30
    v_dot2c_f32_bf16 v199, v43, v31
    v_dot2c_f32_bf16 v200, v44, v30
    v_dot2c_f32_bf16 v201, v44, v31
    v_dot2c_f32_bf16 v202, v45, v30
    v_dot2c_f32_bf16 v203, v45, v31
    v_dot2c_f32_bf16 v204, v46, v30
    v_dot2c_f32_bf16 v205, v46, v31
    v_dot2c_f32_bf16 v206, v47, v30
    v_dot2c_f32_bf16 v207, v47, v31
    v_dot2c_f32_bf16 v192, v48, v30
    v_dot2c_f32_bf16 v193, v48, v31
    v_dot2c_f32_bf16 v194, v49, v30
    v_dot2c_f32_bf16 v195, v49, v31
    v_dot2c_f32_bf16 v196, v50, v30
    v_dot2c_f32_bf16 v197, v50, v31
    v_dot2c_f32_bf16 v198, v51, v30
    v_dot2c_f32_bf16 v199, v51, v31
    v_dot2c_f32_bf16 v200, v52, v30
    v_dot2c_f32_bf16 v201, v52, v31
    v_dot2c_f32_bf16 v202, v53, v30
    v_dot2c_f32_bf16 v203, v53, v31
    v_dot2c_f32_bf16 v204, v54, v30
    v_dot2c_f32_bf16 v205, v54, v31
    v_dot2c_f32_bf16 v206, v55, v30
    v_dot2c_f32_bf16 v207, v55, v31
    s_nop 2
    v_cvt_pk_bf16_f32 v192, v192, v193
    v_cvt_pk_bf16_f32 v193, v194, v195
    v_cvt_pk_bf16_f32 v194, v196, v197
    v_cvt_pk_bf16_f32 v195, v198, v199
    v_cvt_pk_bf16_f32 v196, v200, v201
    v_cvt_pk_bf16_f32 v197, v202, v203
    v_cvt_pk_bf16_f32 v198, v204, v205
    v_cvt_pk_bf16_f32 v199, v206, v207
    buffer_store_dwordx4 v[192:195], v15, s[4:7], s42 offen offset:0
    buffer_store_dwordx4 v[196:199], v15, s[4:7], s42 offen offset:64
    s_endpgm
AT_fb:
    s_waitcnt vmcnt(0) lgkmcnt(0)
    s_cmp_eq_u64 s[58:59], 0
    s_cbranch_scc1 AT_fb2
    s_mov_b64 s[58:59], 0
    s_mov_b32 s68, s70
    s_mov_b32 s72, s63
    s_lshl_b32 s62, s30, 3
    s_sub_u32 s62, 120, s62
    s_add_u32 s73, s62, s28
    v_and_b32 v88, 15, v1
    v_lshrrev_b32 v80, 4, v1
    v_lshlrev_b32 v80, 2, v80
    v_sub_u32 v88, v88, v80
    s_lshl_b32 s73, s73, 4
    v_add_u32 v88, s73, v88
    s_add_u32 s73, s62, 7
    s_sub_u32 s73, s73, s28
    s_lshr_b32 s67, s73, 1
    v_and_b32 v89, 15, v1
    v_lshrrev_b32 v80, 4, v1
    v_lshlrev_b32 v80, 2, v80
    v_sub_u32 v89, v89, v80
    s_lshl_b32 s73, s73, 4
    v_add_u32 v89, s73, v89
    s_branch AT_fbgo
AT_fb2:
    s_cmp_eq_u64 s[60:61], 0
    s_cbranch_scc1 AT_fbe
    s_mov_b64 s[60:61], 0
    s_mov_b32 s68, s71
    s_add_u32 s72, s71, 131072
    s_lshl2_add_u32 s67, s30, s28
    s_lshl_b32 s73, s67, 1
    v_and_b32 v88, 15, v1
    v_lshrrev_b32 v80, 4, v1
    v_lshlrev_b32 v80, 2, v80
    v_sub_u32 v88, v88, v80
    s_lshl_b32 s73, s73, 4
    v_add_u32 v88, s73, v88
    s_lshl_b32 s73, s67, 1
    s_add_u32 s73, s73, 1
    v_and_b32 v89, 15, v1
    v_lshrrev_b32 v80, 4, v1
    v_lshlrev_b32 v80, 2, v80
    v_sub_u32 v89, v89, v80
    s_lshl_b32 s73, s73, 4
    v_add_u32 v89, s73, v89
    v_accvgpr_mov_b32 a64, a96
    v_accvgpr_mov_b32 a65, a97
    v_accvgpr_mov_b32 a66, a98
    v_accvgpr_mov_b32 a67, a99
    v_accvgpr_mov_b32 a68, a100
    v_accvgpr_mov_b32 a69, a101
    v_accvgpr_mov_b32 a70, a102
    v_accvgpr_mov_b32 a71, a103
    v_accvgpr_mov_b32 a72, a104
    v_accvgpr_mov_b32 a73, a105
    v_accvgpr_mov_b32 a74, a106
    v_accvgpr_mov_b32 a75, a107
    v_accvgpr_mov_b32 a76, a108
    v_accvgpr_mov_b32 a77, a109
    v_accvgpr_mov_b32 a78, a110
    v_accvgpr_mov_b32 a79, a111
    v_accvgpr_mov_b32 a80, a112
    v_accvgpr_mov_b32 a81, a113
    v_accvgpr_mov_b32 a82, a114
    v_accvgpr_mov_b32 a83, a115
    v_accvgpr_mov_b32 a84, a116
    v_accvgpr_mov_b32 a85, a117
    v_accvgpr_mov_b32 a86, a118
    v_accvgpr_mov_b32 a87, a119
    v_accvgpr_mov_b32 a88, a120
    v_accvgpr_mov_b32 a89, a121
    v_accvgpr_mov_b32 a90, a122
    v_accvgpr_mov_b32 a91, a123
    v_accvgpr_mov_b32 a92, a124
    v_accvgpr_mov_b32 a93, a125
    v_accvgpr_mov_b32 a94, a126
    v_accvgpr_mov_b32 a95, a127
AT_fbgo:
    s_mov_b32 s64, 0
    s_mov_b32 s69, 0
    v_mov_b32 v90, 0xf149f2ca
    v_mov_b32 v128, 0
    v_mov_b32 v129, 0
    v_mov_b32 v130, 0
    v_mov_b32 v131, 0
    v_mov_b32 v132, 0
    v_mov_b32 v133, 0
    v_mov_b32 v134, 0
    v_mov_b32 v135, 0
    v_mov_b32 v136, 0
    v_mov_b32 v137, 0
    v_mov_b32 v138, 0
    v_mov_b32 v139, 0
    v_mov_b32 v140, 0
    v_mov_b32 v141, 0
    v_mov_b32 v142, 0
    v_mov_b32 v143, 0
    v_mov_b32 v144, 0
    v_mov_b32 v145, 0
    v_mov_b32 v146, 0
    v_mov_b32 v147, 0
    v_mov_b32 v148, 0
    v_mov_b32 v149, 0
    v_mov_b32 v150, 0
    v_mov_b32 v151, 0
    v_mov_b32 v152, 0
    v_mov_b32 v153, 0
    v_mov_b32 v154, 0
    v_mov_b32 v155, 0
    v_mov_b32 v156, 0
    v_mov_b32 v157, 0
    v_mov_b32 v158, 0
    v_mov_b32 v159, 0
    v_mov_b32 v160, 0
    v_mov_b32 v161, 0
    v_mov_b32 v162, 0
    v_mov_b32 v163, 0
    v_mov_b32 v164, 0
    v_mov_b32 v165, 0
    v_mov_b32 v166, 0
    v_mov_b32 v167, 0
    v_mov_b32 v168, 0
    v_mov_b32 v169, 0
    v_mov_b32 v170, 0
    v_mov_b32 v171, 0
    v_mov_b32 v172, 0
    v_mov_b32 v173, 0
    v_mov_b32 v174, 0
    v_mov_b32 v175, 0
    v_mov_b32 v176, 0
    v_mov_b32 v177, 0
    v_mov_b32 v178, 0
    v_mov_b32 v179, 0
    v_mov_b32 v180, 0
    v_mov_b32 v181, 0
    v_mov_b32 v182, 0
    v_mov_b32 v183, 0
    v_mov_b32 v184, 0
    v_mov_b32 v185, 0
    v_mov_b32 v186, 0
    v_mov_b32 v187, 0
    v_mov_b32 v188, 0
    v_mov_b32 v189, 0
    v_mov_b32 v190, 0
    v_mov_b32 v191, 0
    v_mov_b32 v116, 0xf149f2ca
    v_mov_b32 v117, 0xf149f2ca
    v_mov_b32 v124, 0
    v_mov_b32 v125, 0
AT_fbl:
    s_add_u32 s62, s69, 0
    buffer_load_dwordx4 a[0:3], v2, s[8:11], s62 offen offset:0 sc1
    buffer_load_dwordx4 a[4:7], v2, s[8:11], s62 offen offset:1024 sc1
    buffer_load_dwordx4 a[8:11], v2, s[8:11], s62 offen offset:2048 sc1
    buffer_load_dwordx4 a[12:15], v2, s[8:11], s62 offen offset:3072 sc1
    s_add_u32 s62, s69, 4096
    buffer_load_dwordx4 a[16:19], v2, s[8:11], s62 offen offset:0 sc1
    buffer_load_dwordx4 a[20:23], v2, s[8:11], s62 offen offset:1024 sc1
    buffer_load_dwordx4 a[24:27], v2, s[8:11], s62 offen offset:2048 sc1
    buffer_load_dwordx4 a[28:31], v2, s[8:11], s62 offen offset:3072 sc1
    s_add_u32 s62, s69, 24576
    buffer_load_dwordx4 a[32:35], v2, s[8:11], s62 offen offset:0 sc1
    buffer_load_dwordx4 a[36:39], v2, s[8:11], s62 offen offset:1024 sc1
    buffer_load_dwordx4 a[40:43], v2, s[8:11], s62 offen offset:2048 sc1
    buffer_load_dwordx4 a[44:47], v2, s[8:11], s62 offen offset:3072 sc1
    s_add_u32 s62, s69, 28672
    buffer_load_dwordx4 a[48:51], v2, s[8:11], s62 offen offset:0 sc1
    buffer_load_dwordx4 a[52:55], v2, s[8:11], s62 offen offset:1024 sc1
    buffer_load_dwordx4 a[56:59], v2, s[8:11], s62 offen offset:2048 sc1
    buffer_load_dwordx4 a[60:63], v2, s[8:11], s62 offen offset:3072 sc1
    s_waitcnt vmcnt(0)
    v_mfma_f32_16x16x32_bf16 v[16:19], a[0:3], a[64:67], 0
    v_mfma_f32_16x16x32_bf16 v[16:19], a[4:7], a[68:71], v[16:19]
    v_mfma_f32_16x16x32_bf16 v[16:19], a[8:11], a[72:75], v[16:19]
    v_mfma_f32_16x16x32_bf16 v[16:19], a[12:15], a[76:79], v[16:19]
    v_mfma_f32_16x16x32_bf16 v[20:23], a[16:19], a[64:67], 0
    v_mfma_f32_16x16x32_bf16 v[20:23], a[20:23], a[68:71], v[20:23]
    v_mfma_f32_16x16x32_bf16 v[20:23], a[24:27], a[72:75], v[20:23]
    v_mfma_f32_16x16x32_bf16 v[20:23], a[28:31], a[76:79], v[20:23]
    v_mfma_f32_16x16x32_bf16 v[24:27], a[0:3], a[80:83], 0
    v_mfma_f32_16x16x32_bf16 v[24:27], a[4:7], a[84:87], v[24:27]
    v_mfma_f32_16x16x32_bf16 v[24:27], a[8:11], a[88:91], v[24:27]
    v_mfma_f32_16x16x32_bf16 v[24:27], a[12:15], a[92:95], v[24:27]
    v_mfma_f32_16x16x32_bf16 v[28:31], a[16:19], a[80:83], 0
    v_mfma_f32_16x16x32_bf16 v[28:31], a[20:23], a[84:87], v[28:31]
    v_mfma_f32_16x16x32_bf16 v[28:31], a[24:27], a[88:91], v[28:31]
    v_mfma_f32_16x16x32_bf16 v[28:31], a[28:31], a[92:95], v[28:31]
    s_nop 7
    s_lshl_b32 s73, s64, 5
    s_add_u32 s62, s73, 0
    v_cmp_gt_i32 vcc, s62, v88
    s_nop 1
    v_cndmask_b32 v16, v16, v90, vcc
    v_cmp_gt_i32 vcc, s62, v89
    s_nop 1
    v_cndmask_b32 v24, v24, v90, vcc
    s_add_u32 s62, s73, 1
    v_cmp_gt_i32 vcc, s62, v88
    s_nop 1
    v_cndmask_b32 v17, v17, v90, vcc
    v_cmp_gt_i32 vcc, s62, v89
    s_nop 1
    v_cndmask_b32 v25, v25, v90, vcc
    s_add_u32 s62, s73, 2
    v_cmp_gt_i32 vcc, s62, v88
    s_nop 1
    v_cndmask_b32 v18, v18, v90, vcc
    v_cmp_gt_i32 vcc, s62, v89
    s_nop 1
    v_cndmask_b32 v26, v26, v90, vcc
    s_add_u32 s62, s73, 3
    v_cmp_gt_i32 vcc, s62, v88
    s_nop 1
    v_cndmask_b32 v19, v19, v90, vcc
    v_cmp_gt_i32 vcc, s62, v89
    s_nop 1
    v_cndmask_b32 v27, v27, v90, vcc
    s_add_u32 s62, s73, 16
    v_cmp_gt_i32 vcc, s62, v88
    s_nop 1
    v_cndmask_b32 v20, v20, v90, vcc
    v_cmp_gt_i32 vcc, s62, v89
    s_nop 1
    v_cndmask_b32 v28, v28, v90, vcc
    s_add_u32 s62, s73, 17
    v_cmp_gt_i32 vcc, s62, v88
    s_nop 1
    v_cndmask_b32 v21, v21, v90, vcc
    v_cmp_gt_i32 vcc, s62, v89
    s_nop 1
    v_cndmask_b32 v29, v29, v90, vcc
    s_add_u32 s62, s73, 18
    v_cmp_gt_i32 vcc, s62, v88
    s_nop 1
    v_cndmask_b32 v22, v22, v90, vcc
    v_cmp_gt_i32 vcc, s62, v89
    s_nop 1
    v_cndmask_b32 v30, v30, v90, vcc
    s_add_u32 s62, s73, 19
    v_cmp_gt_i32 vcc, s62, v88
    s_nop 1
    v_cndmask_b32 v23, v23, v90, vcc
    v_cmp_gt_i32 vcc, s62, v89
    s_nop 1
    v_cndmask_b32 v31, v31, v90, vcc
    v_max3_f32 v80, v16, v17, v18
    v_max3_f32 v80, v80, v19, v20
    v_max3_f32 v80, v80, v21, v22
    v_max3_f32 v80, v80, v23, v116
    v_max3_f32 v81, v24, v25, v26
    v_max3_f32 v81, v81, v27, v28
    v_max3_f32 v81, v81, v29, v30
    v_max3_f32 v81, v81, v31, v117
    v_mov_b32 v82, v80
    v_mov_b32 v83, v81
    s_nop 1
    v_permlane32_swap_b32 v80, v82
    v_permlane32_swap_b32 v81, v83
    v_max_f32 v80, v80, v82
    v_max_f32 v81, v81, v83
    v_mov_b32 v82, v80
    v_mov_b32 v83, v81
    s_nop 1
    v_permlane16_swap_b32 v80, v82
    v_permlane16_swap_b32 v81, v83
    v_max_f32 v80, v80, v82
    v_max_f32 v81, v81, v83
    v_sub_f32 v118, v116, v80
    v_exp_f32 v118, v118
    v_mov_b32 v116, v80
    v_sub_f32 v16, v16, v116
    v_sub_f32 v17, v17, v116
    v_sub_f32 v18, v18, v116
    v_sub_f32 v19, v19, v116
    v_sub_f32 v20, v20, v116
    v_sub_f32 v21, v21, v116
    v_sub_f32 v22, v22, v116
    v_sub_f32 v23, v23, v116
    v_exp_f32 v48, v16
    v_exp_f32 v49, v17
    v_exp_f32 v50, v18
    v_exp_f32 v51, v19
    v_exp_f32 v52, v20
    v_exp_f32 v53, v21
    v_exp_f32 v54, v22
    v_exp_f32 v55, v23
    v_mul_f32 v124, v124, v118
    v_mul_f32 v128, v128, v118
    v_mul_f32 v129, v129, v118
    v_mul_f32 v130, v130, v118
    v_mul_f32 v131, v131, v118
    v_mul_f32 v132, v132, v118
    v_mul_f32 v133, v133, v118
    v_mul_f32 v134, v134, v118
    v_mul_f32 v135, v135, v118
    v_mul_f32 v136, v136, v118
    v_mul_f32 v137, v137, v118
    v_mul_f32 v138, v138, v118
    v_mul_f32 v139, v139, v118
    v_mul_f32 v140, v140, v118
    v_mul_f32 v141, v141, v118
    v_mul_f32 v142, v142, v118
    v_mul_f32 v143, v143, v118
    v_mul_f32 v144, v144, v118
    v_mul_f32 v145, v145, v118
    v_mul_f32 v146, v146, v118
    v_mul_f32 v147, v147, v118
    v_mul_f32 v148, v148, v118
    v_mul_f32 v149, v149, v118
    v_mul_f32 v150, v150, v118
    v_mul_f32 v151, v151, v118
    v_mul_f32 v152, v152, v118
    v_mul_f32 v153, v153, v118
    v_mul_f32 v154, v154, v118
    v_mul_f32 v155, v155, v118
    v_mul_f32 v156, v156, v118
    v_mul_f32 v157, v157, v118
    v_mul_f32 v158, v158, v118
    v_mul_f32 v159, v159, v118
    v_cvt_pk_bf16_f32 v64, v48, v49
    v_cvt_pk_bf16_f32 v65, v50, v51
    v_cvt_pk_bf16_f32 v66, v52, v53
    v_cvt_pk_bf16_f32 v67, v54, v55
    v_add_f32 v124, v124, v48
    v_add_f32 v124, v124, v49
    v_add_f32 v124, v124, v50
    v_add_f32 v124, v124, v51
    v_add_f32 v124, v124, v52
    v_add_f32 v124, v124, v53
    v_add_f32 v124, v124, v54
    v_add_f32 v124, v124, v55
    v_sub_f32 v119, v117, v81
    v_exp_f32 v119, v119
    v_mov_b32 v117, v81
    v_sub_f32 v24, v24, v117
    v_sub_f32 v25, v25, v117
    v_sub_f32 v26, v26, v117
    v_sub_f32 v27, v27, v117
    v_sub_f32 v28, v28, v117
    v_sub_f32 v29, v29, v117
    v_sub_f32 v30, v30, v117
    v_sub_f32 v31, v31, v117
    v_exp_f32 v56, v24
    v_exp_f32 v57, v25
    v_exp_f32 v58, v26
    v_exp_f32 v59, v27
    v_exp_f32 v60, v28
    v_exp_f32 v61, v29
    v_exp_f32 v62, v30
    v_exp_f32 v63, v31
    v_mul_f32 v125, v125, v119
    v_mul_f32 v160, v160, v119
    v_mul_f32 v161, v161, v119
    v_mul_f32 v162, v162, v119
    v_mul_f32 v163, v163, v119
    v_mul_f32 v164, v164, v119
    v_mul_f32 v165, v165, v119
    v_mul_f32 v166, v166, v119
    v_mul_f32 v167, v167, v119
    v_mul_f32 v168, v168, v119
    v_mul_f32 v169, v169, v119
    v_mul_f32 v170, v170, v119
    v_mul_f32 v171, v171, v119
    v_mul_f32 v172, v172, v119
    v_mul_f32 v173, v173, v119
    v_mul_f32 v174, v174, v119
    v_mul_f32 v175, v175, v119
    v_mul_f32 v176, v176, v119
    v_mul_f32 v177, v177, v119
    v_mul_f32 v178, v178, v119
    v_mul_f32 v179, v179, v119
    v_mul_f32 v180, v180, v119
    v_mul_f32 v181, v181, v119
    v_mul_f32 v182, v182, v119
    v_mul_f32 v183, v183, v119
    v_mul_f32 v184, v184, v119
    v_mul_f32 v185, v185, v119
    v_mul_f32 v186, v186, v119
    v_mul_f32 v187, v187, v119
    v_mul_f32 v188, v188, v119
    v_mul_f32 v189, v189, v119
    v_mul_f32 v190, v190, v119
    v_mul_f32 v191, v191, v119
    v_cvt_pk_bf16_f32 v68, v56, v57
    v_cvt_pk_bf16_f32 v69, v58, v59
    v_cvt_pk_bf16_f32 v70, v60, v61
    v_cvt_pk_bf16_f32 v71, v62, v63
    v_add_f32 v125, v125, v56
    v_add_f32 v125, v125, v57
    v_add_f32 v125, v125, v58
    v_add_f32 v125, v125, v59
    v_add_f32 v125, v125, v60
    v_add_f32 v125, v125, v61
    v_add_f32 v125, v125, v62
    v_add_f32 v125, v125, v63
    s_nop 1
    v_mfma_f32_16x16x32_bf16 v[128:131], a[32:35], v[64:67], v[128:131]
    v_mfma_f32_16x16x32_bf16 v[132:135], a[36:39], v[64:67], v[132:135]
    v_mfma_f32_16x16x32_bf16 v[136:139], a[40:43], v[64:67], v[136:139]
    v_mfma_f32_16x16x32_bf16 v[140:143], a[44:47], v[64:67], v[140:143]
    v_mfma_f32_16x16x32_bf16 v[144:147], a[48:51], v[64:67], v[144:147]
    v_mfma_f32_16x16x32_bf16 v[148:151], a[52:55], v[64:67], v[148:151]
    v_mfma_f32_16x16x32_bf16 v[152:155], a[56:59], v[64:67], v[152:155]
    v_mfma_f32_16x16x32_bf16 v[156:159], a[60:63], v[64:67], v[156:159]
    v_mfma_f32_16x16x32_bf16 v[160:163], a[32:35], v[68:71], v[160:163]
    v_mfma_f32_16x16x32_bf16 v[164:167], a[36:39], v[68:71], v[164:167]
    v_mfma_f32_16x16x32_bf16 v[168:171], a[40:43], v[68:71], v[168:171]
    v_mfma_f32_16x16x32_bf16 v[172:175], a[44:47], v[68:71], v[172:175]
    v_mfma_f32_16x16x32_bf16 v[176:179], a[48:51], v[68:71], v[176:179]
    v_mfma_f32_16x16x32_bf16 v[180:183], a[52:55], v[68:71], v[180:183]
    v_mfma_f32_16x16x32_bf16 v[184:187], a[56:59], v[68:71], v[184:187]
    v_mfma_f32_16x16x32_bf16 v[188:191], a[60:63], v[68:71], v[188:191]
    s_add_u32 s69, s69, 16384
    s_add_u32 s64, s64, 1
    s_cmp_le_u32 s64, s67
    s_cbranch_scc1 AT_fbl
    v_mov_b32 v80, v124
    v_mov_b32 v81, v125
    s_nop 1
    v_permlane32_swap_b32 v124, v80
    v_permlane32_swap_b32 v125, v81
    v_add_f32 v124, v124, v80
    v_add_f32 v125, v125, v81
    v_mov_b32 v80, v124
    v_mov_b32 v81, v125
    s_nop 1
    v_permlane16_swap_b32 v124, v80
    v_permlane16_swap_b32 v125, v81
    v_add_f32 v124, v124, v80
    v_add_f32 v125, v125, v81
    v_rcp_f32 v116, v124
    v_rcp_f32 v118, v125
    s_nop 0
    v_pk_mul_f32 v[128:129], v[128:129], v[116:117] op_sel_hi:[1,0]
    v_pk_mul_f32 v[130:131], v[130:131], v[116:117] op_sel_hi:[1,0]
    v_pk_mul_f32 v[132:133], v[132:133], v[116:117] op_sel_hi:[1,0]
    v_pk_mul_f32 v[134:135], v[134:135], v[116:117] op_sel_hi:[1,0]
    v_cvt_pk_bf16_f32 v128, v128, v129
    v_cvt_pk_bf16_f32 v129, v130, v131
    v_cvt_pk_bf16_f32 v130, v132, v133
    v_cvt_pk_bf16_f32 v131, v134, v135
    buffer_store_dwordx4 v[128:131], v2, s[20:23], s68 offen offset:0 sc1
    v_pk_mul_f32 v[136:137], v[136:137], v[116:117] op_sel_hi:[1,0]
    v_pk_mul_f32 v[138:139], v[138:139], v[116:117] op_sel_hi:[1,0]
    v_pk_mul_f32 v[140:141], v[140:141], v[116:117] op_sel_hi:[1,0]
    v_pk_mul_f32 v[142:143], v[142:143], v[116:117] op_sel_hi:[1,0]
    v_cvt_pk_bf16_f32 v136, v136, v137
    v_cvt_pk_bf16_f32 v137, v138, v139
    v_cvt_pk_bf16_f32 v138, v140, v141
    v_cvt_pk_bf16_f32 v139, v142, v143
    buffer_store_dwordx4 v[136:139], v2, s[20:23], s68 offen offset:1024 sc1
    v_pk_mul_f32 v[144:145], v[144:145], v[116:117] op_sel_hi:[1,0]
    v_pk_mul_f32 v[146:147], v[146:147], v[116:117] op_sel_hi:[1,0]
    v_pk_mul_f32 v[148:149], v[148:149], v[116:117] op_sel_hi:[1,0]
    v_pk_mul_f32 v[150:151], v[150:151], v[116:117] op_sel_hi:[1,0]
    v_cvt_pk_bf16_f32 v144, v144, v145
    v_cvt_pk_bf16_f32 v145, v146, v147
    v_cvt_pk_bf16_f32 v146, v148, v149
    v_cvt_pk_bf16_f32 v147, v150, v151
    buffer_store_dwordx4 v[144:147], v2, s[20:23], s68 offen offset:2048 sc1
    v_pk_mul_f32 v[152:153], v[152:153], v[116:117] op_sel_hi:[1,0]
    v_pk_mul_f32 v[154:155], v[154:155], v[116:117] op_sel_hi:[1,0]
    v_pk_mul_f32 v[156:157], v[156:157], v[116:117] op_sel_hi:[1,0]
    v_pk_mul_f32 v[158:159], v[158:159], v[116:117] op_sel_hi:[1,0]
    v_cvt_pk_bf16_f32 v152, v152, v153
    v_cvt_pk_bf16_f32 v153, v154, v155
    v_cvt_pk_bf16_f32 v154, v156, v157
    v_cvt_pk_bf16_f32 v155, v158, v159
    buffer_store_dwordx4 v[152:155], v2, s[20:23], s68 offen offset:3072 sc1
    v_pk_mul_f32 v[160:161], v[160:161], v[118:119] op_sel_hi:[1,0]
    v_pk_mul_f32 v[162:163], v[162:163], v[118:119] op_sel_hi:[1,0]
    v_pk_mul_f32 v[164:165], v[164:165], v[118:119] op_sel_hi:[1,0]
    v_pk_mul_f32 v[166:167], v[166:167], v[118:119] op_sel_hi:[1,0]
    v_cvt_pk_bf16_f32 v160, v160, v161
    v_cvt_pk_bf16_f32 v161, v162, v163
    v_cvt_pk_bf16_f32 v162, v164, v165
    v_cvt_pk_bf16_f32 v163, v166, v167
    buffer_store_dwordx4 v[160:163], v2, s[20:23], s72 offen offset:0 sc1
    v_pk_mul_f32 v[168:169], v[168:169], v[118:119] op_sel_hi:[1,0]
    v_pk_mul_f32 v[170:171], v[170:171], v[118:119] op_sel_hi:[1,0]
    v_pk_mul_f32 v[172:173], v[172:173], v[118:119] op_sel_hi:[1,0]
    v_pk_mul_f32 v[174:175], v[174:175], v[118:119] op_sel_hi:[1,0]
    v_cvt_pk_bf16_f32 v168, v168, v169
    v_cvt_pk_bf16_f32 v169, v170, v171
    v_cvt_pk_bf16_f32 v170, v172, v173
    v_cvt_pk_bf16_f32 v171, v174, v175
    buffer_store_dwordx4 v[168:171], v2, s[20:23], s72 offen offset:1024 sc1
    v_pk_mul_f32 v[176:177], v[176:177], v[118:119] op_sel_hi:[1,0]
    v_pk_mul_f32 v[178:179], v[178:179], v[118:119] op_sel_hi:[1,0]
    v_pk_mul_f32 v[180:181], v[180:181], v[118:119] op_sel_hi:[1,0]
    v_pk_mul_f32 v[182:183], v[182:183], v[118:119] op_sel_hi:[1,0]
    v_cvt_pk_bf16_f32 v176, v176, v177
    v_cvt_pk_bf16_f32 v177, v178, v179
    v_cvt_pk_bf16_f32 v178, v180, v181
    v_cvt_pk_bf16_f32 v179, v182, v183
    buffer_store_dwordx4 v[176:179], v2, s[20:23], s72 offen offset:2048 sc1
    v_pk_mul_f32 v[184:185], v[184:185], v[118:119] op_sel_hi:[1,0]
    v_pk_mul_f32 v[186:187], v[186:187], v[118:119] op_sel_hi:[1,0]
    v_pk_mul_f32 v[188:189], v[188:189], v[118:119] op_sel_hi:[1,0]
    v_pk_mul_f32 v[190:191], v[190:191], v[118:119] op_sel_hi:[1,0]
    v_cvt_pk_bf16_f32 v184, v184, v185
    v_cvt_pk_bf16_f32 v185, v186, v187
    v_cvt_pk_bf16_f32 v186, v188, v189
    v_cvt_pk_bf16_f32 v187, v190, v191
    buffer_store_dwordx4 v[184:187], v2, s[20:23], s72 offen offset:3072 sc1
    s_branch AT_fb
AT_fbe:
    s_add_u32 s62, s71, 131072
    buffer_load_dwordx4 v[128:131], v2, s[20:23], s70 offen offset:0 sc1
    buffer_load_dwordx4 v[136:139], v2, s[20:23], s70 offen offset:1024 sc1
    buffer_load_dwordx4 v[144:147], v2, s[20:23], s70 offen offset:2048 sc1
    buffer_load_dwordx4 v[152:155], v2, s[20:23], s70 offen offset:3072 sc1
    buffer_load_dwordx4 v[160:163], v2, s[20:23], s63 offen offset:0 sc1
    buffer_load_dwordx4 v[168:171], v2, s[20:23], s63 offen offset:1024 sc1
    buffer_load_dwordx4 v[176:179], v2, s[20:23], s63 offen offset:2048 sc1
    buffer_load_dwordx4 v[184:187], v2, s[20:23], s63 offen offset:3072 sc1
    buffer_load_dwordx4 v[192:195], v2, s[20:23], s71 offen offset:0 sc1
    buffer_load_dwordx4 v[200:203], v2, s[20:23], s71 offen offset:1024 sc1
    buffer_load_dwordx4 v[208:211], v2, s[20:23], s71 offen offset:2048 sc1
    buffer_load_dwordx4 v[216:219], v2, s[20:23], s71 offen offset:3072 sc1
    buffer_load_dwordx4 v[224:227], v2, s[20:23], s62 offen offset:0 sc1
    buffer_load_dwordx4 v[232:235], v2, s[20:23], s62 offen offset:1024 sc1
    buffer_load_dwordx4 v[240:243], v2, s[20:23], s62 offen offset:2048 sc1
    buffer_load_dwordx4 v[248:251], v2, s[20:23], s62 offen offset:3072 sc1
    s_waitcnt vmcnt(0)
    s_branch AT_fbx
L_end:
    s_endpgm
.section .rodata,"a"
.p2align 6
.amdhsa_kernel concat_heads__sliding_local_dilated__compressed_kv_cla__prompt_kernel
.amdhsa_next_free_vgpr 512
.amdhsa_next_free_sgpr 102
.amdhsa_accum_offset 256
.amdhsa_group_segment_fixed_size 0
.amdhsa_kernarg_size 96
.amdhsa_user_sgpr_count 2
.amdhsa_user_sgpr_kernarg_segment_ptr 1
.amdhsa_system_sgpr_workgroup_id_x 1
.end_amdhsa_kernel
.text
```
